```python
import torch

def _softmax(x, axis=-1):
    return torch.softmax(x, dim=axis)
def _gelu(x):
    return torch.nn.functional.gelu(x, approximate="tanh")
def _silu(x):
    return torch.nn.functional.silu(x)
def _sigmoid(x):
    return torch.sigmoid(x)
def _layernorm(x, axis=-1, eps=1e-5):
    m = x.mean(dim=axis, keepdim=True)
    v = x.var(dim=axis, keepdim=True, unbiased=False)
    return (x - m) / torch.sqrt(v + eps)
def _scatter_add(tgt, idx, src, axis=0):
    return tgt.clone().index_add_(axis, idx, src)
def _segment_sum(src, seg, n):
    out = torch.zeros((n,) + src.shape[1:], dtype=src.dtype)
    return out.index_add_(0, seg, src)
def _pad(x, pw):
    flat = tuple(v for pair in reversed(pw) for v in pair)
    return torch.nn.functional.pad(x, flat)

kernel_name = 'gated_mix__spectral_fnet__geglu_ffn__prompt'

def setup_inputs():

    _w = (lambda a: (lambda t: t.to(torch.bfloat16) if t.is_floating_point() else t)(torch.as_tensor(a)))
    def _A_setup():
        B, S, D = 1, 2048, 1024
        ns = torch.arange(S)[:, None] * torch.arange(S)[None, :]
        nd = torch.arange(D)[:, None] * torch.arange(D)[None, :]
        Ws_re = torch.cos(-2.0 * torch.pi * ns / S).to(float)
        Ws_im = torch.sin(-2.0 * torch.pi * ns / S).to(float)
        Wd_re = torch.cos(-2.0 * torch.pi * nd / D).to(float)
        Wd_im = torch.sin(-2.0 * torch.pi * nd / D).to(float)
        return {
            "x": _w((lambda *s: torch.randn(*s, dtype=torch.bfloat16) * 0.05)(B, S, D)),
            "dft_seq_re": _w(Ws_re),
            "dft_seq_im": _w(Ws_im),
            "dft_hid_re": _w(Wd_re),
            "dft_hid_im": _w(Wd_im),
        }
    _A_in = _A_setup()

    def _B_setup():
        B, S, D, F = 1, 2048, 1024, 3584
        return {
            "x": _w((lambda *s: torch.randn(*s, dtype=torch.bfloat16) * 0.05)(B, S, D)),
            "w_gate": _w((lambda *s: torch.randn(*s, dtype=torch.bfloat16) * 0.4)(D, F)),
            "w_up": _w((lambda *s: torch.randn(*s, dtype=torch.bfloat16) * 0.4)(D, F)),
            "w_down": _w((lambda *s: torch.randn(*s, dtype=torch.bfloat16) * 0.4)(F, D)),
        }
    _B_in = _B_setup()

    return {
        "A_x": _A_in["x"],
        "A_dft_seq_re": _A_in["dft_seq_re"],
        "A_dft_seq_im": _A_in["dft_seq_im"],
        "A_dft_hid_re": _A_in["dft_hid_re"],
        "A_dft_hid_im": _A_in["dft_hid_im"],
        "B_x": _B_in["x"],
        "B_w_gate": _B_in["w_gate"],
        "B_w_up": _B_in["w_up"],
        "B_w_down": _B_in["w_down"],
        "gate_w": _w((lambda *s: torch.randn(*s, dtype=torch.bfloat16) * 0.05)(1024) * 16.0),
    }

def reference(A_x, A_dft_seq_re, A_dft_seq_im, A_dft_hid_re, A_dft_hid_im, B_x, B_w_gate, B_w_up, B_w_down, gate_w):
    def _A_ref(x, dft_seq_re, dft_seq_im, dft_hid_re, dft_hid_im):
        a = torch.einsum("bsd,ed->bse", x, dft_hid_re)
        b = torch.einsum("bsd,ed->bse", x, dft_hid_im)
        y = torch.einsum("ts,bse->bte", dft_seq_re, a) - torch.einsum("ts,bse->bte", dft_seq_im, b)
        return y

    def _B_ref(x, w_gate, w_up, w_down):
        return (_gelu(x @ w_gate) * (x @ w_up)) @ w_down

    x = A_x
    g = _sigmoid((x * gate_w).sum(-1, keepdims=True))
    a = _A_ref(x, A_dft_seq_re, A_dft_seq_im, A_dft_hid_re, A_dft_hid_im)
    b = _B_ref(x, B_w_gate, B_w_up, B_w_down)
    return g * a + (1 - g) * b
```

```asm
; @launch grid=(256,1,1) block=(256,1,1) lds=163840
.amdgcn_target "amdgcn-amd-amdhsa--gfx950"
.text
.globl gated_mix__spectral_fnet__geglu_ffn__prompt_kernel
.p2align 8
.type gated_mix__spectral_fnet__geglu_ffn__prompt_kernel,@function
gated_mix__spectral_fnet__geglu_ffn__prompt_kernel:
    s_cmp_ge_u32 s2, 256
    s_cbranch_scc1 L_end
    s_load_dwordx2 s[40:41], s[0:1], 0
    s_load_dwordx4 s[44:47], s[0:1], 48
    s_load_dwordx2 s[48:49], s[0:1], 96
    s_load_dwordx2 s[88:89], s[0:1], 64
    s_load_dwordx2 s[42:43], s[0:1], 80
    s_load_dwordx8 s[52:59], s[0:1], 8
    s_load_dwordx2 s[60:61], s[0:1], 72
    s_getpc_b64 s[28:29]
    s_lshr_b32 s27, s2, 3
    s_mul_i32 s26, s27, 2048
    v_lshlrev_b32 v2, 7, v0
    v_add_u32 v2, s26, v2
    v_cmp_gt_u32 vcc, 16, v0
    s_and_saveexec_b64 s[30:31], vcc
    s_cbranch_execz L_nocp
    global_load_dword a255, v2, s[28:29]
L_nocp:
    s_mov_b64 exec, s[30:31]
    v_and_b32 v1, 63, v0
    v_lshrrev_b32 v2, 6, v0
    s_and_b32 s66, s2, 7
    v_readfirstlane_b32 s3, v2
    s_lshr_b32 s27, s2, 3
    s_sub_u32 s67, s27, 28
    s_and_b32 s24, s66, 1
    s_lshl_b32 s24, s24, 2
    s_and_b32 s68, s27, 3
    s_add_u32 s24, s24, s68
    s_lshr_b32 s25, s66, 1
    s_mul_i32 s25, s25, 7
    s_lshr_b32 s69, s27, 2
    s_add_u32 s25, s25, s69

    s_lshr_b32 s27, s2, 3
    s_cmp_ge_u32 s27, 28
    s_cbranch_scc1 L_dft
    s_lshl_b32 s29, s24, 19
    s_lshl_b32 s26, s3, 16
    s_add_u32 s29, s29, s26
    v_lshrrev_b32 v2, 3, v1
    s_lshl_b32 s26, s3, 5
    v_add_u32 v2, s26, v2
    v_lshlrev_b32 v2, 11, v2
    v_add_u32 v2, s29, v2
    v_lshrrev_b32 v3, 4, v1
    v_and_b32 v4, 7, v1
    v_xor_b32 v3, v3, v4
    v_lshl_add_u32 v8, v3, 4, v2
    v_xor_b32 v3, 4, v3
    v_lshl_add_u32 v9, v3, 4, v2
    v_add_u32 v10, 30720, v8
    v_add_u32 v11, 46080, v9
    v_add_u32 v9, 15360, v9

    v_lshrrev_b32 v2, 4, v1
    s_and_b32 s26, s3, 1
    s_lshl_b32 s26, s26, 4
    v_add_u32 v3, s26, v2
    s_mov_b32 s27, 7168
    v_mul_lo_u32 v3, v3, s27
    s_lshl_b32 s26, s25, 8
    v_add_u32 v3, s26, v3
    v_lshlrev_b32 v2, 1, v2
    v_and_b32 v4, 15, v1
    v_xor_b32 v2, v2, v4
    v_lshl_add_u32 v12, v2, 4, v3
    v_xor_b32 v2, 8, v2
    v_lshl_add_u32 v14, v2, 4, v3

    v_add_u32 v13, 27648, v12
    v_add_u32 v15, 82944, v14
    v_add_u32 v14, 55296, v14
    s_mov_b32 s16, 0
    s_mov_b32 s22, 65536
    s_mov_b32 s17, 0
    s_lshl_b32 s21, s3, 12
    s_add_u32 s21, s21, 98304
    s_lshl_b32 s23, s3, 13
    s_waitcnt lgkmcnt(0)
    s_mov_b32 s4, s40
    s_and_b32 s5, s41, 0xffff
    s_mov_b32 s6, 4194304
    s_mov_b32 s7, 0x20000
    s_cmp_ge_u32 s3, 2
    s_cselect_b32 s26, s46, s44
    s_cselect_b32 s27, s47, s45
    s_mov_b32 s8, s26
    s_and_b32 s9, s27, 0xffff
    s_mov_b32 s10, 7340032
    s_mov_b32 s11, 0x20000
    s_add_u32 m0, s21, 0
    s_nop 0
    buffer_load_dwordx4 v12, s[8:11], s17 offen offset:0 lds
    buffer_load_dwordx4 v13, s[8:11], s17 offen offset:1024 lds
    buffer_load_dwordx4 v14, s[8:11], s17 offen offset:2048 lds
    buffer_load_dwordx4 v15, s[8:11], s17 offen offset:3072 lds
    s_add_u32 s17, s17, 229376
    s_add_u32 m0, s23, 0
    s_nop 0
    buffer_load_dwordx4 v8, s[4:7], s16 offen offset:0 lds
    buffer_load_dwordx4 v9, s[4:7], s16 offen offset:1024 lds
    buffer_load_dwordx4 v10, s[4:7], s16 offen offset:2048 lds
    buffer_load_dwordx4 v11, s[4:7], s16 offen offset:3072 lds
    s_add_u32 m0, s23, 4096
    s_add_u32 s16, s16, 128
    buffer_load_dwordx4 v8, s[4:7], s22 offen offset:0 lds
    buffer_load_dwordx4 v9, s[4:7], s22 offen offset:1024 lds
    buffer_load_dwordx4 v10, s[4:7], s22 offen offset:2048 lds
    buffer_load_dwordx4 v11, s[4:7], s22 offen offset:3072 lds
    s_add_u32 s22, s22, 128
    s_add_u32 m0, s21, 16384
    s_nop 0
    buffer_load_dwordx4 v12, s[8:11], s17 offen offset:0 lds
    buffer_load_dwordx4 v13, s[8:11], s17 offen offset:1024 lds
    buffer_load_dwordx4 v14, s[8:11], s17 offen offset:2048 lds
    buffer_load_dwordx4 v15, s[8:11], s17 offen offset:3072 lds
    s_add_u32 s17, s17, 229376
    s_add_u32 s28, s48, 26214400
    s_addc_u32 s29, s49, 0
    s_load_dword s98, s[28:29], 0
    s_mov_b32 s12, s48
    s_and_b32 s13, s49, 0xffff
    s_mov_b32 s14, 268435456
    s_mov_b32 s15, 0x20000
    s_lshr_b32 s27, s2, 3
    s_and_b32 s50, s2, 1
    s_lshl_b32 s50, s50, 2
    s_and_b32 s26, s27, 3
    s_add_u32 s50, s50, s26
    s_lshr_b32 s51, s27, 2
    s_bfe_u32 s96, s2, 0x20001

    s_cmp_eq_u32 s3, 1
    s_cselect_b32 s80, s46, s44
    s_cselect_b32 s81, s47, s45
    s_mov_b32 s82, 7340032
    s_cmp_eq_u32 s3, 2
    s_cselect_b32 s80, s40, s80
    s_cselect_b32 s81, s41, s81
    s_cselect_b32 s82, 4194304, s82
    s_cmp_eq_u32 s3, 3
    s_cselect_b32 s80, s88, s80
    s_cselect_b32 s81, s89, s81
    s_and_b32 s81, s81, 0xffff
    s_mov_b32 s83, 0x20000
    v_mov_b32 v3, 1073741824
    s_add_u32 s86, s67, 28
    s_cmp_ge_u32 s3, 2
    s_cbranch_scc1 L_t_x
    v_lshrrev_b32 v2, 4, v1
    v_lshlrev_b32 v2, 5, v2
    v_bfe_u32 v4, v1, 1, 3
    v_add_u32 v2, v2, v4
    s_lshl_b32 s26, s68, 3
    v_add_u32 v2, s26, v2
    s_mov_b32 s27, 7168
    v_mul_lo_u32 v2, v2, s27
    v_and_b32 v4, 1, v1
    v_lshl_add_u32 v2, v4, 7, v2
    s_lshl_b32 s26, s25, 8
    v_add_u32 v26, s26, v2
    v_cmp_gt_u32 vcc, 32, v1
    s_mov_b32 s84, 458752
    s_mov_b32 s85, 458752
    v_cndmask_b32 v27, v3, v26, vcc
    s_mov_b32 s75, 917504
    v_mov_b32 v42, v3
    buffer_load_dword v28, v3, s[4:7], 0 offen
    buffer_load_dword v28, v3, s[4:7], 0 offen
    v_mov_b32 v48, v3
    s_branch L_t_done
L_t_x:
    s_cmp_eq_u32 s3, 3
    s_cbranch_scc1 L_t_wd
    s_mul_i32 s26, s69, 37
    s_lshl_b32 s27, s24, 8
    s_add_u32 s26, s26, s27
    v_add_u32 v2, s26, v1
    v_lshlrev_b32 v2, 11, v2
    v_cmp_gt_u32 vcc, 0, v1
    s_mov_b32 s84, 128
    s_mov_b32 s85, 0
    v_cndmask_b32 v42, v3, v2, vcc
    s_mov_b32 s75, 128
    v_mov_b32 v27, v3
    buffer_load_dword v28, v42, s[80:83], s84 offen offset:128
    buffer_load_dword v28, v3, s[4:7], 0 offen
    v_mov_b32 v48, v3
    s_branch L_t_done
L_t_wd:
    s_mul_i32 s27, s86, 49
    v_cmp_gt_u32 vcc, 49, v1
    s_lshl_b32 s28, s66, 6

    v_add_u32 v2, s27, v1
    v_add_u32 v2, 0, v2
    v_bfe_u32 v4, v2, 4, 3
    v_bfe_u32 v5, v2, 7, 2
    v_lshl_add_u32 v4, v5, 4, v4
    v_bfe_u32 v5, v2, 11, 1
    v_lshl_add_u32 v4, v5, 3, v4
    v_add_u32 v4, s28, v4
    v_bfe_u32 v5, v2, 9, 2
    v_and_b32 v6, 1, v5
    v_lshrrev_b32 v7, 1, v5
    v_xor_b32 v6, v6, v7
    v_sub_u32 v7, 0, v4
    v_cmp_eq_u32 s[62:63], 1, v6
    v_and_b32 v2, 15, v2
    v_lshlrev_b32 v2, 7, v2
    v_cndmask_b32 v4, v4, v7, s[62:63]
    v_lshlrev_b32 v6, 11, v5
    v_cmp_le_u32 s[62:63], 2, v5
    v_mov_b32 v7, 1024
    s_nop 0
    v_cndmask_b32 v6, v6, v7, s[62:63]
    v_add_u32 v4, v4, v6
    v_lshl_add_u32 v2, v4, 11, v2
    v_cndmask_b32 v46, v3, v2, vcc

    buffer_load_dword v28, v46, s[4:7], 0 offen
    v_add_u32 v2, s27, v1
    v_add_u32 v2, 1372, v2
    v_bfe_u32 v4, v2, 4, 3
    v_bfe_u32 v5, v2, 7, 2
    v_lshl_add_u32 v4, v5, 4, v4
    v_bfe_u32 v5, v2, 11, 1
    v_lshl_add_u32 v4, v5, 3, v4
    v_add_u32 v4, s28, v4
    v_bfe_u32 v5, v2, 9, 2
    v_and_b32 v6, 1, v5
    v_lshrrev_b32 v7, 1, v5
    v_xor_b32 v6, v6, v7
    v_sub_u32 v7, 0, v4
    v_cmp_eq_u32 s[62:63], 1, v6
    v_and_b32 v2, 15, v2
    v_lshlrev_b32 v2, 7, v2
    v_cndmask_b32 v4, v4, v7, s[62:63]
    v_lshlrev_b32 v6, 11, v5
    v_cmp_le_u32 s[62:63], 2, v5
    v_mov_b32 v7, 1024
    s_nop 0
    v_cndmask_b32 v6, v6, v7, s[62:63]
    v_add_u32 v4, v4, v6
    v_lshl_add_u32 v2, v4, 11, v2
    v_cndmask_b32 v47, v3, v2, vcc

    buffer_load_dword v28, v47, s[4:7], 0 offen
    v_add_u32 v2, s27, v1
    v_add_u32 v2, 2744, v2
    v_bfe_u32 v4, v2, 4, 3
    v_bfe_u32 v5, v2, 7, 2
    v_lshl_add_u32 v4, v5, 4, v4
    v_bfe_u32 v5, v2, 11, 1
    v_lshl_add_u32 v4, v5, 3, v4
    v_add_u32 v4, s28, v4
    v_bfe_u32 v5, v2, 9, 2
    v_and_b32 v6, 1, v5
    v_lshrrev_b32 v7, 1, v5
    v_xor_b32 v6, v6, v7
    v_sub_u32 v7, 0, v4
    v_cmp_eq_u32 s[62:63], 1, v6
    v_and_b32 v2, 15, v2
    v_lshlrev_b32 v2, 7, v2
    v_cndmask_b32 v4, v4, v7, s[62:63]
    v_lshlrev_b32 v6, 11, v5
    v_cmp_le_u32 s[62:63], 2, v5
    v_mov_b32 v7, 1024
    s_nop 0
    v_cndmask_b32 v6, v6, v7, s[62:63]
    v_add_u32 v4, v4, v6
    v_lshl_add_u32 v2, v4, 11, v2
    v_cndmask_b32 v48, v3, v2, vcc

    buffer_load_dword v28, v48, s[4:7], 0 offen
    v_lshlrev_b32 v2, 7, v1
    v_cmp_gt_u32 vcc, 32, v1
    s_mul_i32 s84, s66, 28
    s_add_u32 s84, s84, s86
    s_lshl_b32 s84, s84, 12
    v_cndmask_b32 v27, v3, v2, vcc
    s_mov_b32 s85, 917504
    s_mov_b32 s75, 0
    v_mov_b32 v42, v3
L_t_done:

    buffer_load_dword v28, v42, s[80:83], s84 offen
    s_add_u32 s84, s84, s75
    s_cmp_lt_u32 s66, 4
    s_cselect_b32 s36, s56, s58
    s_cselect_b32 s37, s57, s59
    s_cmp_eq_u32 s3, 2
    s_cselect_b32 s36, s52, s36
    s_cselect_b32 s37, s53, s37
    s_cmp_eq_u32 s3, 3
    s_cselect_b32 s36, s54, s36
    s_cselect_b32 s37, s55, s37
    s_and_b32 s37, s37, 0xffff
    s_mov_b32 s39, 0x20000
    s_and_b32 s28, s66, 3
    s_lshl_b32 s26, s28, 18
    s_lshl_b32 s28, s28, 8
    s_lshr_b32 s27, s66, 2
    s_add_u32 s28, s28, s27
    s_lshl_b32 s28, s28, 12
    s_cmp_eq_u32 s3, 1
    s_cselect_b32 s28, s26, s28
    s_cselect_b32 s26, 11, 13
    s_cselect_b32 s38, 2097152, s82
    s_mul_i32 s27, s86, 37
    v_add_u32 v2, s27, v1
    v_lshrrev_b32 v4, 3, v2
    v_lshlrev_b32 v4, s26, v4
    v_and_b32 v2, 7, v2
    v_lshl_add_u32 v2, v2, 7, v4
    s_cmp_eq_u32 s3, 0
    s_cselect_b32 s27, 0, 37
    v_cmp_gt_u32 vcc, s27, v1
    v_mov_b32 v3, 1073741824
    s_nop 0
    v_cndmask_b32 v2, v3, v2, vcc
    v_add_u32 v34, s28, v2
    s_cmp_eq_u32 s3, 1
    s_cselect_b64 vcc, -1, 0
    s_nop 0
    v_cndmask_b32 v2, v3, v34, vcc
    v_cndmask_b32 v34, v34, v3, vcc
    buffer_load_dword v28, v2, s[36:39], 0 offen

    v_lshlrev_b32 v40, 21, v1
    v_add_u32 v40, 0x100000, v40
    s_lshr_b32 s26, s3, 1
    s_lshl_b32 s26, s26, 7
    v_and_b32 v2, 15, v1
    v_lshrrev_b32 v5, 1, v2
    v_add_u32 v2, s26, v2
    v_lshlrev_b32 v2, 7, v2
    v_lshrrev_b32 v3, 4, v1
    v_xor_b32 v5, v3, v5
    v_lshl_add_u32 v16, v5, 4, v2
    v_xor_b32 v5, 4, v5
    v_lshl_add_u32 v33, v5, 4, v2
    v_lshrrev_b32 v4, 2, v1
    v_and_b32 v4, 3, v4
    v_lshl_add_u32 v5, v3, 3, v4
    v_lshlrev_b32 v5, 8, v5
    v_add_u32 v5, 98304, v5
    v_and_b32 v6, 3, v1
    v_lshl_add_u32 v5, v6, 3, v5
    v_and_b32 v6, 1, v3
    v_lshl_or_b32 v6, v6, 2, v4
    s_and_b32 s26, s3, 1
    s_lshl_b32 s26, s26, 2
    v_xor_b32 v6, s26, v6

    v_xor_b32 v7, 0, v6
    v_lshl_add_u32 v17, v7, 5, v5
    v_xor_b32 v7, 1, v6
    v_lshl_add_u32 v18, v7, 5, v5
    v_xor_b32 v7, 2, v6
    v_lshl_add_u32 v19, v7, 5, v5
    v_xor_b32 v7, 3, v6
    v_lshl_add_u32 v20, v7, 5, v5
    v_mov_b32 v21, v16
    v_mov_b32 v22, v17
    v_mov_b32 v23, v18
    v_mov_b32 v24, v19
    v_mov_b32 v25, v20
    v_mov_b32 v36, 0
    v_mov_b32 v37, 0
    v_mov_b32 v38, 0
    v_mov_b32 v39, 0
    s_nop 1
    v_mfma_f32_32x32x16_bf16 v[128:143], v[36:39], v[36:39], 0
    v_mfma_f32_32x32x16_bf16 a[0:15], v[36:39], v[36:39], 0
    v_mfma_f32_32x32x16_bf16 v[144:159], v[36:39], v[36:39], 0
    v_mfma_f32_32x32x16_bf16 a[16:31], v[36:39], v[36:39], 0
    v_mfma_f32_32x32x16_bf16 v[160:175], v[36:39], v[36:39], 0
    v_mfma_f32_32x32x16_bf16 a[32:47], v[36:39], v[36:39], 0
    v_mfma_f32_32x32x16_bf16 v[176:191], v[36:39], v[36:39], 0
    v_mfma_f32_32x32x16_bf16 a[48:63], v[36:39], v[36:39], 0
    v_mfma_f32_32x32x16_bf16 v[192:207], v[36:39], v[36:39], 0
    v_mfma_f32_32x32x16_bf16 a[64:79], v[36:39], v[36:39], 0
    v_mfma_f32_32x32x16_bf16 v[208:223], v[36:39], v[36:39], 0
    v_mfma_f32_32x32x16_bf16 a[80:95], v[36:39], v[36:39], 0
    v_mfma_f32_32x32x16_bf16 v[224:239], v[36:39], v[36:39], 0
    v_mfma_f32_32x32x16_bf16 a[96:111], v[36:39], v[36:39], 0
    v_mfma_f32_32x32x16_bf16 v[240:255], v[36:39], v[36:39], 0
    v_mfma_f32_32x32x16_bf16 a[112:127], v[36:39], v[36:39], 0
    s_waitcnt vmcnt(8) lgkmcnt(0)
    s_barrier
    ds_read_b64_tr_b16 a[128:129], v22 offset:0
    ds_read_b64_tr_b16 a[130:131], v22 offset:1024
    ds_read_b128 a[160:163], v21 offset:0
    ds_read_b64_tr_b16 a[144:145], v22 offset:8192
    ds_read_b64_tr_b16 a[146:147], v22 offset:9216
    ds_read_b128 a[164:167], v21 offset:2048
    ds_read_b64_tr_b16 a[132:133], v23 offset:0
    ds_read_b64_tr_b16 a[134:135], v23 offset:1024
    ds_read_b128 a[168:171], v21 offset:4096
    ds_read_b64_tr_b16 a[148:149], v23 offset:8192
    ds_read_b64_tr_b16 a[150:151], v23 offset:9216
    ds_read_b128 a[172:175], v21 offset:6144
    ds_read_b64_tr_b16 a[136:137], v24 offset:0
    ds_read_b64_tr_b16 a[138:139], v24 offset:1024
    ds_read_b128 a[176:179], v21 offset:8192
    ds_read_b64_tr_b16 a[152:153], v24 offset:8192
    ds_read_b64_tr_b16 a[154:155], v24 offset:9216
    ds_read_b128 a[180:183], v21 offset:10240
    ds_read_b64_tr_b16 a[140:141], v25 offset:0
    ds_read_b64_tr_b16 a[142:143], v25 offset:1024
    ds_read_b128 a[184:187], v21 offset:12288
    ds_read_b64_tr_b16 a[156:157], v25 offset:8192
    ds_read_b64_tr_b16 a[158:159], v25 offset:9216
    ds_read_b128 a[188:191], v21 offset:14336
    s_mul_i32 s98, s98, 0x9E3779B1
    s_add_u32 s98, s98, 0x7F4A7C15
    s_xor_b32 s99, s98, 0x5bd1e995
    s_lshl_b32 s26, s2, 7
    s_add_u32 s26, s26, 26607616
    s_cmp_eq_u32 s3, 0
    s_cselect_b32 s26, s26, 1073741824
    v_and_b32 v43, 15, v1
    v_lshl_add_u32 v43, v43, 3, s26
    v_mov_b32 v44, s98
    v_mov_b32 v45, s99
    s_mov_b32 s19, 0
    s_mov_b32 s20, 32768
    s_mov_b32 s18, 0
    s_mov_b32 s28, 16384
    s_mov_b32 s29, 0
    v_mov_b32 v21, v33
    v_add_u32 v22, s28, v17
    v_add_u32 v23, s28, v18
    v_add_u32 v24, s28, v19
    v_add_u32 v25, s28, v20
    s_mov_b32 s72, 229376
    s_mov_b32 s73, 128
    s_mov_b32 s74, 65536
    s_waitcnt lgkmcnt(0)
    v_mfma_f32_16x16x32_bf16 v[128:131], a[128:131], a[160:163], v[128:131]
    s_waitcnt vmcnt(4)
    s_barrier
    v_mfma_f32_16x16x32_bf16 v[144:147], a[128:131], a[164:167], v[144:147]
    s_add_u32 m0, s21, 32768
    ds_read_b64_tr_b16 a[192:193], v22 offset:0
    v_mfma_f32_16x16x32_bf16 v[160:163], a[128:131], a[168:171], v[160:163]
    buffer_load_dwordx4 v12, s[8:11], s17 offen offset:0 lds
    s_add_u32 s28, s28, 16384
    v_mfma_f32_16x16x32_bf16 v[176:179], a[128:131], a[172:175], v[176:179]
    ds_read_b64_tr_b16 a[194:195], v22 offset:1024
    v_mfma_f32_16x16x32_bf16 v[192:195], a[128:131], a[176:179], v[192:195]
    buffer_load_dwordx4 v13, s[8:11], s17 offen offset:1024 lds
    s_and_b32 s28, s28, 65535
    v_mfma_f32_16x16x32_bf16 v[208:211], a[128:131], a[180:183], v[208:211]
    ds_read_b128 a[224:227], v21 offset:0
    v_mfma_f32_16x16x32_bf16 v[224:227], a[128:131], a[184:187], v[224:227]
    buffer_load_dwordx4 v14, s[8:11], s17 offen offset:2048 lds
    s_add_u32 s18, s18, 1
    v_mfma_f32_16x16x32_bf16 v[240:243], a[128:131], a[188:191], v[240:243]
    ds_read_b64_tr_b16 a[208:209], v22 offset:8192
    v_mfma_f32_16x16x32_bf16 a[112:115], a[144:147], a[188:191], a[112:115]
    buffer_load_dwordx4 v15, s[8:11], s17 offen offset:3072 lds
    v_mfma_f32_16x16x32_bf16 a[96:99], a[144:147], a[184:187], a[96:99]
    s_add_u32 m0, s23, 32768
    ds_read_b64_tr_b16 a[210:211], v22 offset:9216
    v_mfma_f32_16x16x32_bf16 a[80:83], a[144:147], a[180:183], a[80:83]
    s_add_u32 s17, s17, 229376
    buffer_load_dwordx4 v8, s[4:7], s16 offen offset:0 lds
    v_mfma_f32_16x16x32_bf16 a[64:67], a[144:147], a[176:179], a[64:67]
    ds_read_b128 a[228:231], v21 offset:2048
    v_mfma_f32_16x16x32_bf16 a[48:51], a[144:147], a[172:175], a[48:51]
    buffer_load_dwordx4 v9, s[4:7], s16 offen offset:1024 lds
    v_mfma_f32_16x16x32_bf16 a[32:35], a[144:147], a[168:171], a[32:35]
    ds_read_b64_tr_b16 a[196:197], v23 offset:0
    v_mfma_f32_16x16x32_bf16 a[16:19], a[144:147], a[164:167], a[16:19]
    buffer_load_dwordx4 v10, s[4:7], s16 offen offset:2048 lds
    v_mfma_f32_16x16x32_bf16 a[0:3], a[144:147], a[160:163], a[0:3]
    ds_read_b64_tr_b16 a[198:199], v23 offset:1024
    v_mfma_f32_16x16x32_bf16 v[132:135], a[132:135], a[160:163], v[132:135]
    buffer_load_dwordx4 v11, s[4:7], s16 offen offset:3072 lds
    v_mfma_f32_16x16x32_bf16 v[148:151], a[132:135], a[164:167], v[148:151]
    s_add_u32 m0, s23, 36864
    ds_read_b128 a[232:235], v21 offset:4096
    v_mfma_f32_16x16x32_bf16 v[164:167], a[132:135], a[168:171], v[164:167]
    s_add_u32 s16, s16, 128
    buffer_load_dwordx4 v8, s[4:7], s22 offen offset:0 lds
    v_mfma_f32_16x16x32_bf16 v[180:183], a[132:135], a[172:175], v[180:183]
    ds_read_b64_tr_b16 a[212:213], v23 offset:8192
    v_mfma_f32_16x16x32_bf16 v[196:199], a[132:135], a[176:179], v[196:199]
    buffer_load_dwordx4 v9, s[4:7], s22 offen offset:1024 lds
    v_mfma_f32_16x16x32_bf16 v[212:215], a[132:135], a[180:183], v[212:215]
    ds_read_b64_tr_b16 a[214:215], v23 offset:9216
    v_mfma_f32_16x16x32_bf16 v[228:231], a[132:135], a[184:187], v[228:231]
    buffer_load_dwordx4 v10, s[4:7], s22 offen offset:2048 lds
    v_mfma_f32_16x16x32_bf16 v[244:247], a[132:135], a[188:191], v[244:247]
    ds_read_b128 a[236:239], v21 offset:6144
    v_mfma_f32_16x16x32_bf16 a[116:119], a[148:151], a[188:191], a[116:119]
    buffer_load_dwordx4 v11, s[4:7], s22 offen offset:3072 lds
    v_mfma_f32_16x16x32_bf16 a[100:103], a[148:151], a[184:187], a[100:103]
    s_add_u32 m0, s21, 49152
    ds_read_b64_tr_b16 a[200:201], v24 offset:0
    v_mfma_f32_16x16x32_bf16 a[84:87], a[148:151], a[180:183], a[84:87]
    s_add_u32 s22, s22, 128
    buffer_load_dwordx4 v12, s[8:11], s17 offen offset:0 lds
    v_mfma_f32_16x16x32_bf16 a[68:71], a[148:151], a[176:179], a[68:71]
    ds_read_b64_tr_b16 a[202:203], v24 offset:1024
    v_mfma_f32_16x16x32_bf16 a[52:55], a[148:151], a[172:175], a[52:55]
    buffer_load_dwordx4 v13, s[8:11], s17 offen offset:1024 lds
    v_mfma_f32_16x16x32_bf16 a[36:39], a[148:151], a[168:171], a[36:39]
    ds_read_b128 a[240:243], v21 offset:8192
    v_mfma_f32_16x16x32_bf16 a[20:23], a[148:151], a[164:167], a[20:23]
    buffer_load_dwordx4 v14, s[8:11], s17 offen offset:2048 lds
    v_mfma_f32_16x16x32_bf16 a[4:7], a[148:151], a[160:163], a[4:7]
    ds_read_b64_tr_b16 a[216:217], v24 offset:8192
    v_mfma_f32_16x16x32_bf16 v[136:139], a[136:139], a[160:163], v[136:139]
    buffer_load_dwordx4 v15, s[8:11], s17 offen offset:3072 lds
    v_mfma_f32_16x16x32_bf16 v[152:155], a[136:139], a[164:167], v[152:155]
    ds_read_b64_tr_b16 a[218:219], v24 offset:9216
    v_mfma_f32_16x16x32_bf16 v[168:171], a[136:139], a[168:171], v[168:171]
    s_add_u32 s17, s17, 229376
    buffer_load_dword v28, v40, s[80:83], 0 offen
    v_mfma_f32_16x16x32_bf16 v[184:187], a[136:139], a[172:175], v[184:187]
    s_add_u32 m0, s23, 65536
    ds_read_b128 a[244:247], v21 offset:10240
    v_mfma_f32_16x16x32_bf16 v[200:203], a[136:139], a[176:179], v[200:203]
    buffer_load_dwordx4 v8, s[4:7], s16 offen offset:0 lds
    v_mfma_f32_16x16x32_bf16 v[216:219], a[136:139], a[180:183], v[216:219]
    ds_read_b64_tr_b16 a[204:205], v25 offset:0
    v_mfma_f32_16x16x32_bf16 v[232:235], a[136:139], a[184:187], v[232:235]
    buffer_load_dwordx4 v9, s[4:7], s16 offen offset:1024 lds
    v_mfma_f32_16x16x32_bf16 v[248:251], a[136:139], a[188:191], v[248:251]
    ds_read_b64_tr_b16 a[206:207], v25 offset:1024
    v_mfma_f32_16x16x32_bf16 a[120:123], a[152:155], a[188:191], a[120:123]
    buffer_load_dwordx4 v10, s[4:7], s16 offen offset:2048 lds
    v_mfma_f32_16x16x32_bf16 a[104:107], a[152:155], a[184:187], a[104:107]
    ds_read_b128 a[248:251], v21 offset:12288
    v_mfma_f32_16x16x32_bf16 a[88:91], a[152:155], a[180:183], a[88:91]
    buffer_load_dwordx4 v11, s[4:7], s16 offen offset:3072 lds
    v_mfma_f32_16x16x32_bf16 a[72:75], a[152:155], a[176:179], a[72:75]
    s_add_u32 m0, s23, 69632
    ds_read_b64_tr_b16 a[220:221], v25 offset:8192
    v_mfma_f32_16x16x32_bf16 a[56:59], a[152:155], a[172:175], a[56:59]
    s_add_u32 s16, s16, 128
    buffer_load_dwordx4 v8, s[4:7], s22 offen offset:0 lds
    v_mfma_f32_16x16x32_bf16 a[40:43], a[152:155], a[168:171], a[40:43]
    ds_read_b64_tr_b16 a[222:223], v25 offset:9216
    v_mfma_f32_16x16x32_bf16 a[24:27], a[152:155], a[164:167], a[24:27]
    buffer_load_dwordx4 v9, s[4:7], s22 offen offset:1024 lds
    v_mfma_f32_16x16x32_bf16 a[8:11], a[152:155], a[160:163], a[8:11]
    ds_read_b128 a[252:255], v21 offset:14336
    v_mfma_f32_16x16x32_bf16 v[140:143], a[140:143], a[160:163], v[140:143]
    buffer_load_dwordx4 v10, s[4:7], s22 offen offset:2048 lds
    v_mfma_f32_16x16x32_bf16 v[156:159], a[140:143], a[164:167], v[156:159]
    v_mfma_f32_16x16x32_bf16 v[172:175], a[140:143], a[168:171], v[172:175]
    buffer_load_dwordx4 v11, s[4:7], s22 offen offset:3072 lds
    v_add_u32 v22, s28, v17
    v_mfma_f32_16x16x32_bf16 v[188:191], a[140:143], a[172:175], v[188:191]
    v_mfma_f32_16x16x32_bf16 v[204:207], a[140:143], a[176:179], v[204:207]
    s_add_u32 s22, s22, 128
    buffer_store_dwordx2 v[44:45], v43, s[12:15], 0 offen sc1
    v_add_u32 v23, s28, v18
    v_mfma_f32_16x16x32_bf16 v[220:223], a[140:143], a[180:183], v[220:223]
    v_mfma_f32_16x16x32_bf16 v[236:239], a[140:143], a[184:187], v[236:239]
    v_add_u32 v24, s28, v19
    v_mfma_f32_16x16x32_bf16 v[252:255], a[140:143], a[188:191], v[252:255]
    v_mfma_f32_16x16x32_bf16 a[124:127], a[156:159], a[188:191], a[124:127]
    v_add_u32 v25, s28, v20
    v_mfma_f32_16x16x32_bf16 a[108:111], a[156:159], a[184:187], a[108:111]
    v_mfma_f32_16x16x32_bf16 a[92:95], a[156:159], a[180:183], a[92:95]
    v_add_u32 v21, s20, v16
    v_mfma_f32_16x16x32_bf16 a[76:79], a[156:159], a[176:179], a[76:79]
    v_mfma_f32_16x16x32_bf16 a[60:63], a[156:159], a[172:175], a[60:63]
    v_mfma_f32_16x16x32_bf16 a[44:47], a[156:159], a[168:171], a[44:47]
    v_mfma_f32_16x16x32_bf16 a[28:31], a[156:159], a[164:167], a[28:31]
    v_mfma_f32_16x16x32_bf16 a[12:15], a[156:159], a[160:163], a[12:15]
    s_waitcnt lgkmcnt(0)
    v_mfma_f32_16x16x32_bf16 v[128:131], a[192:195], a[224:227], v[128:131]
    s_waitcnt vmcnt(12)
    s_barrier
    s_add_u32 m0, s21, s29
    v_mfma_f32_16x16x32_bf16 v[144:147], a[192:195], a[228:231], v[144:147]
    ds_read_b64_tr_b16 a[128:129], v22 offset:0
    s_lshl_b32 s86, s24, 3
    v_mfma_f32_16x16x32_bf16 v[160:163], a[192:195], a[232:235], v[160:163]
    s_add_u32 s28, s28, 16384
    buffer_load_dwordx4 v12, s[8:11], s17 offen offset:0 lds
    s_lshr_b32 s31, s3, 1
    v_mfma_f32_16x16x32_bf16 v[176:179], a[192:195], a[236:239], v[176:179]
    ds_read_b64_tr_b16 a[130:131], v22 offset:1024
    v_mfma_f32_16x16x32_bf16 v[192:195], a[192:195], a[240:243], v[192:195]
    s_and_b32 s28, s28, 65535
    s_lshl_b32 s31, s31, 2
    v_mfma_f32_16x16x32_bf16 v[208:211], a[192:195], a[244:247], v[208:211]
    ds_read_b128 a[160:163], v21 offset:0
    s_add_u32 s86, s86, s31
    v_mfma_f32_16x16x32_bf16 v[224:227], a[192:195], a[248:251], v[224:227]
    s_add_u32 s18, s18, 1
    buffer_load_dwordx4 v13, s[8:11], s17 offen offset:1024 lds
    v_mfma_f32_16x16x32_bf16 v[240:243], a[192:195], a[252:255], v[240:243]
    ds_read_b64_tr_b16 a[144:145], v22 offset:8192
    s_lshl_b32 s68, s86, 11
    v_mfma_f32_16x16x32_bf16 a[112:115], a[208:211], a[252:255], a[112:115]
    s_mul_i32 s86, s86, 229376
    v_mfma_f32_16x16x32_bf16 a[96:99], a[208:211], a[248:251], a[96:99]
    ds_read_b64_tr_b16 a[146:147], v22 offset:9216
    v_mfma_f32_16x16x32_bf16 a[80:83], a[208:211], a[244:247], a[80:83]
    buffer_load_dwordx4 v14, s[8:11], s17 offen offset:2048 lds
    s_lshl_b32 s31, s25, 13
    v_mfma_f32_16x16x32_bf16 a[64:67], a[208:211], a[240:243], a[64:67]
    ds_read_b128 a[164:167], v21 offset:2048
    s_add_u32 s86, s86, s31
    v_mfma_f32_16x16x32_bf16 a[48:51], a[208:211], a[236:239], a[48:51]
    v_mfma_f32_16x16x32_bf16 a[32:35], a[208:211], a[232:235], a[32:35]
    ds_read_b64_tr_b16 a[132:133], v23 offset:0
    s_and_b32 s31, s3, 1
    v_mfma_f32_16x16x32_bf16 a[16:19], a[208:211], a[228:231], a[16:19]
    buffer_load_dwordx4 v15, s[8:11], s17 offen offset:3072 lds
    s_add_u32 m0, m0, 16384
    s_add_u32 s17, s17, s72
    s_lshl_b32 s31, s31, 12
    v_mfma_f32_16x16x32_bf16 a[0:3], a[208:211], a[224:227], a[0:3]
    ds_read_b64_tr_b16 a[134:135], v23 offset:1024
    v_mfma_f32_16x16x32_bf16 v[132:135], a[196:199], a[224:227], v[132:135]
    s_add_u32 s86, s86, s31
    v_mfma_f32_16x16x32_bf16 v[148:151], a[196:199], a[228:231], v[148:151]
    ds_read_b128 a[168:171], v21 offset:4096
    s_lshl_b32 s31, s25, 1
    v_mfma_f32_16x16x32_bf16 v[164:167], a[196:199], a[232:235], v[164:167]
    buffer_load_dwordx4 v12, s[8:11], s17 offen offset:0 lds
    v_mfma_f32_16x16x32_bf16 v[180:183], a[196:199], a[236:239], v[180:183]
    ds_read_b64_tr_b16 a[148:149], v23 offset:8192
    s_and_b32 s26, s3, 1
    v_mfma_f32_16x16x32_bf16 v[196:199], a[196:199], a[240:243], v[196:199]
    s_add_u32 s31, s31, s26
    v_mfma_f32_16x16x32_bf16 v[212:215], a[196:199], a[244:247], v[212:215]
    ds_read_b64_tr_b16 a[150:151], v23 offset:9216
    v_mfma_f32_16x16x32_bf16 v[228:231], a[196:199], a[248:251], v[228:231]
    buffer_load_dwordx4 v13, s[8:11], s17 offen offset:1024 lds
    s_lshl_b32 s31, s31, 7
    v_mfma_f32_16x16x32_bf16 v[244:247], a[196:199], a[252:255], v[244:247]
    ds_read_b128 a[172:175], v21 offset:6144
    s_add_u32 s68, s68, s31
    v_mfma_f32_16x16x32_bf16 a[116:119], a[212:215], a[252:255], a[116:119]
    v_mfma_f32_16x16x32_bf16 a[100:103], a[212:215], a[248:251], a[100:103]
    ds_read_b64_tr_b16 a[136:137], v24 offset:0
    s_add_u32 s68, s68, 26279936
    v_mfma_f32_16x16x32_bf16 a[84:87], a[212:215], a[244:247], a[84:87]
    buffer_load_dwordx4 v14, s[8:11], s17 offen offset:2048 lds
    s_mov_b32 s52, s42
    v_mfma_f32_16x16x32_bf16 a[68:71], a[212:215], a[240:243], a[68:71]
    ds_read_b64_tr_b16 a[138:139], v24 offset:1024
    v_mfma_f32_16x16x32_bf16 a[52:55], a[212:215], a[236:239], a[52:55]
    s_and_b32 s53, s43, 0xffff
    v_mfma_f32_16x16x32_bf16 a[36:39], a[212:215], a[232:235], a[36:39]
    ds_read_b128 a[176:179], v21 offset:8192
    s_mov_b32 s54, 4194304
    v_mfma_f32_16x16x32_bf16 a[20:23], a[212:215], a[228:231], a[20:23]
    buffer_load_dwordx4 v15, s[8:11], s17 offen offset:3072 lds
    s_add_u32 m0, s23, s19
    s_add_u32 s17, s17, s72
    v_mfma_f32_16x16x32_bf16 a[4:7], a[212:215], a[224:227], a[4:7]
    ds_read_b64_tr_b16 a[152:153], v24 offset:8192
    s_mov_b32 s55, 0x20000
    v_mfma_f32_16x16x32_bf16 v[136:139], a[200:203], a[224:227], v[136:139]
    v_mfma_f32_16x16x32_bf16 v[152:155], a[200:203], a[228:231], v[152:155]
    ds_read_b64_tr_b16 a[154:155], v24 offset:9216
    s_mov_b32 s32, s88
    v_mfma_f32_16x16x32_bf16 v[168:171], a[200:203], a[232:235], v[168:171]
    buffer_load_dwordx4 v8, s[4:7], s16 offen offset:0 lds
    s_xor_b32 s29, s29, 32768
    s_and_b32 s33, s89, 0xffff
    v_mfma_f32_16x16x32_bf16 v[184:187], a[200:203], a[236:239], v[184:187]
    ds_read_b128 a[180:183], v21 offset:10240
    v_mfma_f32_16x16x32_bf16 v[200:203], a[200:203], a[240:243], v[200:203]
    s_mov_b32 s34, 7340032
    v_mfma_f32_16x16x32_bf16 v[216:219], a[200:203], a[244:247], v[216:219]
    ds_read_b64_tr_b16 a[140:141], v25 offset:0
    s_mov_b32 s35, 0x20000
    v_mfma_f32_16x16x32_bf16 v[232:235], a[200:203], a[248:251], v[232:235]
    buffer_load_dwordx4 v9, s[4:7], s16 offen offset:1024 lds
    s_mov_b32 s19, s20
    v_mfma_f32_16x16x32_bf16 v[248:251], a[200:203], a[252:255], v[248:251]
    ds_read_b64_tr_b16 a[142:143], v25 offset:1024
    s_mul_i32 s27, s96, 1835008
    v_mfma_f32_16x16x32_bf16 a[120:123], a[216:219], a[252:255], a[120:123]
    s_lshl_b32 s26, s51, 8
    v_mfma_f32_16x16x32_bf16 a[104:107], a[216:219], a[248:251], a[104:107]
    ds_read_b128 a[184:187], v21 offset:12288
    v_mfma_f32_16x16x32_bf16 a[88:91], a[216:219], a[244:247], a[88:91]
    buffer_load_dwordx4 v10, s[4:7], s16 offen offset:2048 lds
    s_add_u32 s20, s20, 32768
    s_cmp_eq_u32 s20, 98304
    s_cselect_b32 s20, 0, s20
    s_add_u32 s27, s27, s26
    v_mfma_f32_16x16x32_bf16 a[72:75], a[216:219], a[240:243], a[72:75]
    ds_read_b64_tr_b16 a[156:157], v25 offset:8192
    v_lshrrev_b32 v3, 4, v1
    v_mfma_f32_16x16x32_bf16 a[56:59], a[216:219], a[236:239], a[56:59]
    v_mfma_f32_16x16x32_bf16 a[40:43], a[216:219], a[232:235], a[40:43]
    ds_read_b64_tr_b16 a[158:159], v25 offset:9216
    s_lshl_b32 s26, s3, 5
    v_mfma_f32_16x16x32_bf16 a[24:27], a[216:219], a[228:231], a[24:27]
    buffer_load_dwordx4 v11, s[4:7], s16 offen offset:3072 lds
    s_add_u32 m0, m0, 4096
    v_add_u32 v2, s26, v3
    v_mfma_f32_16x16x32_bf16 a[8:11], a[216:219], a[224:227], a[8:11]
    ds_read_b128 a[188:191], v21 offset:14336
    v_mfma_f32_16x16x32_bf16 v[140:143], a[204:207], a[224:227], v[140:143]
    v_lshlrev_b32 v2, 11, v2
    v_mfma_f32_16x16x32_bf16 v[156:159], a[204:207], a[228:231], v[156:159]
    buffer_load_dwordx4 v8, s[4:7], s22 offen offset:0 lds
    s_add_u32 s16, s16, s73
    v_add_u32 v2, s27, v2
    v_mfma_f32_16x16x32_bf16 v[172:175], a[204:207], a[232:235], v[172:175]
    v_add_u32 v22, s28, v17
    v_mfma_f32_16x16x32_bf16 v[188:191], a[204:207], a[236:239], v[188:191]
    v_lshlrev_b32 v3, 1, v3
    v_mfma_f32_16x16x32_bf16 v[204:207], a[204:207], a[240:243], v[204:207]
    v_add_u32 v23, s28, v18
    buffer_load_dwordx4 v9, s[4:7], s22 offen offset:1024 lds
    v_and_b32 v96, 15, v1
    v_mfma_f32_16x16x32_bf16 v[220:223], a[204:207], a[244:247], v[220:223]
    v_mfma_f32_16x16x32_bf16 v[236:239], a[204:207], a[248:251], v[236:239]
    v_add_u32 v24, s28, v19
    v_xor_b32 v3, v3, v96
    v_mfma_f32_16x16x32_bf16 v[252:255], a[204:207], a[252:255], v[252:255]
    buffer_load_dwordx4 v10, s[4:7], s22 offen offset:2048 lds
    v_lshl_add_u32 v96, v3, 4, v2
    v_mfma_f32_16x16x32_bf16 a[124:127], a[220:223], a[252:255], a[124:127]
    v_add_u32 v25, s28, v20
    v_mfma_f32_16x16x32_bf16 a[108:111], a[220:223], a[248:251], a[108:111]
    v_xor_b32 v3, 8, v3
    v_mfma_f32_16x16x32_bf16 a[92:95], a[220:223], a[244:247], a[92:95]
    v_add_u32 v21, s19, v33
    buffer_load_dwordx4 v11, s[4:7], s22 offen offset:3072 lds
    s_add_u32 s22, s16, s74
    v_lshl_add_u32 v97, v3, 4, v2
    v_mfma_f32_16x16x32_bf16 a[76:79], a[220:223], a[240:243], a[76:79]
    v_mfma_f32_16x16x32_bf16 a[60:63], a[220:223], a[236:239], a[60:63]
    v_add_u32 v98, 14336, v96
    v_mfma_f32_16x16x32_bf16 a[44:47], a[220:223], a[232:235], a[44:47]
    v_mfma_f32_16x16x32_bf16 a[28:31], a[220:223], a[228:231], a[28:31]
    buffer_load_dword v28, v27, s[80:83], s84 offen
    s_add_u32 s84, s84, s85
    v_mfma_f32_16x16x32_bf16 a[12:15], a[220:223], a[224:227], a[12:15]
    s_waitcnt lgkmcnt(0)
    v_mfma_f32_16x16x32_bf16 v[128:131], a[128:131], a[160:163], v[128:131]
    s_waitcnt vmcnt(24)
    s_barrier
    v_mfma_f32_16x16x32_bf16 v[144:147], a[128:131], a[164:167], v[144:147]
    ds_read_b64_tr_b16 a[192:193], v22 offset:0
    v_add_u32 v99, 21504, v97
    v_add_u32 v97, 7168, v97
    v_mfma_f32_16x16x32_bf16 v[160:163], a[128:131], a[168:171], v[160:163]
    s_add_u32 s28, s28, 16384
    v_lshrrev_b32 v3, 4, v1
    s_lshl_b32 s26, s3, 4
    v_mfma_f32_16x16x32_bf16 v[176:179], a[128:131], a[172:175], v[176:179]
    ds_read_b64_tr_b16 a[194:195], v22 offset:1024
    v_add_u32 v2, s26, v3
    v_lshlrev_b32 v2, 11, v2
    v_mfma_f32_16x16x32_bf16 v[192:195], a[128:131], a[176:179], v[192:195]
    s_and_b32 s28, s28, 65535
    v_add_u32 v2, s27, v2
    v_lshlrev_b32 v3, 1, v3
    v_mfma_f32_16x16x32_bf16 v[208:211], a[128:131], a[180:183], v[208:211]
    ds_read_b128 a[224:227], v21 offset:0
    v_and_b32 v100, 15, v1
    v_xor_b32 v3, v3, v100
    v_mfma_f32_16x16x32_bf16 v[224:227], a[128:131], a[184:187], v[224:227]
    s_add_u32 s18, s18, 1
    v_lshl_add_u32 v100, v3, 4, v2
    v_xor_b32 v3, 8, v3
    v_mfma_f32_16x16x32_bf16 v[240:243], a[128:131], a[188:191], v[240:243]
    ds_read_b64_tr_b16 a[208:209], v22 offset:8192
    v_lshl_add_u32 v101, v3, 4, v2
    v_add_u32 v102, 14336, v100
    v_mfma_f32_16x16x32_bf16 a[112:115], a[144:147], a[188:191], a[112:115]
    v_add_u32 v103, 21504, v101
    v_add_u32 v101, 7168, v101
    v_mfma_f32_16x16x32_bf16 a[96:99], a[144:147], a[184:187], a[96:99]
    ds_read_b64_tr_b16 a[210:211], v22 offset:9216
    s_lshl_b32 s27, s50, 2
    s_add_u32 s27, s27, s3
    v_mfma_f32_16x16x32_bf16 a[80:83], a[144:147], a[180:183], a[80:83]
    s_lshl_b32 s27, s27, 1
    s_mul_i32 s27, s27, 229376
    v_mfma_f32_16x16x32_bf16 a[64:67], a[144:147], a[176:179], a[64:67]
    ds_read_b128 a[228:231], v21 offset:2048
    s_mul_i32 s26, s96, 57344
    s_add_u32 s27, s27, s26
    v_mfma_f32_16x16x32_bf16 a[48:51], a[144:147], a[172:175], a[48:51]
    s_add_u32 s56, s48, s27
    s_addc_u32 s57, s49, 0
    v_mfma_f32_16x16x32_bf16 a[32:35], a[144:147], a[168:171], a[32:35]
    ds_read_b64_tr_b16 a[196:197], v23 offset:0
    s_and_b32 s57, s57, 0xffff
    s_mov_b32 s58, 286720
    v_mfma_f32_16x16x32_bf16 a[16:19], a[144:147], a[164:167], a[16:19]
    s_mov_b32 s59, 0x20000
    s_mov_b32 s45, s51
    v_mfma_f32_16x16x32_bf16 a[0:3], a[144:147], a[160:163], a[0:3]
    ds_read_b64_tr_b16 a[198:199], v23 offset:1024
    s_lshl_b32 s40, s45, 18
    s_lshr_b32 s79, s96, 1
    v_mfma_f32_16x16x32_bf16 v[132:135], a[132:135], a[160:163], v[132:135]
    s_mul_i32 s79, s79, 229376
    s_cmp_le_u32 s45, 0
    s_mov_b32 s41, 0
    s_cselect_b32 s41, 262144, s41
    v_mfma_f32_16x16x32_bf16 v[148:151], a[132:135], a[164:167], v[148:151]
    ds_read_b128 a[232:235], v21 offset:4096
    s_cmp_le_u32 s45, 1
    s_mov_b32 s42, 262144
    s_cselect_b32 s42, 524288, s42
    s_cmp_le_u32 s45, 2
    s_mov_b32 s43, 524288
    s_cselect_b32 s43, 786432, s43
    v_mfma_f32_16x16x32_bf16 v[164:167], a[132:135], a[168:171], v[164:167]
    s_cmp_le_u32 s45, 3
    s_mov_b32 s76, 786432
    s_cselect_b32 s76, 1048576, s76
    s_cmp_le_u32 s45, 4
    s_mov_b32 s77, 1048576
    s_cselect_b32 s77, 1310720, s77
    v_mfma_f32_16x16x32_bf16 v[180:183], a[132:135], a[172:175], v[180:183]
    ds_read_b64_tr_b16 a[212:213], v23 offset:8192
    s_cmp_le_u32 s45, 5
    s_mov_b32 s78, 1310720
    s_cselect_b32 s78, 1572864, s78
    v_lshlrev_b32 v104, 4, v1
    v_mfma_f32_16x16x32_bf16 v[196:199], a[132:135], a[176:179], v[196:199]
    v_mov_b32 v107, 1073741824
    v_lshrrev_b32 v3, 4, v1
    v_mfma_f32_16x16x32_bf16 v[212:215], a[132:135], a[180:183], v[212:215]
    ds_read_b64_tr_b16 a[214:215], v23 offset:9216
    v_lshrrev_b32 v4, 2, v1
    v_and_b32 v4, 3, v4
    v_mfma_f32_16x16x32_bf16 v[228:231], a[132:135], a[184:187], v[228:231]
    v_lshl_add_u32 v5, v3, 2, v4
    v_and_b32 v6, 7, v5
    v_mfma_f32_16x16x32_bf16 v[244:247], a[132:135], a[188:191], v[244:247]
    ds_read_b128 a[236:239], v21 offset:6144
    s_and_b32 s26, s96, 1
    s_lshl_b32 s26, s26, 2
    v_mfma_f32_16x16x32_bf16 a[116:119], a[148:151], a[188:191], a[116:119]
    v_xor_b32 v6, s26, v6
    v_lshlrev_b32 v5, 8, v5
    v_mfma_f32_16x16x32_bf16 a[100:103], a[148:151], a[184:187], a[100:103]
    ds_read_b64_tr_b16 a[200:201], v24 offset:0
    v_lshl_add_u32 v5, v6, 5, v5
    v_and_b32 v7, 3, v1
    v_mfma_f32_16x16x32_bf16 a[84:87], a[148:151], a[180:183], a[84:87]
    v_lshl_add_u32 v105, v7, 3, v5
    s_lshl_b32 s26, s50, 1
    v_mfma_f32_16x16x32_bf16 a[68:71], a[148:151], a[176:179], a[68:71]
    ds_read_b64_tr_b16 a[202:203], v24 offset:1024
    s_lshr_b32 s27, s3, 1
    s_add_u32 s26, s26, s27
    v_mfma_f32_16x16x32_bf16 a[52:55], a[148:151], a[172:175], a[52:55]
    s_lshl_b32 s26, s26, 13
    s_mul_i32 s44, s96, 1792
    v_mfma_f32_16x16x32_bf16 a[36:39], a[148:151], a[168:171], a[36:39]
    ds_read_b128 a[240:243], v21 offset:8192
    s_add_u32 s44, s44, s26
    s_add_u32 s44, s44, 26279936
    v_mfma_f32_16x16x32_bf16 a[20:23], a[148:151], a[164:167], a[20:23]
    v_lshlrev_b32 v108, 7, v1
    v_and_b32 v110, 31, v1
    v_mfma_f32_16x16x32_bf16 a[4:7], a[148:151], a[160:163], a[4:7]
    ds_read_b64_tr_b16 a[216:217], v24 offset:8192
    v_lshlrev_b32 v110, 7, v110
    v_mfma_f32_16x16x32_bf16 v[136:139], a[136:139], a[160:163], v[136:139]
    v_add_u32 v110, 26247168, v110
    v_lshrrev_b32 v2, 1, v1
    v_mfma_f32_16x16x32_bf16 v[152:155], a[136:139], a[164:167], v[152:155]
    ds_read_b64_tr_b16 a[218:219], v24 offset:9216
    v_cmp_le_u32 vcc, s45, v2
    v_add_u32 v3, 1, v2
    v_mfma_f32_16x16x32_bf16 v[168:171], a[136:139], a[168:171], v[168:171]
    v_and_b32 v4, 1, v1
    v_cndmask_b32 v2, v2, v3, vcc
    v_mfma_f32_16x16x32_bf16 v[184:187], a[136:139], a[172:175], v[184:187]
    ds_read_b128 a[244:247], v21 offset:10240
    v_cmp_gt_u32 vcc, 12, v1
    v_lshl_add_u32 v2, v2, 1, v4
    v_mfma_f32_16x16x32_bf16 v[200:203], a[136:139], a[176:179], v[200:203]
    v_lshlrev_b32 v2, 7, v2
    v_cndmask_b32 v109, v107, v2, vcc
    v_mfma_f32_16x16x32_bf16 v[216:219], a[136:139], a[180:183], v[216:219]
    ds_read_b64_tr_b16 a[204:205], v25 offset:0
    s_lshl_b32 s70, s3, 13
    s_add_u32 s70, s70, 26607616
    v_mfma_f32_16x16x32_bf16 v[232:235], a[136:139], a[184:187], v[232:235]
    s_cmp_eq_u32 s2, 0
    s_cselect_b32 s70, s70, 1073741824
    s_cselect_b64 s[60:61], -1, 0
    s_lshl_b32 s26, s2, 2
    v_mfma_f32_16x16x32_bf16 v[248:251], a[136:139], a[188:191], v[248:251]
    ds_read_b64_tr_b16 a[206:207], v25 offset:1024
    s_add_u32 s26, s26, s3
    s_mul_i32 s71, s26, 12288
    v_mfma_f32_16x16x32_bf16 a[120:123], a[152:155], a[188:191], a[120:123]
    s_add_u32 s71, s71, 27262976
    s_lshl_b32 s69, s26, 7
    v_mfma_f32_16x16x32_bf16 a[104:107], a[152:155], a[184:187], a[104:107]
    ds_read_b128 a[248:251], v21 offset:12288
    s_add_u32 s69, s69, 26476544
    v_xor_b32 v120, 0, v105
    v_mfma_f32_16x16x32_bf16 a[88:91], a[152:155], a[180:183], a[88:91]
    v_xor_b32 v121, 32, v105
    v_xor_b32 v122, 64, v105
    v_mfma_f32_16x16x32_bf16 a[72:75], a[152:155], a[176:179], a[72:75]
    ds_read_b64_tr_b16 a[220:221], v25 offset:8192
    v_xor_b32 v123, 96, v105
    v_xor_b32 v124, 128, v105
    v_mfma_f32_16x16x32_bf16 a[56:59], a[152:155], a[172:175], a[56:59]
    v_xor_b32 v125, 160, v105
    v_xor_b32 v126, 192, v105
    v_mfma_f32_16x16x32_bf16 a[40:43], a[152:155], a[168:171], a[40:43]
    ds_read_b64_tr_b16 a[222:223], v25 offset:9216
    v_xor_b32 v127, 224, v105
    s_lshl_b32 s64, s51, 1
    v_mfma_f32_16x16x32_bf16 a[24:27], a[152:155], a[164:167], a[24:27]
    s_and_b32 s26, s96, 1
    s_add_u32 s64, s64, s26
    v_mfma_f32_16x16x32_bf16 a[8:11], a[152:155], a[160:163], a[8:11]
    ds_read_b128 a[252:255], v21 offset:14336
    s_lshl_b32 s26, s50, 8
    s_lshl_b32 s27, s3, 6
    v_mfma_f32_16x16x32_bf16 v[140:143], a[140:143], a[160:163], v[140:143]
    s_add_u32 s27, s26, s27
    s_lshr_b32 s26, s96, 1
    v_mfma_f32_16x16x32_bf16 v[156:159], a[140:143], a[164:167], v[156:159]
    s_lshl_b32 s26, s26, 5
    s_add_u32 s27, s27, s26
    v_mfma_f32_16x16x32_bf16 v[172:175], a[140:143], a[168:171], v[172:175]
    v_add_u32 v22, s28, v17
    v_and_b32 v2, 15, v1
    v_add_u32 v2, s27, v2
    v_mfma_f32_16x16x32_bf16 v[188:191], a[140:143], a[172:175], v[188:191]
    v_lshlrev_b32 v119, 4, v2
    v_add_u32 v119, 25296896, v119
    v_mfma_f32_16x16x32_bf16 v[204:207], a[140:143], a[176:179], v[204:207]
    v_add_u32 v23, s28, v18
    v_lshlrev_b32 v2, 11, v2
    v_lshrrev_b32 v3, 4, v1
    v_mfma_f32_16x16x32_bf16 v[220:223], a[140:143], a[180:183], v[220:223]
    v_and_b32 v4, 1, v3
    v_lshl_add_u32 v2, v4, 5, v2
    v_mfma_f32_16x16x32_bf16 v[236:239], a[140:143], a[184:187], v[236:239]
    v_add_u32 v24, s28, v19
    v_lshrrev_b32 v4, 1, v3
    v_lshl_add_u32 v2, v4, 4, v2
    v_mfma_f32_16x16x32_bf16 v[252:255], a[140:143], a[188:191], v[252:255]
    s_lshl_b32 s26, s64, 7
    v_add_u32 v112, s26, v2
    v_mfma_f32_16x16x32_bf16 a[124:127], a[156:159], a[188:191], a[124:127]
    v_add_u32 v25, s28, v20
    v_add_u32 v113, 32768, v112
    s_lshl_b32 s26, s64, 1
    v_mfma_f32_16x16x32_bf16 a[108:111], a[156:159], a[184:187], a[108:111]
    s_sub_u32 s65, 30, s26
    s_cmp_ge_u32 s64, 8
    s_cselect_b64 s[46:47], -1, 0
    s_cselect_b32 s65, s65, s26
    v_mfma_f32_16x16x32_bf16 a[92:95], a[156:159], a[180:183], a[92:95]
    v_add_u32 v21, s20, v16
    s_mul_i32 s65, s65, 33792
    s_add_u32 s65, s65, 21168128
    v_mfma_f32_16x16x32_bf16 a[76:79], a[156:159], a[176:179], a[76:79]
    s_mov_b32 s26, 574464
    v_lshrrev_b32 v2, 2, v1
    v_mfma_f32_16x16x32_bf16 a[60:63], a[156:159], a[172:175], a[60:63]
    v_lshl_add_u32 v2, v2, 1, 0
    v_and_b32 v3, 3, v1
    v_mfma_f32_16x16x32_bf16 a[44:47], a[156:159], a[168:171], a[44:47]
    v_lshlrev_b32 v3, 4, v3
    v_mfma_f32_16x16x32_bf16 a[28:31], a[156:159], a[164:167], a[28:31]
    v_mfma_f32_16x16x32_bf16 a[12:15], a[156:159], a[160:163], a[12:15]
    s_waitcnt lgkmcnt(0)
    v_mfma_f32_16x16x32_bf16 v[128:131], a[192:195], a[224:227], v[128:131]
    s_waitcnt vmcnt(12)
    s_barrier
    s_add_u32 m0, s21, s29
    v_mfma_f32_16x16x32_bf16 v[144:147], a[192:195], a[228:231], v[144:147]
    ds_read_b64_tr_b16 a[128:129], v22 offset:0
    v_add_u32 v3, 0, v3
    v_add_u32 v2, s27, v2
    v_mfma_f32_16x16x32_bf16 v[160:163], a[192:195], a[232:235], v[160:163]
    s_add_u32 s28, s28, 16384
    buffer_load_dwordx4 v12, s[8:11], s17 offen offset:0 lds
    v_sub_u32 v4, 2048, v2
    v_mfma_f32_16x16x32_bf16 v[176:179], a[192:195], a[236:239], v[176:179]
    ds_read_b64_tr_b16 a[130:131], v22 offset:1024
    v_min_u32 v4, v4, v2
    v_mfma_f32_16x16x32_bf16 v[192:195], a[192:195], a[240:243], v[192:195]
    s_and_b32 s28, s28, 65535
    v_cmp_lt_u32 vcc, 1024, v2
    v_and_b32 v5, 1, v4
    v_mfma_f32_16x16x32_bf16 v[208:211], a[192:195], a[244:247], v[208:211]
    ds_read_b128 a[160:163], v21 offset:0
    v_mul_lo_u32 v5, v5, s26
    v_mfma_f32_16x16x32_bf16 v[224:227], a[192:195], a[248:251], v[224:227]
    s_add_u32 s18, s18, 1
    buffer_load_dwordx4 v13, s[8:11], s17 offen offset:1024 lds
    v_lshrrev_b32 v4, 1, v4
    v_mfma_f32_16x16x32_bf16 v[240:243], a[192:195], a[252:255], v[240:243]
    ds_read_b64_tr_b16 a[144:145], v22 offset:8192
    v_lshl_add_u32 v4, v4, 6, v5
    v_mfma_f32_16x16x32_bf16 a[112:115], a[208:211], a[252:255], a[112:115]
    s_xor_b64 vcc, vcc, s[46:47]
    v_add3_u32 v4, v4, v3, s65
    v_mfma_f32_16x16x32_bf16 a[96:99], a[208:211], a[248:251], a[96:99]
    ds_read_b64_tr_b16 a[146:147], v22 offset:9216
    v_add_u32 v5, 2097152, v4
    v_mfma_f32_16x16x32_bf16 a[80:83], a[208:211], a[244:247], a[80:83]
    buffer_load_dwordx4 v14, s[8:11], s17 offen offset:2048 lds
    v_cndmask_b32 v114, v4, v5, vcc
    v_mfma_f32_16x16x32_bf16 a[64:67], a[208:211], a[240:243], a[64:67]
    ds_read_b128 a[164:167], v21 offset:2048
    v_lshrrev_b32 v2, 2, v1
    v_lshl_add_u32 v2, v2, 1, 1
    v_mfma_f32_16x16x32_bf16 a[48:51], a[208:211], a[236:239], a[48:51]
    v_and_b32 v3, 3, v1
    v_mfma_f32_16x16x32_bf16 a[32:35], a[208:211], a[232:235], a[32:35]
    ds_read_b64_tr_b16 a[132:133], v23 offset:0
    v_lshlrev_b32 v3, 4, v3
    v_mfma_f32_16x16x32_bf16 a[16:19], a[208:211], a[228:231], a[16:19]
    buffer_load_dwordx4 v15, s[8:11], s17 offen offset:3072 lds
    s_add_u32 m0, m0, 16384
    s_add_u32 s17, s17, s72
    v_add_u32 v3, 0, v3
    v_mfma_f32_16x16x32_bf16 a[0:3], a[208:211], a[224:227], a[0:3]
    ds_read_b64_tr_b16 a[134:135], v23 offset:1024
    v_add_u32 v2, s27, v2
    v_sub_u32 v4, 2048, v2
    v_mfma_f32_16x16x32_bf16 v[132:135], a[196:199], a[224:227], v[132:135]
    v_min_u32 v4, v4, v2
    v_mfma_f32_16x16x32_bf16 v[148:151], a[196:199], a[228:231], v[148:151]
    ds_read_b128 a[168:171], v21 offset:4096
    v_cmp_lt_u32 vcc, 1024, v2
    v_mfma_f32_16x16x32_bf16 v[164:167], a[196:199], a[232:235], v[164:167]
    buffer_load_dwordx4 v12, s[8:11], s17 offen offset:0 lds
    v_and_b32 v5, 1, v4
    v_mul_lo_u32 v5, v5, s26
    v_mfma_f32_16x16x32_bf16 v[180:183], a[196:199], a[236:239], v[180:183]
    ds_read_b64_tr_b16 a[148:149], v23 offset:8192
    v_lshrrev_b32 v4, 1, v4
    v_mfma_f32_16x16x32_bf16 v[196:199], a[196:199], a[240:243], v[196:199]
    v_lshl_add_u32 v4, v4, 6, v5
    v_mfma_f32_16x16x32_bf16 v[212:215], a[196:199], a[244:247], v[212:215]
    ds_read_b64_tr_b16 a[150:151], v23 offset:9216
    s_xor_b64 vcc, vcc, s[46:47]
    v_mfma_f32_16x16x32_bf16 v[228:231], a[196:199], a[248:251], v[228:231]
    buffer_load_dwordx4 v13, s[8:11], s17 offen offset:1024 lds
    v_add3_u32 v4, v4, v3, s65
    v_add_u32 v5, 2097152, v4
    v_mfma_f32_16x16x32_bf16 v[244:247], a[196:199], a[252:255], v[244:247]
    ds_read_b128 a[172:175], v21 offset:6144
    v_cndmask_b32 v115, v4, v5, vcc
    v_mfma_f32_16x16x32_bf16 a[116:119], a[212:215], a[252:255], a[116:119]
    v_lshrrev_b32 v2, 2, v1
    v_mfma_f32_16x16x32_bf16 a[100:103], a[212:215], a[248:251], a[100:103]
    ds_read_b64_tr_b16 a[136:137], v24 offset:0
    v_lshl_add_u32 v2, v2, 1, 0
    v_mfma_f32_16x16x32_bf16 a[84:87], a[212:215], a[244:247], a[84:87]
    buffer_load_dwordx4 v14, s[8:11], s17 offen offset:2048 lds
    v_and_b32 v3, 3, v1
    v_lshlrev_b32 v3, 4, v3
    v_mfma_f32_16x16x32_bf16 a[68:71], a[212:215], a[240:243], a[68:71]
    ds_read_b64_tr_b16 a[138:139], v24 offset:1024
    v_add_u32 v3, 33792, v3
    v_mfma_f32_16x16x32_bf16 a[52:55], a[212:215], a[236:239], a[52:55]
    v_add_u32 v2, s27, v2
    v_mfma_f32_16x16x32_bf16 a[36:39], a[212:215], a[232:235], a[36:39]
    ds_read_b128 a[176:179], v21 offset:8192
    v_sub_u32 v4, 2048, v2
    v_min_u32 v4, v4, v2
    v_mfma_f32_16x16x32_bf16 a[20:23], a[212:215], a[228:231], a[20:23]
    buffer_load_dwordx4 v15, s[8:11], s17 offen offset:3072 lds
    s_add_u32 m0, s23, s19
    s_add_u32 s17, s17, s72
    v_cmp_lt_u32 vcc, 1024, v2
    v_mfma_f32_16x16x32_bf16 a[4:7], a[212:215], a[224:227], a[4:7]
    ds_read_b64_tr_b16 a[152:153], v24 offset:8192
    v_and_b32 v5, 1, v4
    v_mfma_f32_16x16x32_bf16 v[136:139], a[200:203], a[224:227], v[136:139]
    v_mul_lo_u32 v5, v5, s26
    v_mfma_f32_16x16x32_bf16 v[152:155], a[200:203], a[228:231], v[152:155]
    ds_read_b64_tr_b16 a[154:155], v24 offset:9216
    v_lshrrev_b32 v4, 1, v4
    v_lshl_add_u32 v4, v4, 6, v5
    v_mfma_f32_16x16x32_bf16 v[168:171], a[200:203], a[232:235], v[168:171]
    buffer_load_dwordx4 v8, s[4:7], s16 offen offset:0 lds
    s_xor_b32 s29, s29, 32768
    s_xor_b64 vcc, vcc, s[46:47]
    v_mfma_f32_16x16x32_bf16 v[184:187], a[200:203], a[236:239], v[184:187]
    ds_read_b128 a[180:183], v21 offset:10240
    v_add3_u32 v4, v4, v3, s65
    v_mfma_f32_16x16x32_bf16 v[200:203], a[200:203], a[240:243], v[200:203]
    v_add_u32 v5, 2097152, v4
    v_cndmask_b32 v116, v4, v5, vcc
    v_mfma_f32_16x16x32_bf16 v[216:219], a[200:203], a[244:247], v[216:219]
    ds_read_b64_tr_b16 a[140:141], v25 offset:0
    v_lshrrev_b32 v2, 2, v1
    v_mfma_f32_16x16x32_bf16 v[232:235], a[200:203], a[248:251], v[232:235]
    buffer_load_dwordx4 v9, s[4:7], s16 offen offset:1024 lds
    s_mov_b32 s19, s20
    v_lshl_add_u32 v2, v2, 1, 1
    v_mfma_f32_16x16x32_bf16 v[248:251], a[200:203], a[252:255], v[248:251]
    ds_read_b64_tr_b16 a[142:143], v25 offset:1024
    v_and_b32 v3, 3, v1
    v_mfma_f32_16x16x32_bf16 a[120:123], a[216:219], a[252:255], a[120:123]
    v_lshlrev_b32 v3, 4, v3
    v_add_u32 v3, 33792, v3
    v_mfma_f32_16x16x32_bf16 a[104:107], a[216:219], a[248:251], a[104:107]
    ds_read_b128 a[184:187], v21 offset:12288
    v_add_u32 v2, s27, v2
    v_mfma_f32_16x16x32_bf16 a[88:91], a[216:219], a[244:247], a[88:91]
    buffer_load_dwordx4 v10, s[4:7], s16 offen offset:2048 lds
    s_add_u32 s20, s20, 32768
    s_cmp_eq_u32 s20, 98304
    s_cselect_b32 s20, 0, s20
    v_sub_u32 v4, 2048, v2
    v_mfma_f32_16x16x32_bf16 a[72:75], a[216:219], a[240:243], a[72:75]
    ds_read_b64_tr_b16 a[156:157], v25 offset:8192
    v_min_u32 v4, v4, v2
    v_mfma_f32_16x16x32_bf16 a[56:59], a[216:219], a[236:239], a[56:59]
    v_cmp_lt_u32 vcc, 1024, v2
    v_and_b32 v5, 1, v4
    v_mfma_f32_16x16x32_bf16 a[40:43], a[216:219], a[232:235], a[40:43]
    ds_read_b64_tr_b16 a[158:159], v25 offset:9216
    v_mul_lo_u32 v5, v5, s26
    v_mfma_f32_16x16x32_bf16 a[24:27], a[216:219], a[228:231], a[24:27]
    buffer_load_dwordx4 v11, s[4:7], s16 offen offset:3072 lds
    s_add_u32 m0, m0, 4096
    v_lshrrev_b32 v4, 1, v4
    v_mfma_f32_16x16x32_bf16 a[8:11], a[216:219], a[224:227], a[8:11]
    ds_read_b128 a[188:191], v21 offset:14336
    v_lshl_add_u32 v4, v4, 6, v5
    s_xor_b64 vcc, vcc, s[46:47]
    v_mfma_f32_16x16x32_bf16 v[140:143], a[204:207], a[224:227], v[140:143]
    v_add3_u32 v4, v4, v3, s65
    v_mfma_f32_16x16x32_bf16 v[156:159], a[204:207], a[228:231], v[156:159]
    buffer_load_dwordx4 v8, s[4:7], s22 offen offset:0 lds
    s_add_u32 s16, s16, s73
    v_add_u32 v5, 2097152, v4
    v_mfma_f32_16x16x32_bf16 v[172:175], a[204:207], a[232:235], v[172:175]
    v_add_u32 v22, s28, v17
    v_cndmask_b32 v117, v4, v5, vcc
    v_mfma_f32_16x16x32_bf16 v[188:191], a[204:207], a[236:239], v[188:191]
    v_and_b32 v2, 31, v1
    v_mov_b32 v3, 67584
    v_mfma_f32_16x16x32_bf16 v[204:207], a[204:207], a[240:243], v[204:207]
    v_add_u32 v23, s28, v18
    buffer_load_dwordx4 v9, s[4:7], s22 offen offset:1024 lds
    v_add_u32 v2, s27, v2
    v_mfma_f32_16x16x32_bf16 v[220:223], a[204:207], a[244:247], v[220:223]
    v_sub_u32 v4, 2048, v2
    v_mfma_f32_16x16x32_bf16 v[236:239], a[204:207], a[248:251], v[236:239]
    v_add_u32 v24, s28, v19
    v_min_u32 v4, v4, v2
    v_cmp_lt_u32 vcc, 1024, v2
    v_mfma_f32_16x16x32_bf16 v[252:255], a[204:207], a[252:255], v[252:255]
    buffer_load_dwordx4 v10, s[4:7], s22 offen offset:2048 lds
    v_and_b32 v5, 1, v4
    v_mfma_f32_16x16x32_bf16 a[124:127], a[220:223], a[252:255], a[124:127]
    v_add_u32 v25, s28, v20
    v_mul_lo_u32 v5, v5, s26
    v_mfma_f32_16x16x32_bf16 a[108:111], a[220:223], a[248:251], a[108:111]
    v_lshrrev_b32 v4, 1, v4
    v_mfma_f32_16x16x32_bf16 a[92:95], a[220:223], a[244:247], a[92:95]
    v_add_u32 v21, s19, v33
    buffer_load_dwordx4 v11, s[4:7], s22 offen offset:3072 lds
    s_add_u32 s22, s16, s74
    v_lshl_add_u32 v4, v4, 6, v5
    s_xor_b64 vcc, vcc, s[46:47]
    v_mfma_f32_16x16x32_bf16 a[76:79], a[220:223], a[240:243], a[76:79]
    v_add3_u32 v4, v4, v3, s65
    v_mfma_f32_16x16x32_bf16 a[60:63], a[220:223], a[236:239], a[60:63]
    v_add_u32 v5, 2097152, v4
    v_mfma_f32_16x16x32_bf16 a[44:47], a[220:223], a[232:235], a[44:47]
    v_cndmask_b32 v118, v4, v5, vcc
    v_mfma_f32_16x16x32_bf16 a[28:31], a[220:223], a[228:231], a[28:31]
    buffer_load_dword v28, v27, s[80:83], s84 offen
    s_add_u32 s84, s84, s85
    buffer_load_dword v28, v34, s[36:39], 0 offen
    v_mfma_f32_16x16x32_bf16 a[12:15], a[220:223], a[224:227], a[12:15]
    .p2align 6
L_g1_loop:
    s_waitcnt lgkmcnt(0)
    v_mfma_f32_16x16x32_bf16 v[128:131], a[128:131], a[160:163], v[128:131]
    s_waitcnt vmcnt(24)
    s_barrier
    v_mfma_f32_16x16x32_bf16 v[144:147], a[128:131], a[164:167], v[144:147]
    ds_read_b64_tr_b16 a[192:193], v22 offset:0
    v_mfma_f32_16x16x32_bf16 v[160:163], a[128:131], a[168:171], v[160:163]
    s_add_u32 s28, s28, 16384
    v_mfma_f32_16x16x32_bf16 v[176:179], a[128:131], a[172:175], v[176:179]
    ds_read_b64_tr_b16 a[194:195], v22 offset:1024
    v_mfma_f32_16x16x32_bf16 v[192:195], a[128:131], a[176:179], v[192:195]
    s_and_b32 s28, s28, 65535
    v_mfma_f32_16x16x32_bf16 v[208:211], a[128:131], a[180:183], v[208:211]
    ds_read_b128 a[224:227], v21 offset:0
    v_mfma_f32_16x16x32_bf16 v[224:227], a[128:131], a[184:187], v[224:227]
    s_add_u32 s18, s18, 1
    v_mfma_f32_16x16x32_bf16 v[240:243], a[128:131], a[188:191], v[240:243]
    ds_read_b64_tr_b16 a[208:209], v22 offset:8192
    v_mfma_f32_16x16x32_bf16 a[112:115], a[144:147], a[188:191], a[112:115]
    v_mfma_f32_16x16x32_bf16 a[96:99], a[144:147], a[184:187], a[96:99]
    ds_read_b64_tr_b16 a[210:211], v22 offset:9216
    v_mfma_f32_16x16x32_bf16 a[80:83], a[144:147], a[180:183], a[80:83]
    v_mfma_f32_16x16x32_bf16 a[64:67], a[144:147], a[176:179], a[64:67]
    ds_read_b128 a[228:231], v21 offset:2048
    v_mfma_f32_16x16x32_bf16 a[48:51], a[144:147], a[172:175], a[48:51]
    v_mfma_f32_16x16x32_bf16 a[32:35], a[144:147], a[168:171], a[32:35]
    ds_read_b64_tr_b16 a[196:197], v23 offset:0
    v_mfma_f32_16x16x32_bf16 a[16:19], a[144:147], a[164:167], a[16:19]
    v_mfma_f32_16x16x32_bf16 a[0:3], a[144:147], a[160:163], a[0:3]
    ds_read_b64_tr_b16 a[198:199], v23 offset:1024
    v_mfma_f32_16x16x32_bf16 v[132:135], a[132:135], a[160:163], v[132:135]
    v_mfma_f32_16x16x32_bf16 v[148:151], a[132:135], a[164:167], v[148:151]
    ds_read_b128 a[232:235], v21 offset:4096
    v_mfma_f32_16x16x32_bf16 v[164:167], a[132:135], a[168:171], v[164:167]
    v_mfma_f32_16x16x32_bf16 v[180:183], a[132:135], a[172:175], v[180:183]
    ds_read_b64_tr_b16 a[212:213], v23 offset:8192
    v_mfma_f32_16x16x32_bf16 v[196:199], a[132:135], a[176:179], v[196:199]
    v_mfma_f32_16x16x32_bf16 v[212:215], a[132:135], a[180:183], v[212:215]
    ds_read_b64_tr_b16 a[214:215], v23 offset:9216
    v_mfma_f32_16x16x32_bf16 v[228:231], a[132:135], a[184:187], v[228:231]
    v_mfma_f32_16x16x32_bf16 v[244:247], a[132:135], a[188:191], v[244:247]
    ds_read_b128 a[236:239], v21 offset:6144
    v_mfma_f32_16x16x32_bf16 a[116:119], a[148:151], a[188:191], a[116:119]
    v_mfma_f32_16x16x32_bf16 a[100:103], a[148:151], a[184:187], a[100:103]
    ds_read_b64_tr_b16 a[200:201], v24 offset:0
    v_mfma_f32_16x16x32_bf16 a[84:87], a[148:151], a[180:183], a[84:87]
    v_mfma_f32_16x16x32_bf16 a[68:71], a[148:151], a[176:179], a[68:71]
    ds_read_b64_tr_b16 a[202:203], v24 offset:1024
    v_mfma_f32_16x16x32_bf16 a[52:55], a[148:151], a[172:175], a[52:55]
    v_mfma_f32_16x16x32_bf16 a[36:39], a[148:151], a[168:171], a[36:39]
    ds_read_b128 a[240:243], v21 offset:8192
    v_mfma_f32_16x16x32_bf16 a[20:23], a[148:151], a[164:167], a[20:23]
    v_mfma_f32_16x16x32_bf16 a[4:7], a[148:151], a[160:163], a[4:7]
    ds_read_b64_tr_b16 a[216:217], v24 offset:8192
    v_mfma_f32_16x16x32_bf16 v[136:139], a[136:139], a[160:163], v[136:139]
    v_mfma_f32_16x16x32_bf16 v[152:155], a[136:139], a[164:167], v[152:155]
    ds_read_b64_tr_b16 a[218:219], v24 offset:9216
    v_mfma_f32_16x16x32_bf16 v[168:171], a[136:139], a[168:171], v[168:171]
    v_mfma_f32_16x16x32_bf16 v[184:187], a[136:139], a[172:175], v[184:187]
    ds_read_b128 a[244:247], v21 offset:10240
    v_mfma_f32_16x16x32_bf16 v[200:203], a[136:139], a[176:179], v[200:203]
    v_mfma_f32_16x16x32_bf16 v[216:219], a[136:139], a[180:183], v[216:219]
    ds_read_b64_tr_b16 a[204:205], v25 offset:0
    v_mfma_f32_16x16x32_bf16 v[232:235], a[136:139], a[184:187], v[232:235]
    v_mfma_f32_16x16x32_bf16 v[248:251], a[136:139], a[188:191], v[248:251]
    ds_read_b64_tr_b16 a[206:207], v25 offset:1024
    v_mfma_f32_16x16x32_bf16 a[120:123], a[152:155], a[188:191], a[120:123]
    v_mfma_f32_16x16x32_bf16 a[104:107], a[152:155], a[184:187], a[104:107]
    ds_read_b128 a[248:251], v21 offset:12288
    v_mfma_f32_16x16x32_bf16 a[88:91], a[152:155], a[180:183], a[88:91]
    v_mfma_f32_16x16x32_bf16 a[72:75], a[152:155], a[176:179], a[72:75]
    ds_read_b64_tr_b16 a[220:221], v25 offset:8192
    v_mfma_f32_16x16x32_bf16 a[56:59], a[152:155], a[172:175], a[56:59]
    v_mfma_f32_16x16x32_bf16 a[40:43], a[152:155], a[168:171], a[40:43]
    ds_read_b64_tr_b16 a[222:223], v25 offset:9216
    v_mfma_f32_16x16x32_bf16 a[24:27], a[152:155], a[164:167], a[24:27]
    v_mfma_f32_16x16x32_bf16 a[8:11], a[152:155], a[160:163], a[8:11]
    ds_read_b128 a[252:255], v21 offset:14336
    v_mfma_f32_16x16x32_bf16 v[140:143], a[140:143], a[160:163], v[140:143]
    v_mfma_f32_16x16x32_bf16 v[156:159], a[140:143], a[164:167], v[156:159]
    v_mfma_f32_16x16x32_bf16 v[172:175], a[140:143], a[168:171], v[172:175]
    v_add_u32 v22, s28, v17
    v_mfma_f32_16x16x32_bf16 v[188:191], a[140:143], a[172:175], v[188:191]
    v_mfma_f32_16x16x32_bf16 v[204:207], a[140:143], a[176:179], v[204:207]
    v_add_u32 v23, s28, v18
    v_mfma_f32_16x16x32_bf16 v[220:223], a[140:143], a[180:183], v[220:223]
    v_mfma_f32_16x16x32_bf16 v[236:239], a[140:143], a[184:187], v[236:239]
    v_add_u32 v24, s28, v19
    v_mfma_f32_16x16x32_bf16 v[252:255], a[140:143], a[188:191], v[252:255]
    v_mfma_f32_16x16x32_bf16 a[124:127], a[156:159], a[188:191], a[124:127]
    v_add_u32 v25, s28, v20
    v_mfma_f32_16x16x32_bf16 a[108:111], a[156:159], a[184:187], a[108:111]
    v_mfma_f32_16x16x32_bf16 a[92:95], a[156:159], a[180:183], a[92:95]
    v_add_u32 v21, s20, v16
    v_mfma_f32_16x16x32_bf16 a[76:79], a[156:159], a[176:179], a[76:79]
    v_mfma_f32_16x16x32_bf16 a[60:63], a[156:159], a[172:175], a[60:63]
    v_mfma_f32_16x16x32_bf16 a[44:47], a[156:159], a[168:171], a[44:47]
    v_mfma_f32_16x16x32_bf16 a[28:31], a[156:159], a[164:167], a[28:31]
    v_mfma_f32_16x16x32_bf16 a[12:15], a[156:159], a[160:163], a[12:15]
    s_waitcnt lgkmcnt(0)
    v_mfma_f32_16x16x32_bf16 v[128:131], a[192:195], a[224:227], v[128:131]
    s_waitcnt vmcnt(12)
    s_barrier
    s_add_u32 m0, s21, s29
    v_mfma_f32_16x16x32_bf16 v[144:147], a[192:195], a[228:231], v[144:147]
    ds_read_b64_tr_b16 a[128:129], v22 offset:0
    v_mfma_f32_16x16x32_bf16 v[160:163], a[192:195], a[232:235], v[160:163]
    s_add_u32 s28, s28, 16384
    buffer_load_dwordx4 v12, s[8:11], s17 offen offset:0 lds
    v_mfma_f32_16x16x32_bf16 v[176:179], a[192:195], a[236:239], v[176:179]
    ds_read_b64_tr_b16 a[130:131], v22 offset:1024
    v_mfma_f32_16x16x32_bf16 v[192:195], a[192:195], a[240:243], v[192:195]
    s_and_b32 s28, s28, 65535
    v_mfma_f32_16x16x32_bf16 v[208:211], a[192:195], a[244:247], v[208:211]
    ds_read_b128 a[160:163], v21 offset:0
    v_mfma_f32_16x16x32_bf16 v[224:227], a[192:195], a[248:251], v[224:227]
    s_add_u32 s18, s18, 1
    buffer_load_dwordx4 v13, s[8:11], s17 offen offset:1024 lds
    v_mfma_f32_16x16x32_bf16 v[240:243], a[192:195], a[252:255], v[240:243]
    ds_read_b64_tr_b16 a[144:145], v22 offset:8192
    v_mfma_f32_16x16x32_bf16 a[112:115], a[208:211], a[252:255], a[112:115]
    v_mfma_f32_16x16x32_bf16 a[96:99], a[208:211], a[248:251], a[96:99]
    ds_read_b64_tr_b16 a[146:147], v22 offset:9216
    v_mfma_f32_16x16x32_bf16 a[80:83], a[208:211], a[244:247], a[80:83]
    buffer_load_dwordx4 v14, s[8:11], s17 offen offset:2048 lds
    v_mfma_f32_16x16x32_bf16 a[64:67], a[208:211], a[240:243], a[64:67]
    ds_read_b128 a[164:167], v21 offset:2048
    v_mfma_f32_16x16x32_bf16 a[48:51], a[208:211], a[236:239], a[48:51]
    v_mfma_f32_16x16x32_bf16 a[32:35], a[208:211], a[232:235], a[32:35]
    ds_read_b64_tr_b16 a[132:133], v23 offset:0
    v_mfma_f32_16x16x32_bf16 a[16:19], a[208:211], a[228:231], a[16:19]
    buffer_load_dwordx4 v15, s[8:11], s17 offen offset:3072 lds
    s_add_u32 m0, m0, 16384
    s_add_u32 s17, s17, s72
    v_mfma_f32_16x16x32_bf16 a[0:3], a[208:211], a[224:227], a[0:3]
    ds_read_b64_tr_b16 a[134:135], v23 offset:1024
    v_mfma_f32_16x16x32_bf16 v[132:135], a[196:199], a[224:227], v[132:135]
    v_mfma_f32_16x16x32_bf16 v[148:151], a[196:199], a[228:231], v[148:151]
    ds_read_b128 a[168:171], v21 offset:4096
    v_mfma_f32_16x16x32_bf16 v[164:167], a[196:199], a[232:235], v[164:167]
    buffer_load_dwordx4 v12, s[8:11], s17 offen offset:0 lds
    v_mfma_f32_16x16x32_bf16 v[180:183], a[196:199], a[236:239], v[180:183]
    ds_read_b64_tr_b16 a[148:149], v23 offset:8192
    v_mfma_f32_16x16x32_bf16 v[196:199], a[196:199], a[240:243], v[196:199]
    v_mfma_f32_16x16x32_bf16 v[212:215], a[196:199], a[244:247], v[212:215]
    ds_read_b64_tr_b16 a[150:151], v23 offset:9216
    v_mfma_f32_16x16x32_bf16 v[228:231], a[196:199], a[248:251], v[228:231]
    buffer_load_dwordx4 v13, s[8:11], s17 offen offset:1024 lds
    v_mfma_f32_16x16x32_bf16 v[244:247], a[196:199], a[252:255], v[244:247]
    ds_read_b128 a[172:175], v21 offset:6144
    v_mfma_f32_16x16x32_bf16 a[116:119], a[212:215], a[252:255], a[116:119]
    v_mfma_f32_16x16x32_bf16 a[100:103], a[212:215], a[248:251], a[100:103]
    ds_read_b64_tr_b16 a[136:137], v24 offset:0
    v_mfma_f32_16x16x32_bf16 a[84:87], a[212:215], a[244:247], a[84:87]
    buffer_load_dwordx4 v14, s[8:11], s17 offen offset:2048 lds
    v_mfma_f32_16x16x32_bf16 a[68:71], a[212:215], a[240:243], a[68:71]
    ds_read_b64_tr_b16 a[138:139], v24 offset:1024
    v_mfma_f32_16x16x32_bf16 a[52:55], a[212:215], a[236:239], a[52:55]
    v_mfma_f32_16x16x32_bf16 a[36:39], a[212:215], a[232:235], a[36:39]
    ds_read_b128 a[176:179], v21 offset:8192
    v_mfma_f32_16x16x32_bf16 a[20:23], a[212:215], a[228:231], a[20:23]
    buffer_load_dwordx4 v15, s[8:11], s17 offen offset:3072 lds
    s_add_u32 m0, s23, s19
    s_add_u32 s17, s17, s72
    v_mfma_f32_16x16x32_bf16 a[4:7], a[212:215], a[224:227], a[4:7]
    ds_read_b64_tr_b16 a[152:153], v24 offset:8192
    v_mfma_f32_16x16x32_bf16 v[136:139], a[200:203], a[224:227], v[136:139]
    v_mfma_f32_16x16x32_bf16 v[152:155], a[200:203], a[228:231], v[152:155]
    ds_read_b64_tr_b16 a[154:155], v24 offset:9216
    v_mfma_f32_16x16x32_bf16 v[168:171], a[200:203], a[232:235], v[168:171]
    buffer_load_dwordx4 v8, s[4:7], s16 offen offset:0 lds
    s_xor_b32 s29, s29, 32768
    v_mfma_f32_16x16x32_bf16 v[184:187], a[200:203], a[236:239], v[184:187]
    ds_read_b128 a[180:183], v21 offset:10240
    v_mfma_f32_16x16x32_bf16 v[200:203], a[200:203], a[240:243], v[200:203]
    v_mfma_f32_16x16x32_bf16 v[216:219], a[200:203], a[244:247], v[216:219]
    ds_read_b64_tr_b16 a[140:141], v25 offset:0
    v_mfma_f32_16x16x32_bf16 v[232:235], a[200:203], a[248:251], v[232:235]
    buffer_load_dwordx4 v9, s[4:7], s16 offen offset:1024 lds
    s_mov_b32 s19, s20
    v_mfma_f32_16x16x32_bf16 v[248:251], a[200:203], a[252:255], v[248:251]
    ds_read_b64_tr_b16 a[142:143], v25 offset:1024
    v_mfma_f32_16x16x32_bf16 a[120:123], a[216:219], a[252:255], a[120:123]
    v_mfma_f32_16x16x32_bf16 a[104:107], a[216:219], a[248:251], a[104:107]
    ds_read_b128 a[184:187], v21 offset:12288
    v_mfma_f32_16x16x32_bf16 a[88:91], a[216:219], a[244:247], a[88:91]
    buffer_load_dwordx4 v10, s[4:7], s16 offen offset:2048 lds
    s_add_u32 s20, s20, 32768
    s_cmp_eq_u32 s20, 98304
    s_cselect_b32 s20, 0, s20
    v_mfma_f32_16x16x32_bf16 a[72:75], a[216:219], a[240:243], a[72:75]
    ds_read_b64_tr_b16 a[156:157], v25 offset:8192
    v_mfma_f32_16x16x32_bf16 a[56:59], a[216:219], a[236:239], a[56:59]
    v_mfma_f32_16x16x32_bf16 a[40:43], a[216:219], a[232:235], a[40:43]
    ds_read_b64_tr_b16 a[158:159], v25 offset:9216
    v_mfma_f32_16x16x32_bf16 a[24:27], a[216:219], a[228:231], a[24:27]
    buffer_load_dwordx4 v11, s[4:7], s16 offen offset:3072 lds
    s_add_u32 m0, m0, 4096
    v_mfma_f32_16x16x32_bf16 a[8:11], a[216:219], a[224:227], a[8:11]
    ds_read_b128 a[188:191], v21 offset:14336
    v_mfma_f32_16x16x32_bf16 v[140:143], a[204:207], a[224:227], v[140:143]
    v_mfma_f32_16x16x32_bf16 v[156:159], a[204:207], a[228:231], v[156:159]
    buffer_load_dwordx4 v8, s[4:7], s22 offen offset:0 lds
    s_add_u32 s16, s16, s73
    v_mfma_f32_16x16x32_bf16 v[172:175], a[204:207], a[232:235], v[172:175]
    v_add_u32 v22, s28, v17
    v_mfma_f32_16x16x32_bf16 v[188:191], a[204:207], a[236:239], v[188:191]
    v_mfma_f32_16x16x32_bf16 v[204:207], a[204:207], a[240:243], v[204:207]
    v_add_u32 v23, s28, v18
    buffer_load_dwordx4 v9, s[4:7], s22 offen offset:1024 lds
    v_mfma_f32_16x16x32_bf16 v[220:223], a[204:207], a[244:247], v[220:223]
    v_mfma_f32_16x16x32_bf16 v[236:239], a[204:207], a[248:251], v[236:239]
    v_add_u32 v24, s28, v19
    v_mfma_f32_16x16x32_bf16 v[252:255], a[204:207], a[252:255], v[252:255]
    buffer_load_dwordx4 v10, s[4:7], s22 offen offset:2048 lds
    v_mfma_f32_16x16x32_bf16 a[124:127], a[220:223], a[252:255], a[124:127]
    v_add_u32 v25, s28, v20
    v_mfma_f32_16x16x32_bf16 a[108:111], a[220:223], a[248:251], a[108:111]
    v_mfma_f32_16x16x32_bf16 a[92:95], a[220:223], a[244:247], a[92:95]
    v_add_u32 v21, s19, v33
    buffer_load_dwordx4 v11, s[4:7], s22 offen offset:3072 lds
    s_cmp_ge_u32 s18, 26
    s_cbranch_scc1 L_g1_sw
L_g1_swd:
    s_add_u32 s22, s16, s74
    v_mfma_f32_16x16x32_bf16 a[76:79], a[220:223], a[240:243], a[76:79]
    v_mfma_f32_16x16x32_bf16 a[60:63], a[220:223], a[236:239], a[60:63]
    v_mfma_f32_16x16x32_bf16 a[44:47], a[220:223], a[232:235], a[44:47]
    v_mfma_f32_16x16x32_bf16 a[28:31], a[220:223], a[228:231], a[28:31]
    buffer_load_dword v28, v27, s[80:83], s84 offen
    s_add_u32 s84, s84, s85
    v_mfma_f32_16x16x32_bf16 a[12:15], a[220:223], a[224:227], a[12:15]
    s_cmp_lt_u32 s18, 32
    s_cbranch_scc1 L_g1_loop
    s_branch L_g1_done
L_g1_sw:
    s_cmp_eq_u32 s18, 26
    s_cbranch_scc0 L_g1_sw2
    s_mov_b64 s[4:5], s[32:33]
    s_mov_b32 s6, s34
    v_mov_b32 v8, v96
    v_mov_b32 v9, v97
    v_mov_b32 v10, v98
    v_mov_b32 v11, v99
    s_mov_b32 s16, s41
    s_mov_b32 s74, 32768
    s_branch L_g1_swd
L_g1_sw2:
    s_cmp_eq_u32 s18, 28
    s_cselect_b32 s16, s42, s40
    s_branch L_g1_swd
L_g1_done:
    s_mov_b32 s26, 3222493025
    s_mov_b32 s28, 3184710632
    s_mov_b32 s29, 3184710632
    v_mov_b32 v24, s26
    v_mov_b32 v25, s26
    v_mov_b32 v2, 0
    v_mov_b32 v3, 0
    v_mov_b32 v4, 0
    v_mov_b32 v5, 0
    s_lshr_b32 s27, s3, 1
    s_lshl_b32 s27, s27, 15
    s_and_b32 s26, s3, 1
    s_lshl_b32 s26, s26, 12
    s_add_u32 s26, s26, s27
    s_add_u32 s26, s26, 98304
    v_add_u32 v29, s26, v104
    s_waitcnt lgkmcnt(0)
    v_accvgpr_read_b32 v32, a0
    v_accvgpr_read_b32 v33, a1
    v_accvgpr_read_b32 v34, a2
    v_accvgpr_read_b32 v35, a3
    v_accvgpr_read_b32 v36, a4
    v_accvgpr_read_b32 v37, a5
    v_accvgpr_read_b32 v38, a6
    v_accvgpr_read_b32 v39, a7
    v_accvgpr_read_b32 v40, a8
    v_accvgpr_read_b32 v41, a9
    v_accvgpr_read_b32 v42, a10
    v_accvgpr_read_b32 v43, a11
    v_accvgpr_read_b32 v44, a12
    v_accvgpr_read_b32 v45, a13
    v_accvgpr_read_b32 v46, a14
    v_accvgpr_read_b32 v47, a15
    v_pk_mul_f32 v[48:49], v[128:129], v[128:129]
    v_pk_mul_f32 v[50:51], v[130:131], v[130:131]
    v_pk_mul_f32 v[52:53], v[132:133], v[132:133]
    v_pk_mul_f32 v[54:55], v[134:135], v[134:135]
    v_pk_mul_f32 v[56:57], v[136:137], v[136:137]
    v_pk_mul_f32 v[58:59], v[138:139], v[138:139]
    v_pk_mul_f32 v[60:61], v[140:141], v[140:141]
    v_pk_mul_f32 v[62:63], v[142:143], v[142:143]
    v_pk_fma_f32 v[48:49], v[48:49], s[28:29], v[24:25]
    v_pk_fma_f32 v[50:51], v[50:51], s[28:29], v[24:25]
    v_pk_fma_f32 v[52:53], v[52:53], s[28:29], v[24:25]
    v_pk_fma_f32 v[54:55], v[54:55], s[28:29], v[24:25]
    v_pk_fma_f32 v[56:57], v[56:57], s[28:29], v[24:25]
    v_pk_fma_f32 v[58:59], v[58:59], s[28:29], v[24:25]
    v_pk_fma_f32 v[60:61], v[60:61], s[28:29], v[24:25]
    v_pk_fma_f32 v[62:63], v[62:63], s[28:29], v[24:25]
    v_pk_mul_f32 v[48:49], v[48:49], v[128:129]
    v_pk_mul_f32 v[50:51], v[50:51], v[130:131]
    v_pk_mul_f32 v[52:53], v[52:53], v[132:133]
    v_pk_mul_f32 v[54:55], v[54:55], v[134:135]
    v_pk_mul_f32 v[56:57], v[56:57], v[136:137]
    v_pk_mul_f32 v[58:59], v[58:59], v[138:139]
    v_pk_mul_f32 v[60:61], v[60:61], v[140:141]
    v_pk_mul_f32 v[62:63], v[62:63], v[142:143]
    v_exp_f32 v48, v48
    v_exp_f32 v49, v49
    v_exp_f32 v50, v50
    v_exp_f32 v51, v51
    v_exp_f32 v52, v52
    v_exp_f32 v53, v53
    v_exp_f32 v54, v54
    v_exp_f32 v55, v55
    v_exp_f32 v56, v56
    v_exp_f32 v57, v57
    v_exp_f32 v58, v58
    v_exp_f32 v59, v59
    v_exp_f32 v60, v60
    v_exp_f32 v61, v61
    v_exp_f32 v62, v62
    v_exp_f32 v63, v63
    v_pk_mul_f32 v[32:33], v[32:33], v[128:129]
    v_pk_mul_f32 v[34:35], v[34:35], v[130:131]
    v_pk_mul_f32 v[36:37], v[36:37], v[132:133]
    v_pk_mul_f32 v[38:39], v[38:39], v[134:135]
    v_pk_mul_f32 v[40:41], v[40:41], v[136:137]
    v_pk_mul_f32 v[42:43], v[42:43], v[138:139]
    v_pk_mul_f32 v[44:45], v[44:45], v[140:141]
    v_pk_mul_f32 v[46:47], v[46:47], v[142:143]
    v_pk_add_f32 v[48:49], v[48:49], 1.0 op_sel_hi:[1,0]
    v_pk_add_f32 v[50:51], v[50:51], 1.0 op_sel_hi:[1,0]
    v_pk_add_f32 v[52:53], v[52:53], 1.0 op_sel_hi:[1,0]
    v_pk_add_f32 v[54:55], v[54:55], 1.0 op_sel_hi:[1,0]
    v_pk_add_f32 v[56:57], v[56:57], 1.0 op_sel_hi:[1,0]
    v_pk_add_f32 v[58:59], v[58:59], 1.0 op_sel_hi:[1,0]
    v_pk_add_f32 v[60:61], v[60:61], 1.0 op_sel_hi:[1,0]
    v_pk_add_f32 v[62:63], v[62:63], 1.0 op_sel_hi:[1,0]
    v_rcp_f32 v48, v48
    v_rcp_f32 v49, v49
    v_rcp_f32 v50, v50
    v_rcp_f32 v51, v51
    v_rcp_f32 v52, v52
    v_rcp_f32 v53, v53
    v_rcp_f32 v54, v54
    v_rcp_f32 v55, v55
    v_rcp_f32 v56, v56
    v_rcp_f32 v57, v57
    v_rcp_f32 v58, v58
    v_rcp_f32 v59, v59
    v_rcp_f32 v60, v60
    v_rcp_f32 v61, v61
    v_rcp_f32 v62, v62
    v_rcp_f32 v63, v63
    s_nop 0
    v_pk_mul_f32 v[32:33], v[32:33], v[48:49]
    v_pk_mul_f32 v[34:35], v[34:35], v[50:51]
    v_pk_mul_f32 v[36:37], v[36:37], v[52:53]
    v_pk_mul_f32 v[38:39], v[38:39], v[54:55]
    v_pk_mul_f32 v[40:41], v[40:41], v[56:57]
    v_pk_mul_f32 v[42:43], v[42:43], v[58:59]
    v_pk_mul_f32 v[44:45], v[44:45], v[60:61]
    v_pk_mul_f32 v[46:47], v[46:47], v[62:63]
    v_cvt_pk_bf16_f32 v128, v32, v33
    v_cvt_pk_bf16_f32 v129, v34, v35
    v_cvt_pk_bf16_f32 v130, v36, v37
    v_cvt_pk_bf16_f32 v131, v38, v39
    v_cvt_pk_bf16_f32 v132, v40, v41
    v_cvt_pk_bf16_f32 v133, v42, v43
    v_cvt_pk_bf16_f32 v134, v44, v45
    v_cvt_pk_bf16_f32 v135, v46, v47
    s_add_u32 s31, s86, 0
    buffer_store_dwordx4 v[128:131], v104, s[12:15], s31 offen sc1
    s_add_u32 s31, s86, 2048
    buffer_store_dwordx4 v[132:135], v104, s[12:15], s31 offen sc1
    s_waitcnt vmcnt(2)
    s_barrier
    ds_write_b128 v29, v[128:131] offset:0
    ds_write_b128 v29, v[132:135] offset:2048
    v_accvgpr_read_b32 v64, a16
    v_accvgpr_read_b32 v65, a17
    v_accvgpr_read_b32 v66, a18
    v_accvgpr_read_b32 v67, a19
    v_accvgpr_read_b32 v68, a20
    v_accvgpr_read_b32 v69, a21
    v_accvgpr_read_b32 v70, a22
    v_accvgpr_read_b32 v71, a23
    v_accvgpr_read_b32 v72, a24
    v_accvgpr_read_b32 v73, a25
    v_accvgpr_read_b32 v74, a26
    v_accvgpr_read_b32 v75, a27
    v_accvgpr_read_b32 v76, a28
    v_accvgpr_read_b32 v77, a29
    v_accvgpr_read_b32 v78, a30
    v_accvgpr_read_b32 v79, a31
    v_pk_mul_f32 v[80:81], v[144:145], v[144:145]
    v_pk_mul_f32 v[82:83], v[146:147], v[146:147]
    v_pk_mul_f32 v[84:85], v[148:149], v[148:149]
    v_pk_mul_f32 v[86:87], v[150:151], v[150:151]
    v_pk_mul_f32 v[88:89], v[152:153], v[152:153]
    v_pk_mul_f32 v[90:91], v[154:155], v[154:155]
    v_pk_mul_f32 v[92:93], v[156:157], v[156:157]
    v_pk_mul_f32 v[94:95], v[158:159], v[158:159]
    v_pk_fma_f32 v[80:81], v[80:81], s[28:29], v[24:25]
    v_pk_fma_f32 v[82:83], v[82:83], s[28:29], v[24:25]
    v_pk_fma_f32 v[84:85], v[84:85], s[28:29], v[24:25]
    v_pk_fma_f32 v[86:87], v[86:87], s[28:29], v[24:25]
    v_pk_fma_f32 v[88:89], v[88:89], s[28:29], v[24:25]
    v_pk_fma_f32 v[90:91], v[90:91], s[28:29], v[24:25]
    v_pk_fma_f32 v[92:93], v[92:93], s[28:29], v[24:25]
    v_pk_fma_f32 v[94:95], v[94:95], s[28:29], v[24:25]
    v_pk_mul_f32 v[80:81], v[80:81], v[144:145]
    v_pk_mul_f32 v[82:83], v[82:83], v[146:147]
    v_pk_mul_f32 v[84:85], v[84:85], v[148:149]
    v_pk_mul_f32 v[86:87], v[86:87], v[150:151]
    v_pk_mul_f32 v[88:89], v[88:89], v[152:153]
    v_pk_mul_f32 v[90:91], v[90:91], v[154:155]
    v_pk_mul_f32 v[92:93], v[92:93], v[156:157]
    v_pk_mul_f32 v[94:95], v[94:95], v[158:159]
    v_exp_f32 v80, v80
    v_exp_f32 v81, v81
    v_exp_f32 v82, v82
    v_exp_f32 v83, v83
    v_exp_f32 v84, v84
    v_exp_f32 v85, v85
    v_exp_f32 v86, v86
    v_exp_f32 v87, v87
    v_exp_f32 v88, v88
    v_exp_f32 v89, v89
    v_exp_f32 v90, v90
    v_exp_f32 v91, v91
    v_exp_f32 v92, v92
    v_exp_f32 v93, v93
    v_exp_f32 v94, v94
    v_exp_f32 v95, v95
    v_pk_mul_f32 v[64:65], v[64:65], v[144:145]
    v_pk_mul_f32 v[66:67], v[66:67], v[146:147]
    v_pk_mul_f32 v[68:69], v[68:69], v[148:149]
    v_pk_mul_f32 v[70:71], v[70:71], v[150:151]
    v_pk_mul_f32 v[72:73], v[72:73], v[152:153]
    v_pk_mul_f32 v[74:75], v[74:75], v[154:155]
    v_pk_mul_f32 v[76:77], v[76:77], v[156:157]
    v_pk_mul_f32 v[78:79], v[78:79], v[158:159]
    v_pk_add_f32 v[80:81], v[80:81], 1.0 op_sel_hi:[1,0]
    v_pk_add_f32 v[82:83], v[82:83], 1.0 op_sel_hi:[1,0]
    v_pk_add_f32 v[84:85], v[84:85], 1.0 op_sel_hi:[1,0]
    v_pk_add_f32 v[86:87], v[86:87], 1.0 op_sel_hi:[1,0]
    v_pk_add_f32 v[88:89], v[88:89], 1.0 op_sel_hi:[1,0]
    v_pk_add_f32 v[90:91], v[90:91], 1.0 op_sel_hi:[1,0]
    v_pk_add_f32 v[92:93], v[92:93], 1.0 op_sel_hi:[1,0]
    v_pk_add_f32 v[94:95], v[94:95], 1.0 op_sel_hi:[1,0]
    v_rcp_f32 v80, v80
    v_rcp_f32 v81, v81
    v_rcp_f32 v82, v82
    v_rcp_f32 v83, v83
    v_rcp_f32 v84, v84
    v_rcp_f32 v85, v85
    v_rcp_f32 v86, v86
    v_rcp_f32 v87, v87
    v_rcp_f32 v88, v88
    v_rcp_f32 v89, v89
    v_rcp_f32 v90, v90
    v_rcp_f32 v91, v91
    v_rcp_f32 v92, v92
    v_rcp_f32 v93, v93
    v_rcp_f32 v94, v94
    v_rcp_f32 v95, v95
    s_nop 0
    v_pk_mul_f32 v[64:65], v[64:65], v[80:81]
    v_pk_mul_f32 v[66:67], v[66:67], v[82:83]
    v_pk_mul_f32 v[68:69], v[68:69], v[84:85]
    v_pk_mul_f32 v[70:71], v[70:71], v[86:87]
    v_pk_mul_f32 v[72:73], v[72:73], v[88:89]
    v_pk_mul_f32 v[74:75], v[74:75], v[90:91]
    v_pk_mul_f32 v[76:77], v[76:77], v[92:93]
    v_pk_mul_f32 v[78:79], v[78:79], v[94:95]
    v_cvt_pk_bf16_f32 v144, v64, v65
    v_cvt_pk_bf16_f32 v145, v66, v67
    v_cvt_pk_bf16_f32 v146, v68, v69
    v_cvt_pk_bf16_f32 v147, v70, v71
    v_cvt_pk_bf16_f32 v148, v72, v73
    v_cvt_pk_bf16_f32 v149, v74, v75
    v_cvt_pk_bf16_f32 v150, v76, v77
    v_cvt_pk_bf16_f32 v151, v78, v79
    s_add_u32 s31, s86, 1024
    buffer_store_dwordx4 v[144:147], v104, s[12:15], s31 offen sc1
    s_add_u32 s31, s86, 3072
    buffer_store_dwordx4 v[148:151], v104, s[12:15], s31 offen sc1
    ds_write_b128 v29, v[144:147] offset:1024
    ds_write_b128 v29, v[148:151] offset:3072
    v_accvgpr_read_b32 v32, a32
    v_accvgpr_read_b32 v33, a33
    v_accvgpr_read_b32 v34, a34
    v_accvgpr_read_b32 v35, a35
    v_accvgpr_read_b32 v36, a36
    v_accvgpr_read_b32 v37, a37
    v_accvgpr_read_b32 v38, a38
    v_accvgpr_read_b32 v39, a39
    v_accvgpr_read_b32 v40, a40
    v_accvgpr_read_b32 v41, a41
    v_accvgpr_read_b32 v42, a42
    v_accvgpr_read_b32 v43, a43
    v_accvgpr_read_b32 v44, a44
    v_accvgpr_read_b32 v45, a45
    v_accvgpr_read_b32 v46, a46
    v_accvgpr_read_b32 v47, a47
    v_pk_mul_f32 v[48:49], v[160:161], v[160:161]
    v_pk_mul_f32 v[50:51], v[162:163], v[162:163]
    v_pk_mul_f32 v[52:53], v[164:165], v[164:165]
    v_pk_mul_f32 v[54:55], v[166:167], v[166:167]
    v_pk_mul_f32 v[56:57], v[168:169], v[168:169]
    v_pk_mul_f32 v[58:59], v[170:171], v[170:171]
    v_pk_mul_f32 v[60:61], v[172:173], v[172:173]
    v_pk_mul_f32 v[62:63], v[174:175], v[174:175]
    v_pk_fma_f32 v[48:49], v[48:49], s[28:29], v[24:25]
    v_pk_fma_f32 v[50:51], v[50:51], s[28:29], v[24:25]
    v_pk_fma_f32 v[52:53], v[52:53], s[28:29], v[24:25]
    v_pk_fma_f32 v[54:55], v[54:55], s[28:29], v[24:25]
    v_pk_fma_f32 v[56:57], v[56:57], s[28:29], v[24:25]
    v_pk_fma_f32 v[58:59], v[58:59], s[28:29], v[24:25]
    v_pk_fma_f32 v[60:61], v[60:61], s[28:29], v[24:25]
    v_pk_fma_f32 v[62:63], v[62:63], s[28:29], v[24:25]
    v_pk_mul_f32 v[48:49], v[48:49], v[160:161]
    v_pk_mul_f32 v[50:51], v[50:51], v[162:163]
    v_pk_mul_f32 v[52:53], v[52:53], v[164:165]
    v_pk_mul_f32 v[54:55], v[54:55], v[166:167]
    v_pk_mul_f32 v[56:57], v[56:57], v[168:169]
    v_pk_mul_f32 v[58:59], v[58:59], v[170:171]
    v_pk_mul_f32 v[60:61], v[60:61], v[172:173]
    v_pk_mul_f32 v[62:63], v[62:63], v[174:175]
    v_exp_f32 v48, v48
    v_exp_f32 v49, v49
    v_exp_f32 v50, v50
    v_exp_f32 v51, v51
    v_exp_f32 v52, v52
    v_exp_f32 v53, v53
    v_exp_f32 v54, v54
    v_exp_f32 v55, v55
    v_exp_f32 v56, v56
    v_exp_f32 v57, v57
    v_exp_f32 v58, v58
    v_exp_f32 v59, v59
    v_exp_f32 v60, v60
    v_exp_f32 v61, v61
    v_exp_f32 v62, v62
    v_exp_f32 v63, v63
    v_pk_mul_f32 v[32:33], v[32:33], v[160:161]
    v_pk_mul_f32 v[34:35], v[34:35], v[162:163]
    v_pk_mul_f32 v[36:37], v[36:37], v[164:165]
    v_pk_mul_f32 v[38:39], v[38:39], v[166:167]
    v_pk_mul_f32 v[40:41], v[40:41], v[168:169]
    v_pk_mul_f32 v[42:43], v[42:43], v[170:171]
    v_pk_mul_f32 v[44:45], v[44:45], v[172:173]
    v_pk_mul_f32 v[46:47], v[46:47], v[174:175]
    v_pk_add_f32 v[48:49], v[48:49], 1.0 op_sel_hi:[1,0]
    v_pk_add_f32 v[50:51], v[50:51], 1.0 op_sel_hi:[1,0]
    v_pk_add_f32 v[52:53], v[52:53], 1.0 op_sel_hi:[1,0]
    v_pk_add_f32 v[54:55], v[54:55], 1.0 op_sel_hi:[1,0]
    v_pk_add_f32 v[56:57], v[56:57], 1.0 op_sel_hi:[1,0]
    v_pk_add_f32 v[58:59], v[58:59], 1.0 op_sel_hi:[1,0]
    v_pk_add_f32 v[60:61], v[60:61], 1.0 op_sel_hi:[1,0]
    v_pk_add_f32 v[62:63], v[62:63], 1.0 op_sel_hi:[1,0]
    v_rcp_f32 v48, v48
    v_rcp_f32 v49, v49
    v_rcp_f32 v50, v50
    v_rcp_f32 v51, v51
    v_rcp_f32 v52, v52
    v_rcp_f32 v53, v53
    v_rcp_f32 v54, v54
    v_rcp_f32 v55, v55
    v_rcp_f32 v56, v56
    v_rcp_f32 v57, v57
    v_rcp_f32 v58, v58
    v_rcp_f32 v59, v59
    v_rcp_f32 v60, v60
    v_rcp_f32 v61, v61
    v_rcp_f32 v62, v62
    v_rcp_f32 v63, v63
    s_nop 0
    v_pk_mul_f32 v[32:33], v[32:33], v[48:49]
    v_pk_mul_f32 v[34:35], v[34:35], v[50:51]
    v_pk_mul_f32 v[36:37], v[36:37], v[52:53]
    v_pk_mul_f32 v[38:39], v[38:39], v[54:55]
    v_pk_mul_f32 v[40:41], v[40:41], v[56:57]
    v_pk_mul_f32 v[42:43], v[42:43], v[58:59]
    v_pk_mul_f32 v[44:45], v[44:45], v[60:61]
    v_pk_mul_f32 v[46:47], v[46:47], v[62:63]
    v_cvt_pk_bf16_f32 v160, v32, v33
    v_cvt_pk_bf16_f32 v161, v34, v35
    v_cvt_pk_bf16_f32 v162, v36, v37
    v_cvt_pk_bf16_f32 v163, v38, v39
    v_cvt_pk_bf16_f32 v164, v40, v41
    v_cvt_pk_bf16_f32 v165, v42, v43
    v_cvt_pk_bf16_f32 v166, v44, v45
    v_cvt_pk_bf16_f32 v167, v46, v47
    s_add_u32 s31, s86, 229376
    buffer_store_dwordx4 v[160:163], v104, s[12:15], s31 offen sc1
    s_add_u32 s31, s86, 231424
    buffer_store_dwordx4 v[164:167], v104, s[12:15], s31 offen sc1
    ds_write_b128 v29, v[160:163] offset:8192
    ds_write_b128 v29, v[164:167] offset:10240
    v_accvgpr_read_b32 v64, a48
    v_accvgpr_read_b32 v65, a49
    v_accvgpr_read_b32 v66, a50
    v_accvgpr_read_b32 v67, a51
    v_accvgpr_read_b32 v68, a52
    v_accvgpr_read_b32 v69, a53
    v_accvgpr_read_b32 v70, a54
    v_accvgpr_read_b32 v71, a55
    v_accvgpr_read_b32 v72, a56
    v_accvgpr_read_b32 v73, a57
    v_accvgpr_read_b32 v74, a58
    v_accvgpr_read_b32 v75, a59
    v_accvgpr_read_b32 v76, a60
    v_accvgpr_read_b32 v77, a61
    v_accvgpr_read_b32 v78, a62
    v_accvgpr_read_b32 v79, a63
    v_pk_mul_f32 v[80:81], v[176:177], v[176:177]
    v_pk_mul_f32 v[82:83], v[178:179], v[178:179]
    v_pk_mul_f32 v[84:85], v[180:181], v[180:181]
    v_pk_mul_f32 v[86:87], v[182:183], v[182:183]
    v_pk_mul_f32 v[88:89], v[184:185], v[184:185]
    v_pk_mul_f32 v[90:91], v[186:187], v[186:187]
    v_pk_mul_f32 v[92:93], v[188:189], v[188:189]
    v_pk_mul_f32 v[94:95], v[190:191], v[190:191]
    v_pk_fma_f32 v[80:81], v[80:81], s[28:29], v[24:25]
    v_pk_fma_f32 v[82:83], v[82:83], s[28:29], v[24:25]
    v_pk_fma_f32 v[84:85], v[84:85], s[28:29], v[24:25]
    v_pk_fma_f32 v[86:87], v[86:87], s[28:29], v[24:25]
    v_pk_fma_f32 v[88:89], v[88:89], s[28:29], v[24:25]
    v_pk_fma_f32 v[90:91], v[90:91], s[28:29], v[24:25]
    v_pk_fma_f32 v[92:93], v[92:93], s[28:29], v[24:25]
    v_pk_fma_f32 v[94:95], v[94:95], s[28:29], v[24:25]
    v_pk_mul_f32 v[80:81], v[80:81], v[176:177]
    v_pk_mul_f32 v[82:83], v[82:83], v[178:179]
    v_pk_mul_f32 v[84:85], v[84:85], v[180:181]
    v_pk_mul_f32 v[86:87], v[86:87], v[182:183]
    v_pk_mul_f32 v[88:89], v[88:89], v[184:185]
    v_pk_mul_f32 v[90:91], v[90:91], v[186:187]
    v_pk_mul_f32 v[92:93], v[92:93], v[188:189]
    v_pk_mul_f32 v[94:95], v[94:95], v[190:191]
    v_exp_f32 v80, v80
    v_exp_f32 v81, v81
    v_exp_f32 v82, v82
    v_exp_f32 v83, v83
    v_exp_f32 v84, v84
    v_exp_f32 v85, v85
    v_exp_f32 v86, v86
    v_exp_f32 v87, v87
    v_exp_f32 v88, v88
    v_exp_f32 v89, v89
    v_exp_f32 v90, v90
    v_exp_f32 v91, v91
    v_exp_f32 v92, v92
    v_exp_f32 v93, v93
    v_exp_f32 v94, v94
    v_exp_f32 v95, v95
    v_pk_mul_f32 v[64:65], v[64:65], v[176:177]
    v_pk_mul_f32 v[66:67], v[66:67], v[178:179]
    v_pk_mul_f32 v[68:69], v[68:69], v[180:181]
    v_pk_mul_f32 v[70:71], v[70:71], v[182:183]
    v_pk_mul_f32 v[72:73], v[72:73], v[184:185]
    v_pk_mul_f32 v[74:75], v[74:75], v[186:187]
    v_pk_mul_f32 v[76:77], v[76:77], v[188:189]
    v_pk_mul_f32 v[78:79], v[78:79], v[190:191]
    v_pk_add_f32 v[80:81], v[80:81], 1.0 op_sel_hi:[1,0]
    v_pk_add_f32 v[82:83], v[82:83], 1.0 op_sel_hi:[1,0]
    v_pk_add_f32 v[84:85], v[84:85], 1.0 op_sel_hi:[1,0]
    v_pk_add_f32 v[86:87], v[86:87], 1.0 op_sel_hi:[1,0]
    v_pk_add_f32 v[88:89], v[88:89], 1.0 op_sel_hi:[1,0]
    v_pk_add_f32 v[90:91], v[90:91], 1.0 op_sel_hi:[1,0]
    v_pk_add_f32 v[92:93], v[92:93], 1.0 op_sel_hi:[1,0]
    v_pk_add_f32 v[94:95], v[94:95], 1.0 op_sel_hi:[1,0]
    v_rcp_f32 v80, v80
    v_rcp_f32 v81, v81
    v_rcp_f32 v82, v82
    v_rcp_f32 v83, v83
    v_rcp_f32 v84, v84
    v_rcp_f32 v85, v85
    v_rcp_f32 v86, v86
    v_rcp_f32 v87, v87
    v_rcp_f32 v88, v88
    v_rcp_f32 v89, v89
    v_rcp_f32 v90, v90
    v_rcp_f32 v91, v91
    v_rcp_f32 v92, v92
    v_rcp_f32 v93, v93
    v_rcp_f32 v94, v94
    v_rcp_f32 v95, v95
    s_nop 0
    v_pk_mul_f32 v[64:65], v[64:65], v[80:81]
    v_pk_mul_f32 v[66:67], v[66:67], v[82:83]
    v_pk_mul_f32 v[68:69], v[68:69], v[84:85]
    v_pk_mul_f32 v[70:71], v[70:71], v[86:87]
    v_pk_mul_f32 v[72:73], v[72:73], v[88:89]
    v_pk_mul_f32 v[74:75], v[74:75], v[90:91]
    v_pk_mul_f32 v[76:77], v[76:77], v[92:93]
    v_pk_mul_f32 v[78:79], v[78:79], v[94:95]
    v_cvt_pk_bf16_f32 v176, v64, v65
    v_cvt_pk_bf16_f32 v177, v66, v67
    v_cvt_pk_bf16_f32 v178, v68, v69
    v_cvt_pk_bf16_f32 v179, v70, v71
    v_cvt_pk_bf16_f32 v180, v72, v73
    v_cvt_pk_bf16_f32 v181, v74, v75
    v_cvt_pk_bf16_f32 v182, v76, v77
    v_cvt_pk_bf16_f32 v183, v78, v79
    s_add_u32 s31, s86, 230400
    buffer_store_dwordx4 v[176:179], v104, s[12:15], s31 offen sc1
    s_add_u32 s31, s86, 232448
    buffer_store_dwordx4 v[180:183], v104, s[12:15], s31 offen sc1
    ds_write_b128 v29, v[176:179] offset:9216
    ds_write_b128 v29, v[180:183] offset:11264
    v_mfma_f32_32x32x16_bf16 a[0:15], v[2:5], v[2:5], 0
    v_mfma_f32_32x32x16_bf16 a[16:31], v[2:5], v[2:5], 0
    v_mfma_f32_32x32x16_bf16 a[32:47], v[2:5], v[2:5], 0
    v_mfma_f32_32x32x16_bf16 a[48:63], v[2:5], v[2:5], 0
    v_accvgpr_read_b32 v32, a64
    v_accvgpr_read_b32 v33, a65
    v_accvgpr_read_b32 v34, a66
    v_accvgpr_read_b32 v35, a67
    v_accvgpr_read_b32 v36, a68
    v_accvgpr_read_b32 v37, a69
    v_accvgpr_read_b32 v38, a70
    v_accvgpr_read_b32 v39, a71
    v_accvgpr_read_b32 v40, a72
    v_accvgpr_read_b32 v41, a73
    v_accvgpr_read_b32 v42, a74
    v_accvgpr_read_b32 v43, a75
    v_accvgpr_read_b32 v44, a76
    v_accvgpr_read_b32 v45, a77
    v_accvgpr_read_b32 v46, a78
    v_accvgpr_read_b32 v47, a79
    v_pk_mul_f32 v[48:49], v[192:193], v[192:193]
    v_pk_mul_f32 v[50:51], v[194:195], v[194:195]
    v_pk_mul_f32 v[52:53], v[196:197], v[196:197]
    v_pk_mul_f32 v[54:55], v[198:199], v[198:199]
    v_pk_mul_f32 v[56:57], v[200:201], v[200:201]
    v_pk_mul_f32 v[58:59], v[202:203], v[202:203]
    v_pk_mul_f32 v[60:61], v[204:205], v[204:205]
    v_pk_mul_f32 v[62:63], v[206:207], v[206:207]
    v_pk_fma_f32 v[48:49], v[48:49], s[28:29], v[24:25]
    v_pk_fma_f32 v[50:51], v[50:51], s[28:29], v[24:25]
    v_pk_fma_f32 v[52:53], v[52:53], s[28:29], v[24:25]
    v_pk_fma_f32 v[54:55], v[54:55], s[28:29], v[24:25]
    v_pk_fma_f32 v[56:57], v[56:57], s[28:29], v[24:25]
    v_pk_fma_f32 v[58:59], v[58:59], s[28:29], v[24:25]
    v_pk_fma_f32 v[60:61], v[60:61], s[28:29], v[24:25]
    v_pk_fma_f32 v[62:63], v[62:63], s[28:29], v[24:25]
    v_pk_mul_f32 v[48:49], v[48:49], v[192:193]
    v_pk_mul_f32 v[50:51], v[50:51], v[194:195]
    v_pk_mul_f32 v[52:53], v[52:53], v[196:197]
    v_pk_mul_f32 v[54:55], v[54:55], v[198:199]
    v_pk_mul_f32 v[56:57], v[56:57], v[200:201]
    v_pk_mul_f32 v[58:59], v[58:59], v[202:203]
    v_pk_mul_f32 v[60:61], v[60:61], v[204:205]
    v_pk_mul_f32 v[62:63], v[62:63], v[206:207]
    v_exp_f32 v48, v48
    v_exp_f32 v49, v49
    v_exp_f32 v50, v50
    v_exp_f32 v51, v51
    v_exp_f32 v52, v52
    v_exp_f32 v53, v53
    v_exp_f32 v54, v54
    v_exp_f32 v55, v55
    v_exp_f32 v56, v56
    v_exp_f32 v57, v57
    v_exp_f32 v58, v58
    v_exp_f32 v59, v59
    v_exp_f32 v60, v60
    v_exp_f32 v61, v61
    v_exp_f32 v62, v62
    v_exp_f32 v63, v63
    v_pk_mul_f32 v[32:33], v[32:33], v[192:193]
    v_pk_mul_f32 v[34:35], v[34:35], v[194:195]
    v_pk_mul_f32 v[36:37], v[36:37], v[196:197]
    v_pk_mul_f32 v[38:39], v[38:39], v[198:199]
    v_pk_mul_f32 v[40:41], v[40:41], v[200:201]
    v_pk_mul_f32 v[42:43], v[42:43], v[202:203]
    v_pk_mul_f32 v[44:45], v[44:45], v[204:205]
    v_pk_mul_f32 v[46:47], v[46:47], v[206:207]
    v_pk_add_f32 v[48:49], v[48:49], 1.0 op_sel_hi:[1,0]
    v_pk_add_f32 v[50:51], v[50:51], 1.0 op_sel_hi:[1,0]
    v_pk_add_f32 v[52:53], v[52:53], 1.0 op_sel_hi:[1,0]
    v_pk_add_f32 v[54:55], v[54:55], 1.0 op_sel_hi:[1,0]
    v_pk_add_f32 v[56:57], v[56:57], 1.0 op_sel_hi:[1,0]
    v_pk_add_f32 v[58:59], v[58:59], 1.0 op_sel_hi:[1,0]
    v_pk_add_f32 v[60:61], v[60:61], 1.0 op_sel_hi:[1,0]
    v_pk_add_f32 v[62:63], v[62:63], 1.0 op_sel_hi:[1,0]
    v_rcp_f32 v48, v48
    v_rcp_f32 v49, v49
    v_rcp_f32 v50, v50
    v_rcp_f32 v51, v51
    v_rcp_f32 v52, v52
    v_rcp_f32 v53, v53
    v_rcp_f32 v54, v54
    v_rcp_f32 v55, v55
    v_rcp_f32 v56, v56
    v_rcp_f32 v57, v57
    v_rcp_f32 v58, v58
    v_rcp_f32 v59, v59
    v_rcp_f32 v60, v60
    v_rcp_f32 v61, v61
    v_rcp_f32 v62, v62
    v_rcp_f32 v63, v63
    s_nop 0
    v_pk_mul_f32 v[32:33], v[32:33], v[48:49]
    v_pk_mul_f32 v[34:35], v[34:35], v[50:51]
    v_pk_mul_f32 v[36:37], v[36:37], v[52:53]
    v_pk_mul_f32 v[38:39], v[38:39], v[54:55]
    v_pk_mul_f32 v[40:41], v[40:41], v[56:57]
    v_pk_mul_f32 v[42:43], v[42:43], v[58:59]
    v_pk_mul_f32 v[44:45], v[44:45], v[60:61]
    v_pk_mul_f32 v[46:47], v[46:47], v[62:63]
    v_cvt_pk_bf16_f32 v192, v32, v33
    v_cvt_pk_bf16_f32 v193, v34, v35
    v_cvt_pk_bf16_f32 v194, v36, v37
    v_cvt_pk_bf16_f32 v195, v38, v39
    v_cvt_pk_bf16_f32 v196, v40, v41
    v_cvt_pk_bf16_f32 v197, v42, v43
    v_cvt_pk_bf16_f32 v198, v44, v45
    v_cvt_pk_bf16_f32 v199, v46, v47
    s_add_u32 s31, s86, 458752
    buffer_store_dwordx4 v[192:195], v104, s[12:15], s31 offen sc1
    s_add_u32 s31, s86, 460800
    buffer_store_dwordx4 v[196:199], v104, s[12:15], s31 offen sc1
    ds_write_b128 v29, v[192:195] offset:16384
    ds_write_b128 v29, v[196:199] offset:18432
    v_accvgpr_read_b32 v64, a80
    v_accvgpr_read_b32 v65, a81
    v_accvgpr_read_b32 v66, a82
    v_accvgpr_read_b32 v67, a83
    v_accvgpr_read_b32 v68, a84
    v_accvgpr_read_b32 v69, a85
    v_accvgpr_read_b32 v70, a86
    v_accvgpr_read_b32 v71, a87
    v_accvgpr_read_b32 v72, a88
    v_accvgpr_read_b32 v73, a89
    v_accvgpr_read_b32 v74, a90
    v_accvgpr_read_b32 v75, a91
    v_accvgpr_read_b32 v76, a92
    v_accvgpr_read_b32 v77, a93
    v_accvgpr_read_b32 v78, a94
    v_accvgpr_read_b32 v79, a95
    v_pk_mul_f32 v[80:81], v[208:209], v[208:209]
    v_pk_mul_f32 v[82:83], v[210:211], v[210:211]
    v_pk_mul_f32 v[84:85], v[212:213], v[212:213]
    v_pk_mul_f32 v[86:87], v[214:215], v[214:215]
    v_pk_mul_f32 v[88:89], v[216:217], v[216:217]
    v_pk_mul_f32 v[90:91], v[218:219], v[218:219]
    v_pk_mul_f32 v[92:93], v[220:221], v[220:221]
    v_pk_mul_f32 v[94:95], v[222:223], v[222:223]
    v_pk_fma_f32 v[80:81], v[80:81], s[28:29], v[24:25]
    v_pk_fma_f32 v[82:83], v[82:83], s[28:29], v[24:25]
    v_pk_fma_f32 v[84:85], v[84:85], s[28:29], v[24:25]
    v_pk_fma_f32 v[86:87], v[86:87], s[28:29], v[24:25]
    v_pk_fma_f32 v[88:89], v[88:89], s[28:29], v[24:25]
    v_pk_fma_f32 v[90:91], v[90:91], s[28:29], v[24:25]
    v_pk_fma_f32 v[92:93], v[92:93], s[28:29], v[24:25]
    v_pk_fma_f32 v[94:95], v[94:95], s[28:29], v[24:25]
    v_pk_mul_f32 v[80:81], v[80:81], v[208:209]
    v_pk_mul_f32 v[82:83], v[82:83], v[210:211]
    v_pk_mul_f32 v[84:85], v[84:85], v[212:213]
    v_pk_mul_f32 v[86:87], v[86:87], v[214:215]
    v_pk_mul_f32 v[88:89], v[88:89], v[216:217]
    v_pk_mul_f32 v[90:91], v[90:91], v[218:219]
    v_pk_mul_f32 v[92:93], v[92:93], v[220:221]
    v_pk_mul_f32 v[94:95], v[94:95], v[222:223]
    v_exp_f32 v80, v80
    v_exp_f32 v81, v81
    v_exp_f32 v82, v82
    v_exp_f32 v83, v83
    v_exp_f32 v84, v84
    v_exp_f32 v85, v85
    v_exp_f32 v86, v86
    v_exp_f32 v87, v87
    v_exp_f32 v88, v88
    v_exp_f32 v89, v89
    v_exp_f32 v90, v90
    v_exp_f32 v91, v91
    v_exp_f32 v92, v92
    v_exp_f32 v93, v93
    v_exp_f32 v94, v94
    v_exp_f32 v95, v95
    v_pk_mul_f32 v[64:65], v[64:65], v[208:209]
    v_pk_mul_f32 v[66:67], v[66:67], v[210:211]
    v_pk_mul_f32 v[68:69], v[68:69], v[212:213]
    v_pk_mul_f32 v[70:71], v[70:71], v[214:215]
    v_pk_mul_f32 v[72:73], v[72:73], v[216:217]
    v_pk_mul_f32 v[74:75], v[74:75], v[218:219]
    v_pk_mul_f32 v[76:77], v[76:77], v[220:221]
    v_pk_mul_f32 v[78:79], v[78:79], v[222:223]
    v_pk_add_f32 v[80:81], v[80:81], 1.0 op_sel_hi:[1,0]
    v_pk_add_f32 v[82:83], v[82:83], 1.0 op_sel_hi:[1,0]
    v_pk_add_f32 v[84:85], v[84:85], 1.0 op_sel_hi:[1,0]
    v_pk_add_f32 v[86:87], v[86:87], 1.0 op_sel_hi:[1,0]
    v_pk_add_f32 v[88:89], v[88:89], 1.0 op_sel_hi:[1,0]
    v_pk_add_f32 v[90:91], v[90:91], 1.0 op_sel_hi:[1,0]
    v_pk_add_f32 v[92:93], v[92:93], 1.0 op_sel_hi:[1,0]
    v_pk_add_f32 v[94:95], v[94:95], 1.0 op_sel_hi:[1,0]
    v_rcp_f32 v80, v80
    v_rcp_f32 v81, v81
    v_rcp_f32 v82, v82
    v_rcp_f32 v83, v83
    v_rcp_f32 v84, v84
    v_rcp_f32 v85, v85
    v_rcp_f32 v86, v86
    v_rcp_f32 v87, v87
    v_rcp_f32 v88, v88
    v_rcp_f32 v89, v89
    v_rcp_f32 v90, v90
    v_rcp_f32 v91, v91
    v_rcp_f32 v92, v92
    v_rcp_f32 v93, v93
    v_rcp_f32 v94, v94
    v_rcp_f32 v95, v95
    s_nop 0
    v_pk_mul_f32 v[64:65], v[64:65], v[80:81]
    v_pk_mul_f32 v[66:67], v[66:67], v[82:83]
    v_pk_mul_f32 v[68:69], v[68:69], v[84:85]
    v_pk_mul_f32 v[70:71], v[70:71], v[86:87]
    v_pk_mul_f32 v[72:73], v[72:73], v[88:89]
    v_pk_mul_f32 v[74:75], v[74:75], v[90:91]
    v_pk_mul_f32 v[76:77], v[76:77], v[92:93]
    v_pk_mul_f32 v[78:79], v[78:79], v[94:95]
    v_cvt_pk_bf16_f32 v208, v64, v65
    v_cvt_pk_bf16_f32 v209, v66, v67
    v_cvt_pk_bf16_f32 v210, v68, v69
    v_cvt_pk_bf16_f32 v211, v70, v71
    v_cvt_pk_bf16_f32 v212, v72, v73
    v_cvt_pk_bf16_f32 v213, v74, v75
    v_cvt_pk_bf16_f32 v214, v76, v77
    v_cvt_pk_bf16_f32 v215, v78, v79
    s_add_u32 s31, s86, 459776
    buffer_store_dwordx4 v[208:211], v104, s[12:15], s31 offen sc1
    s_add_u32 s31, s86, 461824
    buffer_store_dwordx4 v[212:215], v104, s[12:15], s31 offen sc1
    ds_write_b128 v29, v[208:211] offset:17408
    ds_write_b128 v29, v[212:215] offset:19456
    v_accvgpr_read_b32 v32, a96
    v_accvgpr_read_b32 v33, a97
    v_accvgpr_read_b32 v34, a98
    v_accvgpr_read_b32 v35, a99
    v_accvgpr_read_b32 v36, a100
    v_accvgpr_read_b32 v37, a101
    v_accvgpr_read_b32 v38, a102
    v_accvgpr_read_b32 v39, a103
    v_accvgpr_read_b32 v40, a104
    v_accvgpr_read_b32 v41, a105
    v_accvgpr_read_b32 v42, a106
    v_accvgpr_read_b32 v43, a107
    v_accvgpr_read_b32 v44, a108
    v_accvgpr_read_b32 v45, a109
    v_accvgpr_read_b32 v46, a110
    v_accvgpr_read_b32 v47, a111
    v_pk_mul_f32 v[48:49], v[224:225], v[224:225]
    v_pk_mul_f32 v[50:51], v[226:227], v[226:227]
    v_pk_mul_f32 v[52:53], v[228:229], v[228:229]
    v_pk_mul_f32 v[54:55], v[230:231], v[230:231]
    v_pk_mul_f32 v[56:57], v[232:233], v[232:233]
    v_pk_mul_f32 v[58:59], v[234:235], v[234:235]
    v_pk_mul_f32 v[60:61], v[236:237], v[236:237]
    v_pk_mul_f32 v[62:63], v[238:239], v[238:239]
    v_pk_fma_f32 v[48:49], v[48:49], s[28:29], v[24:25]
    v_pk_fma_f32 v[50:51], v[50:51], s[28:29], v[24:25]
    v_pk_fma_f32 v[52:53], v[52:53], s[28:29], v[24:25]
    v_pk_fma_f32 v[54:55], v[54:55], s[28:29], v[24:25]
    v_pk_fma_f32 v[56:57], v[56:57], s[28:29], v[24:25]
    v_pk_fma_f32 v[58:59], v[58:59], s[28:29], v[24:25]
    v_pk_fma_f32 v[60:61], v[60:61], s[28:29], v[24:25]
    v_pk_fma_f32 v[62:63], v[62:63], s[28:29], v[24:25]
    v_pk_mul_f32 v[48:49], v[48:49], v[224:225]
    v_pk_mul_f32 v[50:51], v[50:51], v[226:227]
    v_pk_mul_f32 v[52:53], v[52:53], v[228:229]
    v_pk_mul_f32 v[54:55], v[54:55], v[230:231]
    v_pk_mul_f32 v[56:57], v[56:57], v[232:233]
    v_pk_mul_f32 v[58:59], v[58:59], v[234:235]
    v_pk_mul_f32 v[60:61], v[60:61], v[236:237]
    v_pk_mul_f32 v[62:63], v[62:63], v[238:239]
    v_exp_f32 v48, v48
    v_exp_f32 v49, v49
    v_exp_f32 v50, v50
    v_exp_f32 v51, v51
    v_exp_f32 v52, v52
    v_exp_f32 v53, v53
    v_exp_f32 v54, v54
    v_exp_f32 v55, v55
    v_exp_f32 v56, v56
    v_exp_f32 v57, v57
    v_exp_f32 v58, v58
    v_exp_f32 v59, v59
    v_exp_f32 v60, v60
    v_exp_f32 v61, v61
    v_exp_f32 v62, v62
    v_exp_f32 v63, v63
    v_pk_mul_f32 v[32:33], v[32:33], v[224:225]
    v_pk_mul_f32 v[34:35], v[34:35], v[226:227]
    v_pk_mul_f32 v[36:37], v[36:37], v[228:229]
    v_pk_mul_f32 v[38:39], v[38:39], v[230:231]
    v_pk_mul_f32 v[40:41], v[40:41], v[232:233]
    v_pk_mul_f32 v[42:43], v[42:43], v[234:235]
    v_pk_mul_f32 v[44:45], v[44:45], v[236:237]
    v_pk_mul_f32 v[46:47], v[46:47], v[238:239]
    v_pk_add_f32 v[48:49], v[48:49], 1.0 op_sel_hi:[1,0]
    v_pk_add_f32 v[50:51], v[50:51], 1.0 op_sel_hi:[1,0]
    v_pk_add_f32 v[52:53], v[52:53], 1.0 op_sel_hi:[1,0]
    v_pk_add_f32 v[54:55], v[54:55], 1.0 op_sel_hi:[1,0]
    v_pk_add_f32 v[56:57], v[56:57], 1.0 op_sel_hi:[1,0]
    v_pk_add_f32 v[58:59], v[58:59], 1.0 op_sel_hi:[1,0]
    v_pk_add_f32 v[60:61], v[60:61], 1.0 op_sel_hi:[1,0]
    v_pk_add_f32 v[62:63], v[62:63], 1.0 op_sel_hi:[1,0]
    v_rcp_f32 v48, v48
    v_rcp_f32 v49, v49
    v_rcp_f32 v50, v50
    v_rcp_f32 v51, v51
    v_rcp_f32 v52, v52
    v_rcp_f32 v53, v53
    v_rcp_f32 v54, v54
    v_rcp_f32 v55, v55
    v_rcp_f32 v56, v56
    v_rcp_f32 v57, v57
    v_rcp_f32 v58, v58
    v_rcp_f32 v59, v59
    v_rcp_f32 v60, v60
    v_rcp_f32 v61, v61
    v_rcp_f32 v62, v62
    v_rcp_f32 v63, v63
    s_nop 0
    v_pk_mul_f32 v[32:33], v[32:33], v[48:49]
    v_pk_mul_f32 v[34:35], v[34:35], v[50:51]
    v_pk_mul_f32 v[36:37], v[36:37], v[52:53]
    v_pk_mul_f32 v[38:39], v[38:39], v[54:55]
    v_pk_mul_f32 v[40:41], v[40:41], v[56:57]
    v_pk_mul_f32 v[42:43], v[42:43], v[58:59]
    v_pk_mul_f32 v[44:45], v[44:45], v[60:61]
    v_pk_mul_f32 v[46:47], v[46:47], v[62:63]
    v_cvt_pk_bf16_f32 v224, v32, v33
    v_cvt_pk_bf16_f32 v225, v34, v35
    v_cvt_pk_bf16_f32 v226, v36, v37
    v_cvt_pk_bf16_f32 v227, v38, v39
    v_cvt_pk_bf16_f32 v228, v40, v41
    v_cvt_pk_bf16_f32 v229, v42, v43
    v_cvt_pk_bf16_f32 v230, v44, v45
    v_cvt_pk_bf16_f32 v231, v46, v47
    s_add_u32 s31, s86, 688128
    buffer_store_dwordx4 v[224:227], v104, s[12:15], s31 offen sc1
    s_add_u32 s31, s86, 690176
    buffer_store_dwordx4 v[228:231], v104, s[12:15], s31 offen sc1
    ds_write_b128 v29, v[224:227] offset:24576
    ds_write_b128 v29, v[228:231] offset:26624
    v_mfma_f32_32x32x16_bf16 a[64:79], v[2:5], v[2:5], 0
    v_mfma_f32_32x32x16_bf16 a[80:95], v[2:5], v[2:5], 0
    v_mfma_f32_32x32x16_bf16 a[96:111], v[2:5], v[2:5], 0
    v_accvgpr_read_b32 v64, a112
    v_accvgpr_read_b32 v65, a113
    v_accvgpr_read_b32 v66, a114
    v_accvgpr_read_b32 v67, a115
    v_accvgpr_read_b32 v68, a116
    v_accvgpr_read_b32 v69, a117
    v_accvgpr_read_b32 v70, a118
    v_accvgpr_read_b32 v71, a119
    v_accvgpr_read_b32 v72, a120
    v_accvgpr_read_b32 v73, a121
    v_accvgpr_read_b32 v74, a122
    v_accvgpr_read_b32 v75, a123
    v_accvgpr_read_b32 v76, a124
    v_accvgpr_read_b32 v77, a125
    v_accvgpr_read_b32 v78, a126
    v_accvgpr_read_b32 v79, a127
    v_pk_mul_f32 v[80:81], v[240:241], v[240:241]
    v_pk_mul_f32 v[82:83], v[242:243], v[242:243]
    v_pk_mul_f32 v[84:85], v[244:245], v[244:245]
    v_pk_mul_f32 v[86:87], v[246:247], v[246:247]
    v_pk_mul_f32 v[88:89], v[248:249], v[248:249]
    v_pk_mul_f32 v[90:91], v[250:251], v[250:251]
    v_pk_mul_f32 v[92:93], v[252:253], v[252:253]
    v_pk_mul_f32 v[94:95], v[254:255], v[254:255]
    v_pk_fma_f32 v[80:81], v[80:81], s[28:29], v[24:25]
    v_pk_fma_f32 v[82:83], v[82:83], s[28:29], v[24:25]
    v_pk_fma_f32 v[84:85], v[84:85], s[28:29], v[24:25]
    v_pk_fma_f32 v[86:87], v[86:87], s[28:29], v[24:25]
    v_pk_fma_f32 v[88:89], v[88:89], s[28:29], v[24:25]
    v_pk_fma_f32 v[90:91], v[90:91], s[28:29], v[24:25]
    v_pk_fma_f32 v[92:93], v[92:93], s[28:29], v[24:25]
    v_pk_fma_f32 v[94:95], v[94:95], s[28:29], v[24:25]
    v_pk_mul_f32 v[80:81], v[80:81], v[240:241]
    v_pk_mul_f32 v[82:83], v[82:83], v[242:243]
    v_pk_mul_f32 v[84:85], v[84:85], v[244:245]
    v_pk_mul_f32 v[86:87], v[86:87], v[246:247]
    v_pk_mul_f32 v[88:89], v[88:89], v[248:249]
    v_pk_mul_f32 v[90:91], v[90:91], v[250:251]
    v_pk_mul_f32 v[92:93], v[92:93], v[252:253]
    v_pk_mul_f32 v[94:95], v[94:95], v[254:255]
    v_exp_f32 v80, v80
    v_exp_f32 v81, v81
    v_exp_f32 v82, v82
    v_exp_f32 v83, v83
    v_exp_f32 v84, v84
    v_exp_f32 v85, v85
    v_exp_f32 v86, v86
    v_exp_f32 v87, v87
    v_exp_f32 v88, v88
    v_exp_f32 v89, v89
    v_exp_f32 v90, v90
    v_exp_f32 v91, v91
    v_exp_f32 v92, v92
    v_exp_f32 v93, v93
    v_exp_f32 v94, v94
    v_exp_f32 v95, v95
    v_pk_mul_f32 v[64:65], v[64:65], v[240:241]
    v_pk_mul_f32 v[66:67], v[66:67], v[242:243]
    v_pk_mul_f32 v[68:69], v[68:69], v[244:245]
    v_pk_mul_f32 v[70:71], v[70:71], v[246:247]
    v_pk_mul_f32 v[72:73], v[72:73], v[248:249]
    v_pk_mul_f32 v[74:75], v[74:75], v[250:251]
    v_pk_mul_f32 v[76:77], v[76:77], v[252:253]
    v_pk_mul_f32 v[78:79], v[78:79], v[254:255]
    v_pk_add_f32 v[80:81], v[80:81], 1.0 op_sel_hi:[1,0]
    v_pk_add_f32 v[82:83], v[82:83], 1.0 op_sel_hi:[1,0]
    v_pk_add_f32 v[84:85], v[84:85], 1.0 op_sel_hi:[1,0]
    v_pk_add_f32 v[86:87], v[86:87], 1.0 op_sel_hi:[1,0]
    v_pk_add_f32 v[88:89], v[88:89], 1.0 op_sel_hi:[1,0]
    v_pk_add_f32 v[90:91], v[90:91], 1.0 op_sel_hi:[1,0]
    v_pk_add_f32 v[92:93], v[92:93], 1.0 op_sel_hi:[1,0]
    v_pk_add_f32 v[94:95], v[94:95], 1.0 op_sel_hi:[1,0]
    v_rcp_f32 v80, v80
    v_rcp_f32 v81, v81
    v_rcp_f32 v82, v82
    v_rcp_f32 v83, v83
    v_rcp_f32 v84, v84
    v_rcp_f32 v85, v85
    v_rcp_f32 v86, v86
    v_rcp_f32 v87, v87
    v_rcp_f32 v88, v88
    v_rcp_f32 v89, v89
    v_rcp_f32 v90, v90
    v_rcp_f32 v91, v91
    v_rcp_f32 v92, v92
    v_rcp_f32 v93, v93
    v_rcp_f32 v94, v94
    v_rcp_f32 v95, v95
    s_nop 0
    v_pk_mul_f32 v[64:65], v[64:65], v[80:81]
    v_pk_mul_f32 v[66:67], v[66:67], v[82:83]
    v_pk_mul_f32 v[68:69], v[68:69], v[84:85]
    v_pk_mul_f32 v[70:71], v[70:71], v[86:87]
    v_pk_mul_f32 v[72:73], v[72:73], v[88:89]
    v_pk_mul_f32 v[74:75], v[74:75], v[90:91]
    v_pk_mul_f32 v[76:77], v[76:77], v[92:93]
    v_pk_mul_f32 v[78:79], v[78:79], v[94:95]
    v_cvt_pk_bf16_f32 v240, v64, v65
    v_cvt_pk_bf16_f32 v241, v66, v67
    v_cvt_pk_bf16_f32 v242, v68, v69
    v_cvt_pk_bf16_f32 v243, v70, v71
    v_cvt_pk_bf16_f32 v244, v72, v73
    v_cvt_pk_bf16_f32 v245, v74, v75
    v_cvt_pk_bf16_f32 v246, v76, v77
    v_cvt_pk_bf16_f32 v247, v78, v79
    s_add_u32 s31, s86, 689152
    buffer_store_dwordx4 v[240:243], v104, s[12:15], s31 offen sc1
    s_add_u32 s31, s86, 691200
    buffer_store_dwordx4 v[244:247], v104, s[12:15], s31 offen sc1
    ds_write_b128 v29, v[240:243] offset:25600
    ds_write_b128 v29, v[244:247] offset:27648
    v_mfma_f32_32x32x16_bf16 a[112:127], v[2:5], v[2:5], 0
    s_mov_b32 s87, 1073741824
    s_mov_b32 s30, 0
    s_lshl_b32 s26, s3, 14
    s_lshr_b32 s27, s96, 1
    s_lshl_b32 s27, s27, 13
    s_add_u32 s26, s26, 98304
    s_add_u32 s27, s27, s26
    v_add_u32 v29, s27, v104
    v_xor_b32 v10, 8192, v29
    s_waitcnt vmcnt(16) lgkmcnt(0)
    s_barrier
    ds_read_b128 v[128:131], v29 offset:0
    ds_read_b128 v[132:135], v29 offset:1024
    ds_read_b128 v[136:139], v10 offset:0
    ds_read_b128 v[140:143], v10 offset:1024
    ds_read_b128 v[144:147], v29 offset:2048
    ds_read_b128 v[148:151], v29 offset:3072
    ds_read_b128 v[152:155], v10 offset:2048
    ds_read_b128 v[156:159], v10 offset:3072
    ds_read_b128 v[160:163], v29 offset:4096
    ds_read_b128 v[164:167], v29 offset:5120
    ds_read_b128 v[168:171], v10 offset:4096
    ds_read_b128 v[172:175], v10 offset:5120
    ds_read_b128 v[176:179], v29 offset:6144
    ds_read_b128 v[180:183], v29 offset:7168
    ds_read_b128 v[184:187], v10 offset:6144
    ds_read_b128 v[188:191], v10 offset:7168
    s_branch L_g2
L_dft:
    s_waitcnt lgkmcnt(0)
    s_mov_b32 s4, s40
    s_and_b32 s5, s41, 0xffff
    s_mov_b32 s6, 4194304
    s_mov_b32 s7, 0x20000
    s_mov_b32 s32, s60
    s_and_b32 s33, s61, 0xffff
    s_mov_b32 s34, 2048
    s_mov_b32 s35, 0x20000
    v_lshlrev_b32 v2, 4, v1
    v_sub_u32 v3, 2032, v2
    s_mov_b32 s26, 0x100000
    s_mov_b32 s27, 0x300000
    buffer_load_dwordx4 v[128:131], v2, s[4:7], s26 offen
    buffer_load_dwordx4 v[132:135], v3, s[4:7], s26 offen
    buffer_load_dwordx4 v[140:143], v2, s[4:7], s27 offen
    buffer_load_dwordx4 v[144:147], v3, s[4:7], s27 offen

    s_lshl_b32 s26, s66, 2
    s_add_u32 s26, s26, s67
    s_lshl_b32 s26, s26, 4
    v_lshrrev_b32 v40, 3, v1
    v_add_u32 v40, s26, v40
    v_cmp_eq_u32 s[62:63], 0, v40
    v_and_b32 v2, 7, v1
    v_cmp_eq_u32 s[70:71], 0, v2
    v_add_u32 v44, 8, v40
    v_lshlrev_b32 v2, 4, v2
    s_lshl_b32 s26, s3, 8
    v_add_u32 v2, s26, v2
    v_sub_u32 v3, 1904, v2
    v_sub_u32 v41, 2048, v40
    v_sub_u32 v42, 1024, v40
    v_add_u32 v43, 1024, v40
    v_sub_u32 v45, 2048, v44
    v_sub_u32 v46, 1024, v44
    v_add_u32 v47, 1024, v44
    v_mov_b32 v4, 512
    v_mov_b32 v5, 1536
    v_cndmask_b32 v41, v41, v4, s[62:63]
    v_cndmask_b32 v43, v43, v5, s[62:63]
    s_sub_u32 s74, 2048, s26

    v_lshl_add_u32 v224, v40, 11, v2
    v_lshl_add_u32 v228, v40, 11, v3
    v_lshl_add_u32 v225, v41, 11, v2
    v_lshl_add_u32 v229, v41, 11, v3
    v_lshl_add_u32 v226, v42, 11, v2
    v_lshl_add_u32 v230, v42, 11, v3
    v_lshl_add_u32 v227, v43, 11, v2
    v_lshl_add_u32 v231, v43, 11, v3
    v_lshl_add_u32 v232, v44, 11, v2
    v_lshl_add_u32 v236, v44, 11, v3
    v_lshl_add_u32 v233, v45, 11, v2
    v_lshl_add_u32 v237, v45, 11, v3
    v_lshl_add_u32 v234, v46, 11, v2
    v_lshl_add_u32 v238, v46, 11, v3
    v_lshl_add_u32 v235, v47, 11, v2
    v_lshl_add_u32 v239, v47, 11, v3
    buffer_load_dwordx4 v[192:195], v2, s[32:35], 0 offen offset:0
    buffer_load_dwordx4 v[196:199], v3, s[32:35], 0 offen offset:128
    buffer_load_dwordx4 v[200:203], v2, s[32:35], 0 offen offset:128
    buffer_load_dwordx4 v[204:207], v3, s[32:35], 0 offen offset:0
    buffer_load_dwordx4 v[64:67], v224, s[4:7], 0 offen offset:0
    buffer_load_dwordx4 v[68:71], v228, s[4:7], 0 offen offset:128
    buffer_load_dwordx4 v[72:75], v225, s[4:7], 0 offen offset:0
    buffer_load_dwordx4 v[76:79], v229, s[4:7], 0 offen offset:128
    buffer_load_dwordx4 v[80:83], v226, s[4:7], 0 offen offset:0
    buffer_load_dwordx4 v[84:87], v230, s[4:7], 0 offen offset:128
    buffer_load_dwordx4 v[88:91], v227, s[4:7], 0 offen offset:0
    buffer_load_dwordx4 v[92:95], v231, s[4:7], 0 offen offset:128
    v_lshlrev_b32 v4, 11, v40
    buffer_load_ushort v208, v4, s[4:7], s74 offen
    v_lshlrev_b32 v4, 11, v41
    buffer_load_ushort v209, v4, s[4:7], s74 offen
    v_lshlrev_b32 v4, 11, v42
    buffer_load_ushort v210, v4, s[4:7], s74 offen
    v_lshlrev_b32 v4, 11, v43
    buffer_load_ushort v211, v4, s[4:7], s74 offen
    buffer_load_dwordx4 v[96:99], v224, s[4:7], 0 offen offset:128
    buffer_load_dwordx4 v[100:103], v228, s[4:7], 0 offen offset:0
    buffer_load_dwordx4 v[104:107], v225, s[4:7], 0 offen offset:128
    buffer_load_dwordx4 v[108:111], v229, s[4:7], 0 offen offset:0
    buffer_load_dwordx4 v[112:115], v226, s[4:7], 0 offen offset:128
    buffer_load_dwordx4 v[116:119], v230, s[4:7], 0 offen offset:0
    buffer_load_dwordx4 v[120:123], v227, s[4:7], 0 offen offset:128
    buffer_load_dwordx4 v[124:127], v231, s[4:7], 0 offen offset:0
    s_add_u32 s28, s48, 26214400
    s_addc_u32 s29, s49, 0
    s_load_dword s98, s[28:29], 0
    s_mov_b32 s12, s48
    s_and_b32 s13, s49, 0xffff
    s_mov_b32 s14, 268435456
    s_mov_b32 s15, 0x20000
    s_lshr_b32 s27, s2, 3
    s_and_b32 s50, s2, 1
    s_lshl_b32 s50, s50, 2
    s_and_b32 s26, s27, 3
    s_add_u32 s50, s50, s26
    s_lshr_b32 s51, s27, 2
    s_bfe_u32 s96, s2, 0x20001

    s_lshr_b32 s30, s66, 2
    s_cmp_eq_u32 s30, 0
    s_cselect_b32 s26, s56, s58
    s_cselect_b32 s27, s57, s59
    s_mov_b32 s8, s26
    s_and_b32 s9, s27, 0xffff
    s_mov_b32 s10, 2097152
    s_mov_b32 s11, 0x20000
    s_and_b32 s25, s66, 3
    s_lshl_b32 s25, s25, 18
    s_lshl_b32 s21, s3, 12
    v_lshrrev_b32 v2, 3, v1
    s_lshl_b32 s26, s3, 5
    v_add_u32 v2, s26, v2
    v_lshlrev_b32 v2, 11, v2
    v_add_u32 v2, s25, v2
    v_lshrrev_b32 v3, 4, v1
    v_and_b32 v4, 7, v1
    v_xor_b32 v3, v3, v4
    v_lshl_add_u32 v32, v3, 4, v2
    v_xor_b32 v3, 4, v3
    v_lshl_add_u32 v33, v3, 4, v2
    v_add_u32 v34, 30720, v32
    v_add_u32 v35, 46080, v33
    v_add_u32 v33, 15360, v33

    s_mov_b32 s36, s52
    s_and_b32 s37, s53, 0xffff
    s_mov_b32 s38, 8388608
    s_mov_b32 s39, 0x20000
    s_mov_b32 s80, s54
    s_and_b32 s81, s55, 0xffff
    s_mov_b32 s82, 8388608
    s_mov_b32 s83, 0x20000
    s_and_b32 s24, s66, 3
    s_lshl_b32 s24, s24, 8
    s_add_u32 s24, s24, s30
    s_lshl_b32 s24, s24, 12
    s_waitcnt lgkmcnt(0)
    s_mov_b32 s17, 0
    s_mul_i32 s98, s98, 0x9E3779B1
    s_add_u32 s98, s98, 0x7F4A7C15
    s_xor_b32 s99, s98, 0x5bd1e995
    s_cmp_lg_u32 s3, 0
    s_cbranch_scc1 L_st0_2536
    s_lshl_b32 s26, s2, 7
    s_add_u32 s26, s26, 26607616
    v_lshlrev_b32 v2, 3, v1
    v_mov_b32 v4, s98
    v_mov_b32 v5, s99
    s_mov_b64 exec, 65535
    buffer_store_dwordx2 v[4:5], v2, s[12:15], s26 offen sc1
    s_mov_b64 exec, -1

L_st0_2536:
    s_waitcnt vmcnt(24)
    v_mov_b32 v136, 0
    v_mov_b32 v148, 0
    s_cmp_eq_u32 s30, 0
    s_cselect_b32 s26, 1.0, -1.0
    v_mov_b32_dpp v136, v132 wave_shr:1 row_mask:0xf bank_mask:0xf
    v_mov_b32_dpp v148, v144 wave_shr:1 row_mask:0xf bank_mask:0xf
    v_lshlrev_b32 v160, 16, v128
    v_and_b32 v161, 0xffff0000, v128
    v_lshlrev_b32 v162, 16, v129
    v_and_b32 v163, 0xffff0000, v129
    v_lshlrev_b32 v164, 16, v130
    v_and_b32 v165, 0xffff0000, v130
    v_lshlrev_b32 v166, 16, v131
    v_and_b32 v167, 0xffff0000, v131
    v_lshlrev_b32 v168, 16, v136
    v_and_b32 v169, 0xffff0000, v135
    v_lshlrev_b32 v170, 16, v135
    v_and_b32 v171, 0xffff0000, v134
    v_lshlrev_b32 v172, 16, v134
    v_and_b32 v173, 0xffff0000, v133
    v_lshlrev_b32 v174, 16, v133
    v_and_b32 v175, 0xffff0000, v132
    v_lshlrev_b32 v176, 16, v140
    v_and_b32 v177, 0xffff0000, v140
    v_lshlrev_b32 v178, 16, v141
    v_and_b32 v179, 0xffff0000, v141
    v_lshlrev_b32 v180, 16, v142
    v_and_b32 v181, 0xffff0000, v142
    v_lshlrev_b32 v182, 16, v143
    v_and_b32 v183, 0xffff0000, v143
    v_lshlrev_b32 v184, 16, v148
    v_and_b32 v185, 0xffff0000, v147
    v_lshlrev_b32 v186, 16, v147
    v_and_b32 v187, 0xffff0000, v146
    v_lshlrev_b32 v188, 16, v146
    v_and_b32 v189, 0xffff0000, v145
    v_lshlrev_b32 v190, 16, v145
    v_and_b32 v191, 0xffff0000, v144
    v_fma_f32 v160, v176, s26, v160
    v_fma_f32 v161, v177, s26, v161
    v_fma_f32 v162, v178, s26, v162
    v_fma_f32 v163, v179, s26, v163
    v_fma_f32 v164, v180, s26, v164
    v_fma_f32 v165, v181, s26, v165
    v_fma_f32 v166, v182, s26, v166
    v_fma_f32 v167, v183, s26, v167
    v_fma_f32 v168, v184, s26, v168
    v_fma_f32 v169, v185, s26, v169
    v_fma_f32 v170, v186, s26, v170
    v_fma_f32 v171, v187, s26, v171
    v_fma_f32 v172, v188, s26, v172
    v_fma_f32 v173, v189, s26, v173
    v_fma_f32 v174, v190, s26, v174
    v_fma_f32 v175, v191, s26, v175
    v_fma_f32 v160, v168, s26, v160
    v_fma_f32 v161, v169, s26, v161
    v_fma_f32 v162, v170, s26, v162
    v_fma_f32 v163, v171, s26, v163
    v_fma_f32 v164, v172, s26, v164
    v_fma_f32 v165, v173, s26, v165
    v_fma_f32 v166, v174, s26, v166
    v_fma_f32 v167, v175, s26, v167
    v_cvt_pk_bf16_f32 v36, v160, v161
    v_cvt_pk_bf16_f32 v37, v162, v163
    v_cvt_pk_bf16_f32 v38, v164, v165
    v_cvt_pk_bf16_f32 v39, v166, v167
    v_lshlrev_b32 v2, 16, v132
    v_lshlrev_b32 v3, 16, v144
    v_add_f32 v2, v2, v3
    s_nop 0
    v_readlane_b32 s75, v2, 63
    s_cselect_b32 s75, s75, 0
    v_pk_add_f32 v[160:161], v[160:161], v[162:163]
    v_pk_add_f32 v[164:165], v[164:165], v[166:167]
    v_pk_add_f32 v[160:161], v[160:161], v[164:165]
    v_sub_f32 v160, v160, v161
    s_nop 1
    v_add_f32_dpp v160, v160, v160 row_ror:1 row_mask:0xf bank_mask:0xf
    s_nop 1
    v_add_f32_dpp v160, v160, v160 row_ror:2 row_mask:0xf bank_mask:0xf
    s_nop 1
    v_add_f32_dpp v160, v160, v160 row_ror:4 row_mask:0xf bank_mask:0xf
    s_nop 1
    v_add_f32_dpp v160, v160, v160 row_ror:8 row_mask:0xf bank_mask:0xf
    v_mov_b32 v176, v160
    s_nop 1
    v_permlane16_swap_b32 v160, v176
    s_nop 1
    v_add_f32 v160, v160, v176
    v_mov_b32 v176, v160
    s_nop 1
    v_permlane32_swap_b32 v160, v176
    s_nop 1
    v_add_f32 v160, v160, v176
    v_add_f32 v160, s75, v160
    s_nop 0
    v_readfirstlane_b32 s97, v160
    v_mov_b32 v24, 3212853120
    v_mov_b32 v8, 0
    v_mov_b32 v9, 0
    v_mov_b32 v10, 0
    v_mov_b32 v11, 0
    v_mov_b32 v12, 0
    v_mov_b32 v13, 0
    v_mov_b32 v14, 0
    v_mov_b32 v15, 0
    v_mov_b32 v16, 0
    v_mov_b32 v17, 0
    v_mov_b32 v18, 0
    v_mov_b32 v19, 0
    v_mov_b32 v20, 0
    v_mov_b32 v21, 0
    v_mov_b32 v22, 0
    v_mov_b32 v23, 0
    s_lshl_b32 s26, s66, 2
    s_add_u32 s26, s26, s67
    s_lshr_b32 s27, s26, 2
    s_lshl_b32 s27, s27, 16
    s_and_b32 s26, s26, 3
    s_lshl_b32 s26, s26, 10
    s_add_u32 s26, s26, s27
    s_lshl_b32 s27, s3, 14
    s_add_u32 s26, s26, s27
    s_add_u32 s22, s26, 16842752
    v_bfe_u32 v2, v1, 2, 1
    v_lshlrev_b32 v25, 12, v2
    v_and_b32 v2, 3, v1
    v_lshl_add_u32 v25, v2, 8, v25
    v_lshrrev_b32 v2, 3, v1
    v_lshl_add_u32 v25, v2, 4, v25
    s_cmp_eq_u32 s3, 0
    s_cselect_b64 s[72:73], s[70:71], 0

    s_waitcnt vmcnt(8)
    v_dot2_f32_bf16 v8, v64, v192, v8
    v_dot2_f32_bf16 v9, v72, v192, v9
    v_dot2_f32_bf16 v10, v80, v192, v10
    v_dot2_f32_bf16 v11, v88, v192, v11
    v_dot2_f32_bf16 v8, v68, v196, v8
    v_dot2_f32_bf16 v9, v76, v196, v9
    v_dot2_f32_bf16 v10, v84, v196, v10
    v_dot2_f32_bf16 v11, v92, v196, v11
    v_dot2_f32_bf16 v8, v65, v193, v8
    v_dot2_f32_bf16 v9, v73, v193, v9
    v_dot2_f32_bf16 v10, v81, v193, v10
    v_dot2_f32_bf16 v11, v89, v193, v11
    v_dot2_f32_bf16 v8, v69, v197, v8
    v_dot2_f32_bf16 v9, v77, v197, v9
    v_dot2_f32_bf16 v10, v85, v197, v10
    v_dot2_f32_bf16 v11, v93, v197, v11
    v_dot2_f32_bf16 v8, v66, v194, v8
    v_dot2_f32_bf16 v9, v74, v194, v9
    v_dot2_f32_bf16 v10, v82, v194, v10
    v_dot2_f32_bf16 v11, v90, v194, v11
    v_dot2_f32_bf16 v8, v70, v198, v8
    v_dot2_f32_bf16 v9, v78, v198, v9
    v_dot2_f32_bf16 v10, v86, v198, v10
    v_dot2_f32_bf16 v11, v94, v198, v11
    v_dot2_f32_bf16 v8, v67, v195, v8
    v_dot2_f32_bf16 v9, v75, v195, v9
    v_dot2_f32_bf16 v10, v83, v195, v10
    v_dot2_f32_bf16 v11, v91, v195, v11
    v_dot2_f32_bf16 v8, v71, v199, v8
    v_dot2_f32_bf16 v9, v79, v199, v9
    v_dot2_f32_bf16 v10, v87, v199, v10
    v_dot2_f32_bf16 v11, v95, v199, v11
    v_cndmask_b32 v72, v72, 0, s[62:63]
    v_cndmask_b32 v73, v73, 0, s[62:63]
    v_cndmask_b32 v74, v74, 0, s[62:63]
    v_cndmask_b32 v75, v75, 0, s[62:63]
    v_cndmask_b32 v76, v76, 0, s[62:63]
    v_cndmask_b32 v77, v77, 0, s[62:63]
    v_cndmask_b32 v78, v78, 0, s[62:63]
    v_cndmask_b32 v79, v79, 0, s[62:63]
    v_cndmask_b32 v209, v209, 0, s[62:63]
    v_cndmask_b32 v88, v88, 0, s[62:63]
    v_cndmask_b32 v89, v89, 0, s[62:63]
    v_cndmask_b32 v90, v90, 0, s[62:63]
    v_cndmask_b32 v91, v91, 0, s[62:63]
    v_cndmask_b32 v92, v92, 0, s[62:63]
    v_cndmask_b32 v93, v93, 0, s[62:63]
    v_cndmask_b32 v94, v94, 0, s[62:63]
    v_cndmask_b32 v95, v95, 0, s[62:63]
    v_cndmask_b32 v211, v211, 0, s[62:63]
    v_cndmask_b32 v208, v208, 0, s[72:73]
    v_cndmask_b32 v209, v209, 0, s[72:73]
    v_cndmask_b32 v210, v210, 0, s[72:73]
    v_cndmask_b32 v211, v211, 0, s[72:73]
    v_mov_b32 v216, v68
    v_mov_b32 v217, v76
    v_mov_b32 v218, v84
    v_mov_b32 v219, v92
    v_mov_b32_dpp v220, v68 row_shr:1 row_mask:0xf bank_mask:0xf
    v_mov_b32_dpp v221, v76 row_shr:1 row_mask:0xf bank_mask:0xf
    v_mov_b32_dpp v222, v84 row_shr:1 row_mask:0xf bank_mask:0xf
    v_mov_b32_dpp v223, v92 row_shr:1 row_mask:0xf bank_mask:0xf
    v_cndmask_b32 v220, v220, v208, s[70:71]
    v_cndmask_b32 v221, v221, v209, s[70:71]
    v_cndmask_b32 v222, v222, v210, s[70:71]
    v_cndmask_b32 v223, v223, v211, s[70:71]
    v_lshlrev_b32 v240, 16, v64
    v_and_b32 v241, 0xffff0000, v64
    v_lshlrev_b32 v242, 16, v65
    v_and_b32 v243, 0xffff0000, v65
    v_lshlrev_b32 v244, 16, v66
    v_and_b32 v245, 0xffff0000, v66
    v_lshlrev_b32 v246, 16, v67
    v_and_b32 v247, 0xffff0000, v67
    v_lshlrev_b32 v248, 16, v220
    v_and_b32 v249, 0xffff0000, v71
    v_lshlrev_b32 v250, 16, v71
    v_and_b32 v251, 0xffff0000, v70
    v_lshlrev_b32 v252, 16, v70
    v_and_b32 v253, 0xffff0000, v69
    v_lshlrev_b32 v254, 16, v69
    v_and_b32 v255, 0xffff0000, v68
    v_pk_add_f32 v[224:225], v[240:241], v[248:249]
    v_pk_add_f32 v[64:65], v[240:241], v[248:249] neg_lo:[0,1] neg_hi:[0,1]
    v_pk_add_f32 v[226:227], v[242:243], v[250:251]
    v_pk_add_f32 v[66:67], v[242:243], v[250:251] neg_lo:[0,1] neg_hi:[0,1]
    v_pk_add_f32 v[228:229], v[244:245], v[252:253]
    v_pk_add_f32 v[68:69], v[244:245], v[252:253] neg_lo:[0,1] neg_hi:[0,1]
    v_pk_add_f32 v[230:231], v[246:247], v[254:255]
    v_pk_add_f32 v[70:71], v[246:247], v[254:255] neg_lo:[0,1] neg_hi:[0,1]
    v_lshlrev_b32 v240, 16, v72
    v_and_b32 v241, 0xffff0000, v72
    v_lshlrev_b32 v242, 16, v73
    v_and_b32 v243, 0xffff0000, v73
    v_lshlrev_b32 v244, 16, v74
    v_and_b32 v245, 0xffff0000, v74
    v_lshlrev_b32 v246, 16, v75
    v_and_b32 v247, 0xffff0000, v75
    v_lshlrev_b32 v248, 16, v221
    v_and_b32 v249, 0xffff0000, v79
    v_lshlrev_b32 v250, 16, v79
    v_and_b32 v251, 0xffff0000, v78
    v_lshlrev_b32 v252, 16, v78
    v_and_b32 v253, 0xffff0000, v77
    v_lshlrev_b32 v254, 16, v77
    v_and_b32 v255, 0xffff0000, v76
    v_pk_add_f32 v[160:161], v[240:241], v[248:249]
    v_pk_add_f32 v[72:73], v[240:241], v[248:249] neg_lo:[0,1] neg_hi:[0,1]
    v_pk_add_f32 v[162:163], v[242:243], v[250:251]
    v_pk_add_f32 v[74:75], v[242:243], v[250:251] neg_lo:[0,1] neg_hi:[0,1]
    v_pk_add_f32 v[164:165], v[244:245], v[252:253]
    v_pk_add_f32 v[76:77], v[244:245], v[252:253] neg_lo:[0,1] neg_hi:[0,1]
    v_pk_add_f32 v[166:167], v[246:247], v[254:255]
    v_pk_add_f32 v[78:79], v[246:247], v[254:255] neg_lo:[0,1] neg_hi:[0,1]
    v_lshlrev_b32 v240, 16, v80
    v_and_b32 v241, 0xffff0000, v80
    v_lshlrev_b32 v242, 16, v81
    v_and_b32 v243, 0xffff0000, v81
    v_lshlrev_b32 v244, 16, v82
    v_and_b32 v245, 0xffff0000, v82
    v_lshlrev_b32 v246, 16, v83
    v_and_b32 v247, 0xffff0000, v83
    v_lshlrev_b32 v248, 16, v222
    v_and_b32 v249, 0xffff0000, v87
    v_lshlrev_b32 v250, 16, v87
    v_and_b32 v251, 0xffff0000, v86
    v_lshlrev_b32 v252, 16, v86
    v_and_b32 v253, 0xffff0000, v85
    v_lshlrev_b32 v254, 16, v85
    v_and_b32 v255, 0xffff0000, v84
    v_pk_add_f32 v[48:49], v[240:241], v[248:249]
    v_pk_add_f32 v[80:81], v[240:241], v[248:249] neg_lo:[0,1] neg_hi:[0,1]
    v_pk_add_f32 v[50:51], v[242:243], v[250:251]
    v_pk_add_f32 v[82:83], v[242:243], v[250:251] neg_lo:[0,1] neg_hi:[0,1]
    v_pk_add_f32 v[52:53], v[244:245], v[252:253]
    v_pk_add_f32 v[84:85], v[244:245], v[252:253] neg_lo:[0,1] neg_hi:[0,1]
    v_pk_add_f32 v[54:55], v[246:247], v[254:255]
    v_pk_add_f32 v[86:87], v[246:247], v[254:255] neg_lo:[0,1] neg_hi:[0,1]
    v_lshlrev_b32 v240, 16, v88
    v_and_b32 v241, 0xffff0000, v88
    v_lshlrev_b32 v242, 16, v89
    v_and_b32 v243, 0xffff0000, v89
    v_lshlrev_b32 v244, 16, v90
    v_and_b32 v245, 0xffff0000, v90
    v_lshlrev_b32 v246, 16, v91
    v_and_b32 v247, 0xffff0000, v91
    v_lshlrev_b32 v248, 16, v223
    v_and_b32 v249, 0xffff0000, v95
    v_lshlrev_b32 v250, 16, v95
    v_and_b32 v251, 0xffff0000, v94
    v_lshlrev_b32 v252, 16, v94
    v_and_b32 v253, 0xffff0000, v93
    v_lshlrev_b32 v254, 16, v93
    v_and_b32 v255, 0xffff0000, v92
    v_pk_add_f32 v[56:57], v[240:241], v[248:249]
    v_pk_add_f32 v[88:89], v[240:241], v[248:249] neg_lo:[0,1] neg_hi:[0,1]
    v_pk_add_f32 v[58:59], v[242:243], v[250:251]
    v_pk_add_f32 v[90:91], v[242:243], v[250:251] neg_lo:[0,1] neg_hi:[0,1]
    v_pk_add_f32 v[60:61], v[244:245], v[252:253]
    v_pk_add_f32 v[92:93], v[244:245], v[252:253] neg_lo:[0,1] neg_hi:[0,1]
    v_pk_add_f32 v[62:63], v[246:247], v[254:255]
    v_pk_add_f32 v[94:95], v[246:247], v[254:255] neg_lo:[0,1] neg_hi:[0,1]
    v_pk_add_f32 v[224:225], v[224:225], v[160:161]
    v_pk_add_f32 v[48:49], v[48:49], v[56:57]
    v_pk_add_f32 v[64:65], v[64:65], v[72:73] neg_lo:[0,1] neg_hi:[0,1]
    v_pk_add_f32 v[80:81], v[80:81], v[88:89] neg_lo:[0,1] neg_hi:[0,1]
    v_pk_add_f32 v[226:227], v[226:227], v[162:163]
    v_pk_add_f32 v[50:51], v[50:51], v[58:59]
    v_pk_add_f32 v[66:67], v[66:67], v[74:75] neg_lo:[0,1] neg_hi:[0,1]
    v_pk_add_f32 v[82:83], v[82:83], v[90:91] neg_lo:[0,1] neg_hi:[0,1]
    v_pk_add_f32 v[228:229], v[228:229], v[164:165]
    v_pk_add_f32 v[52:53], v[52:53], v[60:61]
    v_pk_add_f32 v[68:69], v[68:69], v[76:77] neg_lo:[0,1] neg_hi:[0,1]
    v_pk_add_f32 v[84:85], v[84:85], v[92:93] neg_lo:[0,1] neg_hi:[0,1]
    v_pk_add_f32 v[230:231], v[230:231], v[166:167]
    v_pk_add_f32 v[54:55], v[54:55], v[62:63]
    v_pk_add_f32 v[70:71], v[70:71], v[78:79] neg_lo:[0,1] neg_hi:[0,1]
    v_pk_add_f32 v[86:87], v[86:87], v[94:95] neg_lo:[0,1] neg_hi:[0,1]
    v_pk_add_f32 v[160:161], v[224:225], v[48:49]
    v_pk_add_f32 v[56:57], v[224:225], v[48:49] neg_lo:[0,1] neg_hi:[0,1]
    v_pk_add_f32 v[72:73], v[64:65], v[80:81] neg_lo:[0,1] neg_hi:[0,1]
    v_pk_add_f32 v[88:89], v[64:65], v[80:81]
    v_pk_add_f32 v[162:163], v[226:227], v[50:51]
    v_pk_add_f32 v[58:59], v[226:227], v[50:51] neg_lo:[0,1] neg_hi:[0,1]
    v_pk_add_f32 v[74:75], v[66:67], v[82:83] neg_lo:[0,1] neg_hi:[0,1]
    v_pk_add_f32 v[90:91], v[66:67], v[82:83]
    v_pk_add_f32 v[164:165], v[228:229], v[52:53]
    v_pk_add_f32 v[60:61], v[228:229], v[52:53] neg_lo:[0,1] neg_hi:[0,1]
    v_pk_add_f32 v[76:77], v[68:69], v[84:85] neg_lo:[0,1] neg_hi:[0,1]
    v_pk_add_f32 v[92:93], v[68:69], v[84:85]
    v_pk_add_f32 v[166:167], v[230:231], v[54:55]
    v_pk_add_f32 v[62:63], v[230:231], v[54:55] neg_lo:[0,1] neg_hi:[0,1]
    v_pk_add_f32 v[78:79], v[70:71], v[86:87] neg_lo:[0,1] neg_hi:[0,1]
    v_pk_add_f32 v[94:95], v[70:71], v[86:87]
    v_pk_add_f32 v[16:17], v[16:17], v[160:161]
    v_pk_add_f32 v[18:19], v[18:19], v[56:57]
    v_pk_add_f32 v[16:17], v[16:17], v[162:163]
    v_pk_add_f32 v[18:19], v[18:19], v[58:59]
    v_pk_add_f32 v[16:17], v[16:17], v[164:165]
    v_pk_add_f32 v[18:19], v[18:19], v[60:61]
    v_pk_add_f32 v[16:17], v[16:17], v[166:167]
    v_pk_add_f32 v[18:19], v[18:19], v[62:63]
    v_cvt_pk_bf16_f32 v64, v160, v161
    v_cvt_pk_bf16_f32 v65, v162, v163
    v_cvt_pk_bf16_f32 v66, v164, v165
    v_cvt_pk_bf16_f32 v67, v166, v167
    s_add_u32 s26, s22, 0
    buffer_store_dwordx4 v[64:67], v25, s[12:15], s26 offen sc1
    v_cvt_pk_bf16_f32 v68, v56, v57
    v_cvt_pk_bf16_f32 v69, v58, v59
    v_cvt_pk_bf16_f32 v70, v60, v61
    v_cvt_pk_bf16_f32 v71, v62, v63
    s_add_u32 s26, s22, 524288
    buffer_store_dwordx4 v[68:71], v25, s[12:15], s26 offen sc1
    v_cvt_pk_bf16_f32 v80, v72, v73
    v_cvt_pk_bf16_f32 v81, v74, v75
    v_cvt_pk_bf16_f32 v82, v76, v77
    v_cvt_pk_bf16_f32 v83, v78, v79
    s_add_u32 s26, s22, 1048576
    buffer_store_dwordx4 v[80:83], v25, s[12:15], s26 offen sc1
    v_cvt_pk_bf16_f32 v84, v88, v89
    v_cvt_pk_bf16_f32 v85, v90, v91
    v_cvt_pk_bf16_f32 v86, v92, v93
    v_cvt_pk_bf16_f32 v87, v94, v95
    s_add_u32 s26, s22, 1572864
    buffer_store_dwordx4 v[84:87], v25, s[12:15], s26 offen sc1
    buffer_load_dwordx4 v[128:131], v232, s[4:7], 0 offen offset:0
    buffer_load_dwordx4 v[132:135], v236, s[4:7], 0 offen offset:128
    buffer_load_dwordx4 v[136:139], v233, s[4:7], 0 offen offset:0
    buffer_load_dwordx4 v[140:143], v237, s[4:7], 0 offen offset:128
    buffer_load_dwordx4 v[144:147], v234, s[4:7], 0 offen offset:0
    buffer_load_dwordx4 v[148:151], v238, s[4:7], 0 offen offset:128
    buffer_load_dwordx4 v[152:155], v235, s[4:7], 0 offen offset:0
    buffer_load_dwordx4 v[156:159], v239, s[4:7], 0 offen offset:128
    v_lshlrev_b32 v4, 11, v44
    buffer_load_ushort v212, v4, s[4:7], s74 offen
    v_lshlrev_b32 v4, 11, v45
    buffer_load_ushort v213, v4, s[4:7], s74 offen
    v_lshlrev_b32 v4, 11, v46
    buffer_load_ushort v214, v4, s[4:7], s74 offen
    v_lshlrev_b32 v4, 11, v47
    buffer_load_ushort v215, v4, s[4:7], s74 offen
    s_add_u32 m0, s21, 0
    s_nop 0
    buffer_load_dwordx4 v32, s[8:11], s17 offen offset:0 lds
    buffer_load_dwordx4 v33, s[8:11], s17 offen offset:1024 lds
    buffer_load_dwordx4 v34, s[8:11], s17 offen offset:2048 lds
    buffer_load_dwordx4 v35, s[8:11], s17 offen offset:3072 lds
    s_add_u32 s17, s17, 128
    s_add_u32 m0, s21, 16384
    s_nop 0
    buffer_load_dwordx4 v32, s[8:11], s17 offen offset:0 lds
    buffer_load_dwordx4 v33, s[8:11], s17 offen offset:1024 lds
    buffer_load_dwordx4 v34, s[8:11], s17 offen offset:2048 lds
    buffer_load_dwordx4 v35, s[8:11], s17 offen offset:3072 lds
    s_add_u32 s17, s17, 128
    s_add_u32 m0, s21, 32768
    s_nop 0
    buffer_load_dwordx4 v32, s[8:11], s17 offen offset:0 lds
    buffer_load_dwordx4 v33, s[8:11], s17 offen offset:1024 lds
    buffer_load_dwordx4 v34, s[8:11], s17 offen offset:2048 lds
    buffer_load_dwordx4 v35, s[8:11], s17 offen offset:3072 lds
    s_add_u32 s17, s17, 128
    s_waitcnt vmcnt(28)
    v_dot2_f32_bf16 v8, v96, v200, v8
    v_dot2_f32_bf16 v9, v104, v200, v9
    v_dot2_f32_bf16 v10, v112, v200, v10
    v_dot2_f32_bf16 v11, v120, v200, v11
    v_dot2_f32_bf16 v8, v100, v204, v8
    v_dot2_f32_bf16 v9, v108, v204, v9
    v_dot2_f32_bf16 v10, v116, v204, v10
    v_dot2_f32_bf16 v11, v124, v204, v11
    v_dot2_f32_bf16 v8, v97, v201, v8
    v_dot2_f32_bf16 v9, v105, v201, v9
    v_dot2_f32_bf16 v10, v113, v201, v10
    v_dot2_f32_bf16 v11, v121, v201, v11
    v_dot2_f32_bf16 v8, v101, v205, v8
    v_dot2_f32_bf16 v9, v109, v205, v9
    v_dot2_f32_bf16 v10, v117, v205, v10
    v_dot2_f32_bf16 v11, v125, v205, v11
    v_dot2_f32_bf16 v8, v98, v202, v8
    v_dot2_f32_bf16 v9, v106, v202, v9
    v_dot2_f32_bf16 v10, v114, v202, v10
    v_dot2_f32_bf16 v11, v122, v202, v11
    v_dot2_f32_bf16 v8, v102, v206, v8
    v_dot2_f32_bf16 v9, v110, v206, v9
    v_dot2_f32_bf16 v10, v118, v206, v10
    v_dot2_f32_bf16 v11, v126, v206, v11
    v_dot2_f32_bf16 v8, v99, v203, v8
    v_dot2_f32_bf16 v9, v107, v203, v9
    v_dot2_f32_bf16 v10, v115, v203, v10
    v_dot2_f32_bf16 v11, v123, v203, v11
    v_dot2_f32_bf16 v8, v103, v207, v8
    v_dot2_f32_bf16 v9, v111, v207, v9
    v_dot2_f32_bf16 v10, v119, v207, v10
    v_dot2_f32_bf16 v11, v127, v207, v11
    v_cndmask_b32 v104, v104, 0, s[62:63]
    v_cndmask_b32 v105, v105, 0, s[62:63]
    v_cndmask_b32 v106, v106, 0, s[62:63]
    v_cndmask_b32 v107, v107, 0, s[62:63]
    v_cndmask_b32 v108, v108, 0, s[62:63]
    v_cndmask_b32 v109, v109, 0, s[62:63]
    v_cndmask_b32 v110, v110, 0, s[62:63]
    v_cndmask_b32 v111, v111, 0, s[62:63]
    v_cndmask_b32 v120, v120, 0, s[62:63]
    v_cndmask_b32 v121, v121, 0, s[62:63]
    v_cndmask_b32 v122, v122, 0, s[62:63]
    v_cndmask_b32 v123, v123, 0, s[62:63]
    v_cndmask_b32 v124, v124, 0, s[62:63]
    v_cndmask_b32 v125, v125, 0, s[62:63]
    v_cndmask_b32 v126, v126, 0, s[62:63]
    v_cndmask_b32 v127, v127, 0, s[62:63]
    v_mov_b32_dpp v208, v216 row_shl:7 row_mask:0xf bank_mask:0xf
    v_mov_b32_dpp v209, v217 row_shl:7 row_mask:0xf bank_mask:0xf
    v_mov_b32_dpp v210, v218 row_shl:7 row_mask:0xf bank_mask:0xf
    v_mov_b32_dpp v211, v219 row_shl:7 row_mask:0xf bank_mask:0xf
    v_lshlrev_b32 v2, 16, v100
    v_lshlrev_b32 v3, 16, v108
    v_lshlrev_b32 v4, 16, v116
    v_lshlrev_b32 v5, 16, v124
    v_add_f32 v2, v2, v3
    v_add_f32 v4, v4, v5
    v_add_f32 v26, v2, v4
    v_sub_f32 v27, v2, v4
    v_mov_b32_dpp v220, v100 row_shr:1 row_mask:0xf bank_mask:0xf
    v_mov_b32_dpp v221, v108 row_shr:1 row_mask:0xf bank_mask:0xf
    v_mov_b32_dpp v222, v116 row_shr:1 row_mask:0xf bank_mask:0xf
    v_mov_b32_dpp v223, v124 row_shr:1 row_mask:0xf bank_mask:0xf
    v_cndmask_b32 v220, v220, v208, s[70:71]
    v_cndmask_b32 v221, v221, v209, s[70:71]
    v_cndmask_b32 v222, v222, v210, s[70:71]
    v_cndmask_b32 v223, v223, v211, s[70:71]
    v_lshlrev_b32 v240, 16, v96
    v_and_b32 v241, 0xffff0000, v96
    v_lshlrev_b32 v242, 16, v97
    v_and_b32 v243, 0xffff0000, v97
    v_lshlrev_b32 v244, 16, v98
    v_and_b32 v245, 0xffff0000, v98
    v_lshlrev_b32 v246, 16, v99
    v_and_b32 v247, 0xffff0000, v99
    v_lshlrev_b32 v248, 16, v220
    v_and_b32 v249, 0xffff0000, v103
    v_lshlrev_b32 v250, 16, v103
    v_and_b32 v251, 0xffff0000, v102
    v_lshlrev_b32 v252, 16, v102
    v_and_b32 v253, 0xffff0000, v101
    v_lshlrev_b32 v254, 16, v101
    v_and_b32 v255, 0xffff0000, v100
    v_pk_add_f32 v[224:225], v[240:241], v[248:249]
    v_pk_add_f32 v[96:97], v[240:241], v[248:249] neg_lo:[0,1] neg_hi:[0,1]
    v_pk_add_f32 v[226:227], v[242:243], v[250:251]
    v_pk_add_f32 v[98:99], v[242:243], v[250:251] neg_lo:[0,1] neg_hi:[0,1]
    v_pk_add_f32 v[228:229], v[244:245], v[252:253]
    v_pk_add_f32 v[100:101], v[244:245], v[252:253] neg_lo:[0,1] neg_hi:[0,1]
    v_pk_add_f32 v[230:231], v[246:247], v[254:255]
    v_pk_add_f32 v[102:103], v[246:247], v[254:255] neg_lo:[0,1] neg_hi:[0,1]
    v_lshlrev_b32 v240, 16, v104
    v_and_b32 v241, 0xffff0000, v104
    v_lshlrev_b32 v242, 16, v105
    v_and_b32 v243, 0xffff0000, v105
    v_lshlrev_b32 v244, 16, v106
    v_and_b32 v245, 0xffff0000, v106
    v_lshlrev_b32 v246, 16, v107
    v_and_b32 v247, 0xffff0000, v107
    v_lshlrev_b32 v248, 16, v221
    v_and_b32 v249, 0xffff0000, v111
    v_lshlrev_b32 v250, 16, v111
    v_and_b32 v251, 0xffff0000, v110
    v_lshlrev_b32 v252, 16, v110
    v_and_b32 v253, 0xffff0000, v109
    v_lshlrev_b32 v254, 16, v109
    v_and_b32 v255, 0xffff0000, v108
    v_pk_add_f32 v[160:161], v[240:241], v[248:249]
    v_pk_add_f32 v[104:105], v[240:241], v[248:249] neg_lo:[0,1] neg_hi:[0,1]
    v_pk_add_f32 v[162:163], v[242:243], v[250:251]
    v_pk_add_f32 v[106:107], v[242:243], v[250:251] neg_lo:[0,1] neg_hi:[0,1]
    v_pk_add_f32 v[164:165], v[244:245], v[252:253]
    v_pk_add_f32 v[108:109], v[244:245], v[252:253] neg_lo:[0,1] neg_hi:[0,1]
    v_pk_add_f32 v[166:167], v[246:247], v[254:255]
    v_pk_add_f32 v[110:111], v[246:247], v[254:255] neg_lo:[0,1] neg_hi:[0,1]
    v_lshlrev_b32 v240, 16, v112
    v_and_b32 v241, 0xffff0000, v112
    v_lshlrev_b32 v242, 16, v113
    v_and_b32 v243, 0xffff0000, v113
    v_lshlrev_b32 v244, 16, v114
    v_and_b32 v245, 0xffff0000, v114
    v_lshlrev_b32 v246, 16, v115
    v_and_b32 v247, 0xffff0000, v115
    v_lshlrev_b32 v248, 16, v222
    v_and_b32 v249, 0xffff0000, v119
    v_lshlrev_b32 v250, 16, v119
    v_and_b32 v251, 0xffff0000, v118
    v_lshlrev_b32 v252, 16, v118
    v_and_b32 v253, 0xffff0000, v117
    v_lshlrev_b32 v254, 16, v117
    v_and_b32 v255, 0xffff0000, v116
    v_pk_add_f32 v[48:49], v[240:241], v[248:249]
    v_pk_add_f32 v[112:113], v[240:241], v[248:249] neg_lo:[0,1] neg_hi:[0,1]
    v_pk_add_f32 v[50:51], v[242:243], v[250:251]
    v_pk_add_f32 v[114:115], v[242:243], v[250:251] neg_lo:[0,1] neg_hi:[0,1]
    v_pk_add_f32 v[52:53], v[244:245], v[252:253]
    v_pk_add_f32 v[116:117], v[244:245], v[252:253] neg_lo:[0,1] neg_hi:[0,1]
    v_pk_add_f32 v[54:55], v[246:247], v[254:255]
    v_pk_add_f32 v[118:119], v[246:247], v[254:255] neg_lo:[0,1] neg_hi:[0,1]
    v_lshlrev_b32 v240, 16, v120
    v_and_b32 v241, 0xffff0000, v120
    v_lshlrev_b32 v242, 16, v121
    v_and_b32 v243, 0xffff0000, v121
    v_lshlrev_b32 v244, 16, v122
    v_and_b32 v245, 0xffff0000, v122
    v_lshlrev_b32 v246, 16, v123
    v_and_b32 v247, 0xffff0000, v123
    v_lshlrev_b32 v248, 16, v223
    v_and_b32 v249, 0xffff0000, v127
    v_lshlrev_b32 v250, 16, v127
    v_and_b32 v251, 0xffff0000, v126
    v_lshlrev_b32 v252, 16, v126
    v_and_b32 v253, 0xffff0000, v125
    v_lshlrev_b32 v254, 16, v125
    v_and_b32 v255, 0xffff0000, v124
    v_pk_add_f32 v[56:57], v[240:241], v[248:249]
    v_pk_add_f32 v[120:121], v[240:241], v[248:249] neg_lo:[0,1] neg_hi:[0,1]
    v_pk_add_f32 v[58:59], v[242:243], v[250:251]
    v_pk_add_f32 v[122:123], v[242:243], v[250:251] neg_lo:[0,1] neg_hi:[0,1]
    v_pk_add_f32 v[60:61], v[244:245], v[252:253]
    v_pk_add_f32 v[124:125], v[244:245], v[252:253] neg_lo:[0,1] neg_hi:[0,1]
    v_pk_add_f32 v[62:63], v[246:247], v[254:255]
    v_pk_add_f32 v[126:127], v[246:247], v[254:255] neg_lo:[0,1] neg_hi:[0,1]
    v_pk_add_f32 v[224:225], v[224:225], v[160:161]
    v_pk_add_f32 v[48:49], v[48:49], v[56:57]
    v_pk_add_f32 v[96:97], v[96:97], v[104:105] neg_lo:[0,1] neg_hi:[0,1]
    v_pk_add_f32 v[112:113], v[112:113], v[120:121] neg_lo:[0,1] neg_hi:[0,1]
    v_pk_add_f32 v[226:227], v[226:227], v[162:163]
    v_pk_add_f32 v[50:51], v[50:51], v[58:59]
    v_pk_add_f32 v[98:99], v[98:99], v[106:107] neg_lo:[0,1] neg_hi:[0,1]
    v_pk_add_f32 v[114:115], v[114:115], v[122:123] neg_lo:[0,1] neg_hi:[0,1]
    v_pk_add_f32 v[228:229], v[228:229], v[164:165]
    v_pk_add_f32 v[52:53], v[52:53], v[60:61]
    v_pk_add_f32 v[100:101], v[100:101], v[108:109] neg_lo:[0,1] neg_hi:[0,1]
    v_pk_add_f32 v[116:117], v[116:117], v[124:125] neg_lo:[0,1] neg_hi:[0,1]
    v_pk_add_f32 v[230:231], v[230:231], v[166:167]
    v_pk_add_f32 v[54:55], v[54:55], v[62:63]
    v_pk_add_f32 v[102:103], v[102:103], v[110:111] neg_lo:[0,1] neg_hi:[0,1]
    v_pk_add_f32 v[118:119], v[118:119], v[126:127] neg_lo:[0,1] neg_hi:[0,1]
    v_pk_add_f32 v[160:161], v[224:225], v[48:49]
    v_pk_add_f32 v[56:57], v[224:225], v[48:49] neg_lo:[0,1] neg_hi:[0,1]
    v_pk_add_f32 v[104:105], v[96:97], v[112:113] neg_lo:[0,1] neg_hi:[0,1]
    v_pk_add_f32 v[120:121], v[96:97], v[112:113]
    v_pk_add_f32 v[162:163], v[226:227], v[50:51]
    v_pk_add_f32 v[58:59], v[226:227], v[50:51] neg_lo:[0,1] neg_hi:[0,1]
    v_pk_add_f32 v[106:107], v[98:99], v[114:115] neg_lo:[0,1] neg_hi:[0,1]
    v_pk_add_f32 v[122:123], v[98:99], v[114:115]
    v_pk_add_f32 v[164:165], v[228:229], v[52:53]
    v_pk_add_f32 v[60:61], v[228:229], v[52:53] neg_lo:[0,1] neg_hi:[0,1]
    v_pk_add_f32 v[108:109], v[100:101], v[116:117] neg_lo:[0,1] neg_hi:[0,1]
    v_pk_add_f32 v[124:125], v[100:101], v[116:117]
    v_pk_add_f32 v[166:167], v[230:231], v[54:55]
    v_pk_add_f32 v[62:63], v[230:231], v[54:55] neg_lo:[0,1] neg_hi:[0,1]
    v_pk_add_f32 v[110:111], v[102:103], v[118:119] neg_lo:[0,1] neg_hi:[0,1]
    v_pk_add_f32 v[126:127], v[102:103], v[118:119]
    v_pk_add_f32 v[16:17], v[16:17], v[160:161]
    v_pk_add_f32 v[18:19], v[18:19], v[56:57]
    v_pk_add_f32 v[16:17], v[16:17], v[162:163]
    v_pk_add_f32 v[18:19], v[18:19], v[58:59]
    v_pk_add_f32 v[16:17], v[16:17], v[164:165]
    v_pk_add_f32 v[18:19], v[18:19], v[60:61]
    v_pk_add_f32 v[16:17], v[16:17], v[166:167]
    v_pk_add_f32 v[18:19], v[18:19], v[62:63]
    v_cvt_pk_bf16_f32 v96, v160, v161
    v_cvt_pk_bf16_f32 v97, v162, v163
    v_cvt_pk_bf16_f32 v98, v164, v165
    v_cvt_pk_bf16_f32 v99, v166, v167
    s_add_u32 s26, s22, 8192
    buffer_store_dwordx4 v[96:99], v25, s[12:15], s26 offen sc1
    v_cvt_pk_bf16_f32 v100, v56, v57
    v_cvt_pk_bf16_f32 v101, v58, v59
    v_cvt_pk_bf16_f32 v102, v60, v61
    v_cvt_pk_bf16_f32 v103, v62, v63
    s_add_u32 s26, s22, 532480
    buffer_store_dwordx4 v[100:103], v25, s[12:15], s26 offen sc1
    v_cvt_pk_bf16_f32 v112, v104, v105
    v_cvt_pk_bf16_f32 v113, v106, v107
    v_cvt_pk_bf16_f32 v114, v108, v109
    v_cvt_pk_bf16_f32 v115, v110, v111
    s_add_u32 s26, s22, 1056768
    buffer_store_dwordx4 v[112:115], v25, s[12:15], s26 offen sc1
    v_cvt_pk_bf16_f32 v116, v120, v121
    v_cvt_pk_bf16_f32 v117, v122, v123
    v_cvt_pk_bf16_f32 v118, v124, v125
    v_cvt_pk_bf16_f32 v119, v126, v127
    s_add_u32 s26, s22, 1581056
    buffer_store_dwordx4 v[116:119], v25, s[12:15], s26 offen sc1
    buffer_load_dwordx4 v[160:163], v232, s[4:7], 0 offen offset:128
    buffer_load_dwordx4 v[164:167], v236, s[4:7], 0 offen offset:0
    buffer_load_dwordx4 v[168:171], v233, s[4:7], 0 offen offset:128
    buffer_load_dwordx4 v[172:175], v237, s[4:7], 0 offen offset:0
    buffer_load_dwordx4 v[176:179], v234, s[4:7], 0 offen offset:128
    buffer_load_dwordx4 v[180:183], v238, s[4:7], 0 offen offset:0
    buffer_load_dwordx4 v[184:187], v235, s[4:7], 0 offen offset:128
    buffer_load_dwordx4 v[188:191], v239, s[4:7], 0 offen offset:0
    s_add_u32 m0, s21, 49152
    s_nop 0
    buffer_load_dwordx4 v32, s[8:11], s17 offen offset:0 lds
    buffer_load_dwordx4 v33, s[8:11], s17 offen offset:1024 lds
    buffer_load_dwordx4 v34, s[8:11], s17 offen offset:2048 lds
    buffer_load_dwordx4 v35, s[8:11], s17 offen offset:3072 lds
    s_add_u32 s17, s17, 128
    s_add_u32 m0, s21, 65536
    s_nop 0
    buffer_load_dwordx4 v32, s[8:11], s17 offen offset:0 lds
    buffer_load_dwordx4 v33, s[8:11], s17 offen offset:1024 lds
    buffer_load_dwordx4 v34, s[8:11], s17 offen offset:2048 lds
    buffer_load_dwordx4 v35, s[8:11], s17 offen offset:3072 lds
    s_add_u32 s17, s17, 128
    s_add_u32 m0, s21, 81920
    s_nop 0
    buffer_load_dwordx4 v32, s[8:11], s17 offen offset:0 lds
    buffer_load_dwordx4 v33, s[8:11], s17 offen offset:1024 lds
    buffer_load_dwordx4 v34, s[8:11], s17 offen offset:2048 lds
    buffer_load_dwordx4 v35, s[8:11], s17 offen offset:3072 lds
    s_add_u32 s17, s17, 128
    s_waitcnt vmcnt(36)
    v_dot2_f32_bf16 v12, v128, v192, v12
    v_dot2_f32_bf16 v13, v136, v192, v13
    v_dot2_f32_bf16 v14, v144, v192, v14
    v_dot2_f32_bf16 v15, v152, v192, v15
    v_dot2_f32_bf16 v12, v132, v196, v12
    v_dot2_f32_bf16 v13, v140, v196, v13
    v_dot2_f32_bf16 v14, v148, v196, v14
    v_dot2_f32_bf16 v15, v156, v196, v15
    v_dot2_f32_bf16 v12, v129, v193, v12
    v_dot2_f32_bf16 v13, v137, v193, v13
    v_dot2_f32_bf16 v14, v145, v193, v14
    v_dot2_f32_bf16 v15, v153, v193, v15
    v_dot2_f32_bf16 v12, v133, v197, v12
    v_dot2_f32_bf16 v13, v141, v197, v13
    v_dot2_f32_bf16 v14, v149, v197, v14
    v_dot2_f32_bf16 v15, v157, v197, v15
    v_dot2_f32_bf16 v12, v130, v194, v12
    v_dot2_f32_bf16 v13, v138, v194, v13
    v_dot2_f32_bf16 v14, v146, v194, v14
    v_dot2_f32_bf16 v15, v154, v194, v15
    v_dot2_f32_bf16 v12, v134, v198, v12
    v_dot2_f32_bf16 v13, v142, v198, v13
    v_dot2_f32_bf16 v14, v150, v198, v14
    v_dot2_f32_bf16 v15, v158, v198, v15
    v_dot2_f32_bf16 v12, v131, v195, v12
    v_dot2_f32_bf16 v13, v139, v195, v13
    v_dot2_f32_bf16 v14, v147, v195, v14
    v_dot2_f32_bf16 v15, v155, v195, v15
    v_dot2_f32_bf16 v12, v135, v199, v12
    v_dot2_f32_bf16 v13, v143, v199, v13
    v_dot2_f32_bf16 v14, v151, v199, v14
    v_dot2_f32_bf16 v15, v159, v199, v15
    v_cndmask_b32 v212, v212, 0, s[72:73]
    v_cndmask_b32 v213, v213, 0, s[72:73]
    v_cndmask_b32 v214, v214, 0, s[72:73]
    v_cndmask_b32 v215, v215, 0, s[72:73]
    v_mov_b32 v216, v132
    v_mov_b32 v217, v140
    v_mov_b32 v218, v148
    v_mov_b32 v219, v156
    v_mov_b32_dpp v220, v132 row_shr:1 row_mask:0xf bank_mask:0xf
    v_mov_b32_dpp v221, v140 row_shr:1 row_mask:0xf bank_mask:0xf
    v_mov_b32_dpp v222, v148 row_shr:1 row_mask:0xf bank_mask:0xf
    v_mov_b32_dpp v223, v156 row_shr:1 row_mask:0xf bank_mask:0xf
    v_cndmask_b32 v220, v220, v212, s[70:71]
    v_cndmask_b32 v221, v221, v213, s[70:71]
    v_cndmask_b32 v222, v222, v214, s[70:71]
    v_cndmask_b32 v223, v223, v215, s[70:71]
    v_lshlrev_b32 v240, 16, v128
    v_and_b32 v241, 0xffff0000, v128
    v_lshlrev_b32 v242, 16, v129
    v_and_b32 v243, 0xffff0000, v129
    v_lshlrev_b32 v244, 16, v130
    v_and_b32 v245, 0xffff0000, v130
    v_lshlrev_b32 v246, 16, v131
    v_and_b32 v247, 0xffff0000, v131
    v_lshlrev_b32 v248, 16, v220
    v_and_b32 v249, 0xffff0000, v135
    v_lshlrev_b32 v250, 16, v135
    v_and_b32 v251, 0xffff0000, v134
    v_lshlrev_b32 v252, 16, v134
    v_and_b32 v253, 0xffff0000, v133
    v_lshlrev_b32 v254, 16, v133
    v_and_b32 v255, 0xffff0000, v132
    v_pk_add_f32 v[224:225], v[240:241], v[248:249]
    v_pk_add_f32 v[128:129], v[240:241], v[248:249] neg_lo:[0,1] neg_hi:[0,1]
    v_pk_add_f32 v[226:227], v[242:243], v[250:251]
    v_pk_add_f32 v[130:131], v[242:243], v[250:251] neg_lo:[0,1] neg_hi:[0,1]
    v_pk_add_f32 v[228:229], v[244:245], v[252:253]
    v_pk_add_f32 v[132:133], v[244:245], v[252:253] neg_lo:[0,1] neg_hi:[0,1]
    v_pk_add_f32 v[230:231], v[246:247], v[254:255]
    v_pk_add_f32 v[134:135], v[246:247], v[254:255] neg_lo:[0,1] neg_hi:[0,1]
    v_lshlrev_b32 v240, 16, v136
    v_and_b32 v241, 0xffff0000, v136
    v_lshlrev_b32 v242, 16, v137
    v_and_b32 v243, 0xffff0000, v137
    v_lshlrev_b32 v244, 16, v138
    v_and_b32 v245, 0xffff0000, v138
    v_lshlrev_b32 v246, 16, v139
    v_and_b32 v247, 0xffff0000, v139
    v_lshlrev_b32 v248, 16, v221
    v_and_b32 v249, 0xffff0000, v143
    v_lshlrev_b32 v250, 16, v143
    v_and_b32 v251, 0xffff0000, v142
    v_lshlrev_b32 v252, 16, v142
    v_and_b32 v253, 0xffff0000, v141
    v_lshlrev_b32 v254, 16, v141
    v_and_b32 v255, 0xffff0000, v140
    v_pk_add_f32 v[72:73], v[240:241], v[248:249]
    v_pk_add_f32 v[136:137], v[240:241], v[248:249] neg_lo:[0,1] neg_hi:[0,1]
    v_pk_add_f32 v[74:75], v[242:243], v[250:251]
    v_pk_add_f32 v[138:139], v[242:243], v[250:251] neg_lo:[0,1] neg_hi:[0,1]
    v_pk_add_f32 v[76:77], v[244:245], v[252:253]
    v_pk_add_f32 v[140:141], v[244:245], v[252:253] neg_lo:[0,1] neg_hi:[0,1]
    v_pk_add_f32 v[78:79], v[246:247], v[254:255]
    v_pk_add_f32 v[142:143], v[246:247], v[254:255] neg_lo:[0,1] neg_hi:[0,1]
    v_lshlrev_b32 v240, 16, v144
    v_and_b32 v241, 0xffff0000, v144
    v_lshlrev_b32 v242, 16, v145
    v_and_b32 v243, 0xffff0000, v145
    v_lshlrev_b32 v244, 16, v146
    v_and_b32 v245, 0xffff0000, v146
    v_lshlrev_b32 v246, 16, v147
    v_and_b32 v247, 0xffff0000, v147
    v_lshlrev_b32 v248, 16, v222
    v_and_b32 v249, 0xffff0000, v151
    v_lshlrev_b32 v250, 16, v151
    v_and_b32 v251, 0xffff0000, v150
    v_lshlrev_b32 v252, 16, v150
    v_and_b32 v253, 0xffff0000, v149
    v_lshlrev_b32 v254, 16, v149
    v_and_b32 v255, 0xffff0000, v148
    v_pk_add_f32 v[48:49], v[240:241], v[248:249]
    v_pk_add_f32 v[144:145], v[240:241], v[248:249] neg_lo:[0,1] neg_hi:[0,1]
    v_pk_add_f32 v[50:51], v[242:243], v[250:251]
    v_pk_add_f32 v[146:147], v[242:243], v[250:251] neg_lo:[0,1] neg_hi:[0,1]
    v_pk_add_f32 v[52:53], v[244:245], v[252:253]
    v_pk_add_f32 v[148:149], v[244:245], v[252:253] neg_lo:[0,1] neg_hi:[0,1]
    v_pk_add_f32 v[54:55], v[246:247], v[254:255]
    v_pk_add_f32 v[150:151], v[246:247], v[254:255] neg_lo:[0,1] neg_hi:[0,1]
    v_lshlrev_b32 v240, 16, v152
    v_and_b32 v241, 0xffff0000, v152
    v_lshlrev_b32 v242, 16, v153
    v_and_b32 v243, 0xffff0000, v153
    v_lshlrev_b32 v244, 16, v154
    v_and_b32 v245, 0xffff0000, v154
    v_lshlrev_b32 v246, 16, v155
    v_and_b32 v247, 0xffff0000, v155
    v_lshlrev_b32 v248, 16, v223
    v_and_b32 v249, 0xffff0000, v159
    v_lshlrev_b32 v250, 16, v159
    v_and_b32 v251, 0xffff0000, v158
    v_lshlrev_b32 v252, 16, v158
    v_and_b32 v253, 0xffff0000, v157
    v_lshlrev_b32 v254, 16, v157
    v_and_b32 v255, 0xffff0000, v156
    v_pk_add_f32 v[56:57], v[240:241], v[248:249]
    v_pk_add_f32 v[152:153], v[240:241], v[248:249] neg_lo:[0,1] neg_hi:[0,1]
    v_pk_add_f32 v[58:59], v[242:243], v[250:251]
    v_pk_add_f32 v[154:155], v[242:243], v[250:251] neg_lo:[0,1] neg_hi:[0,1]
    v_pk_add_f32 v[60:61], v[244:245], v[252:253]
    v_pk_add_f32 v[156:157], v[244:245], v[252:253] neg_lo:[0,1] neg_hi:[0,1]
    v_pk_add_f32 v[62:63], v[246:247], v[254:255]
    v_pk_add_f32 v[158:159], v[246:247], v[254:255] neg_lo:[0,1] neg_hi:[0,1]
    v_pk_add_f32 v[224:225], v[224:225], v[72:73]
    v_pk_add_f32 v[48:49], v[48:49], v[56:57]
    v_pk_add_f32 v[128:129], v[128:129], v[136:137] neg_lo:[0,1] neg_hi:[0,1]
    v_pk_add_f32 v[144:145], v[144:145], v[152:153] neg_lo:[0,1] neg_hi:[0,1]
    v_pk_add_f32 v[226:227], v[226:227], v[74:75]
    v_pk_add_f32 v[50:51], v[50:51], v[58:59]
    v_pk_add_f32 v[130:131], v[130:131], v[138:139] neg_lo:[0,1] neg_hi:[0,1]
    v_pk_add_f32 v[146:147], v[146:147], v[154:155] neg_lo:[0,1] neg_hi:[0,1]
    v_pk_add_f32 v[228:229], v[228:229], v[76:77]
    v_pk_add_f32 v[52:53], v[52:53], v[60:61]
    v_pk_add_f32 v[132:133], v[132:133], v[140:141] neg_lo:[0,1] neg_hi:[0,1]
    v_pk_add_f32 v[148:149], v[148:149], v[156:157] neg_lo:[0,1] neg_hi:[0,1]
    v_pk_add_f32 v[230:231], v[230:231], v[78:79]
    v_pk_add_f32 v[54:55], v[54:55], v[62:63]
    v_pk_add_f32 v[134:135], v[134:135], v[142:143] neg_lo:[0,1] neg_hi:[0,1]
    v_pk_add_f32 v[150:151], v[150:151], v[158:159] neg_lo:[0,1] neg_hi:[0,1]
    v_pk_add_f32 v[72:73], v[224:225], v[48:49]
    v_pk_add_f32 v[56:57], v[224:225], v[48:49] neg_lo:[0,1] neg_hi:[0,1]
    v_pk_add_f32 v[136:137], v[128:129], v[144:145] neg_lo:[0,1] neg_hi:[0,1]
    v_pk_add_f32 v[152:153], v[128:129], v[144:145]
    v_pk_add_f32 v[74:75], v[226:227], v[50:51]
    v_pk_add_f32 v[58:59], v[226:227], v[50:51] neg_lo:[0,1] neg_hi:[0,1]
    v_pk_add_f32 v[138:139], v[130:131], v[146:147] neg_lo:[0,1] neg_hi:[0,1]
    v_pk_add_f32 v[154:155], v[130:131], v[146:147]
    v_pk_add_f32 v[76:77], v[228:229], v[52:53]
    v_pk_add_f32 v[60:61], v[228:229], v[52:53] neg_lo:[0,1] neg_hi:[0,1]
    v_pk_add_f32 v[140:141], v[132:133], v[148:149] neg_lo:[0,1] neg_hi:[0,1]
    v_pk_add_f32 v[156:157], v[132:133], v[148:149]
    v_pk_add_f32 v[78:79], v[230:231], v[54:55]
    v_pk_add_f32 v[62:63], v[230:231], v[54:55] neg_lo:[0,1] neg_hi:[0,1]
    v_pk_add_f32 v[142:143], v[134:135], v[150:151] neg_lo:[0,1] neg_hi:[0,1]
    v_pk_add_f32 v[158:159], v[134:135], v[150:151]
    v_pk_add_f32 v[20:21], v[20:21], v[72:73]
    v_pk_add_f32 v[22:23], v[22:23], v[56:57]
    v_pk_add_f32 v[20:21], v[20:21], v[74:75]
    v_pk_add_f32 v[22:23], v[22:23], v[58:59]
    v_pk_add_f32 v[20:21], v[20:21], v[76:77]
    v_pk_add_f32 v[22:23], v[22:23], v[60:61]
    v_pk_add_f32 v[20:21], v[20:21], v[78:79]
    v_pk_add_f32 v[22:23], v[22:23], v[62:63]
    v_cvt_pk_bf16_f32 v128, v72, v73
    v_cvt_pk_bf16_f32 v129, v74, v75
    v_cvt_pk_bf16_f32 v130, v76, v77
    v_cvt_pk_bf16_f32 v131, v78, v79
    s_add_u32 s26, s22, 128
    buffer_store_dwordx4 v[128:131], v25, s[12:15], s26 offen sc1
    v_cvt_pk_bf16_f32 v132, v56, v57
    v_cvt_pk_bf16_f32 v133, v58, v59
    v_cvt_pk_bf16_f32 v134, v60, v61
    v_cvt_pk_bf16_f32 v135, v62, v63
    s_add_u32 s26, s22, 524416
    buffer_store_dwordx4 v[132:135], v25, s[12:15], s26 offen sc1
    v_cvt_pk_bf16_f32 v144, v136, v137
    v_cvt_pk_bf16_f32 v145, v138, v139
    v_cvt_pk_bf16_f32 v146, v140, v141
    v_cvt_pk_bf16_f32 v147, v142, v143
    s_add_u32 s26, s22, 1048704
    buffer_store_dwordx4 v[144:147], v25, s[12:15], s26 offen sc1
    v_cvt_pk_bf16_f32 v148, v152, v153
    v_cvt_pk_bf16_f32 v149, v154, v155
    v_cvt_pk_bf16_f32 v150, v156, v157
    v_cvt_pk_bf16_f32 v151, v158, v159
    s_add_u32 s26, s22, 1572992
    buffer_store_dwordx4 v[148:151], v25, s[12:15], s26 offen sc1
    s_add_u32 m0, s21, 98304
    s_nop 0
    buffer_load_dwordx4 v32, s[8:11], s17 offen offset:0 lds
    buffer_load_dwordx4 v33, s[8:11], s17 offen offset:1024 lds
    buffer_load_dwordx4 v34, s[8:11], s17 offen offset:2048 lds
    buffer_load_dwordx4 v35, s[8:11], s17 offen offset:3072 lds
    s_add_u32 s17, s17, 128
    s_add_u32 m0, s21, 114688
    s_nop 0
    buffer_load_dwordx4 v32, s[8:11], s17 offen offset:0 lds
    buffer_load_dwordx4 v33, s[8:11], s17 offen offset:1024 lds
    buffer_load_dwordx4 v34, s[8:11], s17 offen offset:2048 lds
    buffer_load_dwordx4 v35, s[8:11], s17 offen offset:3072 lds
    s_add_u32 s17, s17, 128
    s_waitcnt vmcnt(24)
    v_dot2_f32_bf16 v12, v160, v200, v12
    v_dot2_f32_bf16 v13, v168, v200, v13
    v_dot2_f32_bf16 v14, v176, v200, v14
    v_dot2_f32_bf16 v15, v184, v200, v15
    v_dot2_f32_bf16 v12, v164, v204, v12
    v_dot2_f32_bf16 v13, v172, v204, v13
    v_dot2_f32_bf16 v14, v180, v204, v14
    v_dot2_f32_bf16 v15, v188, v204, v15
    v_dot2_f32_bf16 v12, v161, v201, v12
    v_dot2_f32_bf16 v13, v169, v201, v13
    v_dot2_f32_bf16 v14, v177, v201, v14
    v_dot2_f32_bf16 v15, v185, v201, v15
    v_dot2_f32_bf16 v12, v165, v205, v12
    v_dot2_f32_bf16 v13, v173, v205, v13
    v_dot2_f32_bf16 v14, v181, v205, v14
    v_dot2_f32_bf16 v15, v189, v205, v15
    v_dot2_f32_bf16 v12, v162, v202, v12
    v_dot2_f32_bf16 v13, v170, v202, v13
    v_dot2_f32_bf16 v14, v178, v202, v14
    v_dot2_f32_bf16 v15, v186, v202, v15
    v_dot2_f32_bf16 v12, v166, v206, v12
    v_dot2_f32_bf16 v13, v174, v206, v13
    v_dot2_f32_bf16 v14, v182, v206, v14
    v_dot2_f32_bf16 v15, v190, v206, v15
    v_dot2_f32_bf16 v12, v163, v203, v12
    v_dot2_f32_bf16 v13, v171, v203, v13
    v_dot2_f32_bf16 v14, v179, v203, v14
    v_dot2_f32_bf16 v15, v187, v203, v15
    v_dot2_f32_bf16 v12, v167, v207, v12
    v_dot2_f32_bf16 v13, v175, v207, v13
    v_dot2_f32_bf16 v14, v183, v207, v14
    v_dot2_f32_bf16 v15, v191, v207, v15
    v_mov_b32_dpp v212, v216 row_shl:7 row_mask:0xf bank_mask:0xf
    v_mov_b32_dpp v213, v217 row_shl:7 row_mask:0xf bank_mask:0xf
    v_mov_b32_dpp v214, v218 row_shl:7 row_mask:0xf bank_mask:0xf
    v_mov_b32_dpp v215, v219 row_shl:7 row_mask:0xf bank_mask:0xf
    v_lshlrev_b32 v2, 16, v164
    v_lshlrev_b32 v3, 16, v172
    v_lshlrev_b32 v4, 16, v180
    v_lshlrev_b32 v5, 16, v188
    v_add_f32 v2, v2, v3
    v_add_f32 v4, v4, v5
    v_add_f32 v28, v2, v4
    v_sub_f32 v29, v2, v4
    v_mov_b32_dpp v220, v164 row_shr:1 row_mask:0xf bank_mask:0xf
    v_mov_b32_dpp v221, v172 row_shr:1 row_mask:0xf bank_mask:0xf
    v_mov_b32_dpp v222, v180 row_shr:1 row_mask:0xf bank_mask:0xf
    v_mov_b32_dpp v223, v188 row_shr:1 row_mask:0xf bank_mask:0xf
    v_cndmask_b32 v220, v220, v212, s[70:71]
    v_cndmask_b32 v221, v221, v213, s[70:71]
    v_cndmask_b32 v222, v222, v214, s[70:71]
    v_cndmask_b32 v223, v223, v215, s[70:71]
    v_lshlrev_b32 v240, 16, v160
    v_and_b32 v241, 0xffff0000, v160
    v_lshlrev_b32 v242, 16, v161
    v_and_b32 v243, 0xffff0000, v161
    v_lshlrev_b32 v244, 16, v162
    v_and_b32 v245, 0xffff0000, v162
    v_lshlrev_b32 v246, 16, v163
    v_and_b32 v247, 0xffff0000, v163
    v_lshlrev_b32 v248, 16, v220
    v_and_b32 v249, 0xffff0000, v167
    v_lshlrev_b32 v250, 16, v167
    v_and_b32 v251, 0xffff0000, v166
    v_lshlrev_b32 v252, 16, v166
    v_and_b32 v253, 0xffff0000, v165
    v_lshlrev_b32 v254, 16, v165
    v_and_b32 v255, 0xffff0000, v164
    v_pk_add_f32 v[224:225], v[240:241], v[248:249]
    v_pk_add_f32 v[160:161], v[240:241], v[248:249] neg_lo:[0,1] neg_hi:[0,1]
    v_pk_add_f32 v[226:227], v[242:243], v[250:251]
    v_pk_add_f32 v[162:163], v[242:243], v[250:251] neg_lo:[0,1] neg_hi:[0,1]
    v_pk_add_f32 v[228:229], v[244:245], v[252:253]
    v_pk_add_f32 v[164:165], v[244:245], v[252:253] neg_lo:[0,1] neg_hi:[0,1]
    v_pk_add_f32 v[230:231], v[246:247], v[254:255]
    v_pk_add_f32 v[166:167], v[246:247], v[254:255] neg_lo:[0,1] neg_hi:[0,1]
    v_lshlrev_b32 v240, 16, v168
    v_and_b32 v241, 0xffff0000, v168
    v_lshlrev_b32 v242, 16, v169
    v_and_b32 v243, 0xffff0000, v169
    v_lshlrev_b32 v244, 16, v170
    v_and_b32 v245, 0xffff0000, v170
    v_lshlrev_b32 v246, 16, v171
    v_and_b32 v247, 0xffff0000, v171
    v_lshlrev_b32 v248, 16, v221
    v_and_b32 v249, 0xffff0000, v175
    v_lshlrev_b32 v250, 16, v175
    v_and_b32 v251, 0xffff0000, v174
    v_lshlrev_b32 v252, 16, v174
    v_and_b32 v253, 0xffff0000, v173
    v_lshlrev_b32 v254, 16, v173
    v_and_b32 v255, 0xffff0000, v172
    v_pk_add_f32 v[72:73], v[240:241], v[248:249]
    v_pk_add_f32 v[168:169], v[240:241], v[248:249] neg_lo:[0,1] neg_hi:[0,1]
    v_pk_add_f32 v[74:75], v[242:243], v[250:251]
    v_pk_add_f32 v[170:171], v[242:243], v[250:251] neg_lo:[0,1] neg_hi:[0,1]
    v_pk_add_f32 v[76:77], v[244:245], v[252:253]
    v_pk_add_f32 v[172:173], v[244:245], v[252:253] neg_lo:[0,1] neg_hi:[0,1]
    v_pk_add_f32 v[78:79], v[246:247], v[254:255]
    v_pk_add_f32 v[174:175], v[246:247], v[254:255] neg_lo:[0,1] neg_hi:[0,1]
    v_lshlrev_b32 v240, 16, v176
    v_and_b32 v241, 0xffff0000, v176
    v_lshlrev_b32 v242, 16, v177
    v_and_b32 v243, 0xffff0000, v177
    v_lshlrev_b32 v244, 16, v178
    v_and_b32 v245, 0xffff0000, v178
    v_lshlrev_b32 v246, 16, v179
    v_and_b32 v247, 0xffff0000, v179
    v_lshlrev_b32 v248, 16, v222
    v_and_b32 v249, 0xffff0000, v183
    v_lshlrev_b32 v250, 16, v183
    v_and_b32 v251, 0xffff0000, v182
    v_lshlrev_b32 v252, 16, v182
    v_and_b32 v253, 0xffff0000, v181
    v_lshlrev_b32 v254, 16, v181
    v_and_b32 v255, 0xffff0000, v180
    v_pk_add_f32 v[48:49], v[240:241], v[248:249]
    v_pk_add_f32 v[176:177], v[240:241], v[248:249] neg_lo:[0,1] neg_hi:[0,1]
    v_pk_add_f32 v[50:51], v[242:243], v[250:251]
    v_pk_add_f32 v[178:179], v[242:243], v[250:251] neg_lo:[0,1] neg_hi:[0,1]
    v_pk_add_f32 v[52:53], v[244:245], v[252:253]
    v_pk_add_f32 v[180:181], v[244:245], v[252:253] neg_lo:[0,1] neg_hi:[0,1]
    v_pk_add_f32 v[54:55], v[246:247], v[254:255]
    v_pk_add_f32 v[182:183], v[246:247], v[254:255] neg_lo:[0,1] neg_hi:[0,1]
    v_lshlrev_b32 v240, 16, v184
    v_and_b32 v241, 0xffff0000, v184
    v_lshlrev_b32 v242, 16, v185
    v_and_b32 v243, 0xffff0000, v185
    v_lshlrev_b32 v244, 16, v186
    v_and_b32 v245, 0xffff0000, v186
    v_lshlrev_b32 v246, 16, v187
    v_and_b32 v247, 0xffff0000, v187
    v_lshlrev_b32 v248, 16, v223
    v_and_b32 v249, 0xffff0000, v191
    v_lshlrev_b32 v250, 16, v191
    v_and_b32 v251, 0xffff0000, v190
    v_lshlrev_b32 v252, 16, v190
    v_and_b32 v253, 0xffff0000, v189
    v_lshlrev_b32 v254, 16, v189
    v_and_b32 v255, 0xffff0000, v188
    v_pk_add_f32 v[56:57], v[240:241], v[248:249]
    v_pk_add_f32 v[184:185], v[240:241], v[248:249] neg_lo:[0,1] neg_hi:[0,1]
    v_pk_add_f32 v[58:59], v[242:243], v[250:251]
    v_pk_add_f32 v[186:187], v[242:243], v[250:251] neg_lo:[0,1] neg_hi:[0,1]
    v_pk_add_f32 v[60:61], v[244:245], v[252:253]
    v_pk_add_f32 v[188:189], v[244:245], v[252:253] neg_lo:[0,1] neg_hi:[0,1]
    v_pk_add_f32 v[62:63], v[246:247], v[254:255]
    v_pk_add_f32 v[190:191], v[246:247], v[254:255] neg_lo:[0,1] neg_hi:[0,1]
    v_pk_add_f32 v[224:225], v[224:225], v[72:73]
    v_pk_add_f32 v[48:49], v[48:49], v[56:57]
    v_pk_add_f32 v[160:161], v[160:161], v[168:169] neg_lo:[0,1] neg_hi:[0,1]
    v_pk_add_f32 v[176:177], v[176:177], v[184:185] neg_lo:[0,1] neg_hi:[0,1]
    v_pk_add_f32 v[226:227], v[226:227], v[74:75]
    v_pk_add_f32 v[50:51], v[50:51], v[58:59]
    v_pk_add_f32 v[162:163], v[162:163], v[170:171] neg_lo:[0,1] neg_hi:[0,1]
    v_pk_add_f32 v[178:179], v[178:179], v[186:187] neg_lo:[0,1] neg_hi:[0,1]
    v_pk_add_f32 v[228:229], v[228:229], v[76:77]
    v_pk_add_f32 v[52:53], v[52:53], v[60:61]
    v_pk_add_f32 v[164:165], v[164:165], v[172:173] neg_lo:[0,1] neg_hi:[0,1]
    v_pk_add_f32 v[180:181], v[180:181], v[188:189] neg_lo:[0,1] neg_hi:[0,1]
    v_pk_add_f32 v[230:231], v[230:231], v[78:79]
    v_pk_add_f32 v[54:55], v[54:55], v[62:63]
    v_pk_add_f32 v[166:167], v[166:167], v[174:175] neg_lo:[0,1] neg_hi:[0,1]
    v_pk_add_f32 v[182:183], v[182:183], v[190:191] neg_lo:[0,1] neg_hi:[0,1]
    v_pk_add_f32 v[72:73], v[224:225], v[48:49]
    v_pk_add_f32 v[56:57], v[224:225], v[48:49] neg_lo:[0,1] neg_hi:[0,1]
    v_pk_add_f32 v[168:169], v[160:161], v[176:177] neg_lo:[0,1] neg_hi:[0,1]
    v_pk_add_f32 v[184:185], v[160:161], v[176:177]
    v_pk_add_f32 v[74:75], v[226:227], v[50:51]
    v_pk_add_f32 v[58:59], v[226:227], v[50:51] neg_lo:[0,1] neg_hi:[0,1]
    v_pk_add_f32 v[170:171], v[162:163], v[178:179] neg_lo:[0,1] neg_hi:[0,1]
    v_pk_add_f32 v[186:187], v[162:163], v[178:179]
    v_pk_add_f32 v[76:77], v[228:229], v[52:53]
    v_pk_add_f32 v[60:61], v[228:229], v[52:53] neg_lo:[0,1] neg_hi:[0,1]
    v_pk_add_f32 v[172:173], v[164:165], v[180:181] neg_lo:[0,1] neg_hi:[0,1]
    v_pk_add_f32 v[188:189], v[164:165], v[180:181]
    v_pk_add_f32 v[78:79], v[230:231], v[54:55]
    v_pk_add_f32 v[62:63], v[230:231], v[54:55] neg_lo:[0,1] neg_hi:[0,1]
    v_pk_add_f32 v[174:175], v[166:167], v[182:183] neg_lo:[0,1] neg_hi:[0,1]
    v_pk_add_f32 v[190:191], v[166:167], v[182:183]
    v_pk_add_f32 v[20:21], v[20:21], v[72:73]
    v_pk_add_f32 v[22:23], v[22:23], v[56:57]
    v_pk_add_f32 v[20:21], v[20:21], v[74:75]
    v_pk_add_f32 v[22:23], v[22:23], v[58:59]
    v_pk_add_f32 v[20:21], v[20:21], v[76:77]
    v_pk_add_f32 v[22:23], v[22:23], v[60:61]
    v_pk_add_f32 v[20:21], v[20:21], v[78:79]
    v_pk_add_f32 v[22:23], v[22:23], v[62:63]
    v_cvt_pk_bf16_f32 v160, v72, v73
    v_cvt_pk_bf16_f32 v161, v74, v75
    v_cvt_pk_bf16_f32 v162, v76, v77
    v_cvt_pk_bf16_f32 v163, v78, v79
    s_add_u32 s26, s22, 8320
    buffer_store_dwordx4 v[160:163], v25, s[12:15], s26 offen sc1
    v_cvt_pk_bf16_f32 v164, v56, v57
    v_cvt_pk_bf16_f32 v165, v58, v59
    v_cvt_pk_bf16_f32 v166, v60, v61
    v_cvt_pk_bf16_f32 v167, v62, v63
    s_add_u32 s26, s22, 532608
    buffer_store_dwordx4 v[164:167], v25, s[12:15], s26 offen sc1
    v_cvt_pk_bf16_f32 v176, v168, v169
    v_cvt_pk_bf16_f32 v177, v170, v171
    v_cvt_pk_bf16_f32 v178, v172, v173
    v_cvt_pk_bf16_f32 v179, v174, v175
    s_add_u32 s26, s22, 1056896
    buffer_store_dwordx4 v[176:179], v25, s[12:15], s26 offen sc1
    v_cvt_pk_bf16_f32 v180, v184, v185
    v_cvt_pk_bf16_f32 v181, v186, v187
    v_cvt_pk_bf16_f32 v182, v188, v189
    v_cvt_pk_bf16_f32 v183, v190, v191
    s_add_u32 s26, s22, 1581184
    buffer_store_dwordx4 v[180:183], v25, s[12:15], s26 offen sc1
    s_cmp_eq_u32 s3, 3
    s_cselect_b32 s26, 0x80808080, 0
    s_mov_b32 s27, s26
    v_sub_f32 v16, v16, v17
    v_sub_f32 v17, v18, v19
    v_sub_f32 v18, v20, v21
    v_sub_f32 v19, v22, v23

    v_cndmask_b32 v20, 0, v26, s[26:27]
    v_cndmask_b32 v21, 0, v27, s[26:27]
    v_cndmask_b32 v22, 0, v28, s[26:27]
    v_cndmask_b32 v23, 0, v29, s[26:27]
    v_add_f32 v16, v16, v20
    v_add_f32 v17, v17, v21
    v_add_f32 v18, v18, v22
    v_add_f32 v19, v19, v23
    s_nop 0
    v_add_f32_dpp v8, v8, v8 quad_perm:[1,0,3,2] row_mask:0xf bank_mask:0xf
    v_add_f32_dpp v9, v9, v9 quad_perm:[1,0,3,2] row_mask:0xf bank_mask:0xf
    v_add_f32_dpp v10, v10, v10 quad_perm:[1,0,3,2] row_mask:0xf bank_mask:0xf
    v_add_f32_dpp v11, v11, v11 quad_perm:[1,0,3,2] row_mask:0xf bank_mask:0xf
    v_add_f32_dpp v12, v12, v12 quad_perm:[1,0,3,2] row_mask:0xf bank_mask:0xf
    v_add_f32_dpp v13, v13, v13 quad_perm:[1,0,3,2] row_mask:0xf bank_mask:0xf
    v_add_f32_dpp v14, v14, v14 quad_perm:[1,0,3,2] row_mask:0xf bank_mask:0xf
    v_add_f32_dpp v15, v15, v15 quad_perm:[1,0,3,2] row_mask:0xf bank_mask:0xf
    v_add_f32_dpp v16, v16, v16 quad_perm:[1,0,3,2] row_mask:0xf bank_mask:0xf
    v_add_f32_dpp v17, v17, v17 quad_perm:[1,0,3,2] row_mask:0xf bank_mask:0xf
    v_add_f32_dpp v18, v18, v18 quad_perm:[1,0,3,2] row_mask:0xf bank_mask:0xf
    v_add_f32_dpp v19, v19, v19 quad_perm:[1,0,3,2] row_mask:0xf bank_mask:0xf
    v_add_f32_dpp v8, v8, v8 quad_perm:[2,3,0,1] row_mask:0xf bank_mask:0xf
    v_add_f32_dpp v9, v9, v9 quad_perm:[2,3,0,1] row_mask:0xf bank_mask:0xf
    v_add_f32_dpp v10, v10, v10 quad_perm:[2,3,0,1] row_mask:0xf bank_mask:0xf
    v_add_f32_dpp v11, v11, v11 quad_perm:[2,3,0,1] row_mask:0xf bank_mask:0xf
    v_add_f32_dpp v12, v12, v12 quad_perm:[2,3,0,1] row_mask:0xf bank_mask:0xf
    v_add_f32_dpp v13, v13, v13 quad_perm:[2,3,0,1] row_mask:0xf bank_mask:0xf
    v_add_f32_dpp v14, v14, v14 quad_perm:[2,3,0,1] row_mask:0xf bank_mask:0xf
    v_add_f32_dpp v15, v15, v15 quad_perm:[2,3,0,1] row_mask:0xf bank_mask:0xf
    v_add_f32_dpp v16, v16, v16 quad_perm:[2,3,0,1] row_mask:0xf bank_mask:0xf
    v_add_f32_dpp v17, v17, v17 quad_perm:[2,3,0,1] row_mask:0xf bank_mask:0xf
    v_add_f32_dpp v18, v18, v18 quad_perm:[2,3,0,1] row_mask:0xf bank_mask:0xf
    v_add_f32_dpp v19, v19, v19 quad_perm:[2,3,0,1] row_mask:0xf bank_mask:0xf
    v_add_f32_dpp v8, v8, v8 row_half_mirror row_mask:0xf bank_mask:0xf
    v_add_f32_dpp v9, v9, v9 row_half_mirror row_mask:0xf bank_mask:0xf
    v_add_f32_dpp v10, v10, v10 row_half_mirror row_mask:0xf bank_mask:0xf
    v_add_f32_dpp v11, v11, v11 row_half_mirror row_mask:0xf bank_mask:0xf
    v_add_f32_dpp v12, v12, v12 row_half_mirror row_mask:0xf bank_mask:0xf
    v_add_f32_dpp v13, v13, v13 row_half_mirror row_mask:0xf bank_mask:0xf
    v_add_f32_dpp v14, v14, v14 row_half_mirror row_mask:0xf bank_mask:0xf
    v_add_f32_dpp v15, v15, v15 row_half_mirror row_mask:0xf bank_mask:0xf
    v_add_f32_dpp v16, v16, v16 row_half_mirror row_mask:0xf bank_mask:0xf
    v_add_f32_dpp v17, v17, v17 row_half_mirror row_mask:0xf bank_mask:0xf
    v_add_f32_dpp v18, v18, v18 row_half_mirror row_mask:0xf bank_mask:0xf
    v_add_f32_dpp v19, v19, v19 row_half_mirror row_mask:0xf bank_mask:0xf
    s_lshl_b32 s26, s3, 2
    s_lshl_b32 s27, s3, 11
    s_add_u32 s27, s27, 25329664
    s_mov_b32 s28, 25362432
    s_add_u32 s29, s27, 8192

    v_lshl_add_u32 v68, v40, 4, s26
    v_lshl_add_u32 v69, v41, 4, s26
    v_lshl_add_u32 v70, v42, 4, s26
    v_lshl_add_u32 v71, v43, 4, s26
    v_lshl_add_u32 v72, v44, 4, s26
    v_lshl_add_u32 v73, v45, 4, s26
    v_lshl_add_u32 v74, v46, 4, s26
    v_lshl_add_u32 v75, v47, 4, s26
    v_lshlrev_b32 v76, 2, v40
    s_mov_b32 s26, 25296896
    s_mov_b64 exec, s[70:71]
    buffer_store_dword v8, v68, s[12:15], s26 offen sc1
    buffer_store_dword v9, v69, s[12:15], s26 offen sc1
    buffer_store_dword v10, v70, s[12:15], s26 offen sc1
    buffer_store_dword v11, v71, s[12:15], s26 offen sc1
    buffer_store_dword v12, v72, s[12:15], s26 offen sc1
    buffer_store_dword v13, v73, s[12:15], s26 offen sc1
    buffer_store_dword v14, v74, s[12:15], s26 offen sc1
    buffer_store_dword v15, v75, s[12:15], s26 offen sc1
    buffer_store_dword v16, v76, s[12:15], s27 offen offset:0 sc1
    buffer_store_dword v17, v76, s[12:15], s29 offen offset:0 sc1
    buffer_store_dword v18, v76, s[12:15], s27 offen offset:32 sc1
    buffer_store_dword v19, v76, s[12:15], s29 offen offset:32 sc1
    s_mov_b64 exec, -1
    s_cmp_lg_u32 s3, 3
    s_cbranch_scc1 L_fc2
    s_mov_b32 exec_lo, 0x80808080
    s_mov_b32 exec_hi, 0x80808080
    buffer_store_dword v26, v76, s[12:15], s28 offen sc1
    buffer_store_dword v27, v76, s[12:15], s28 offen offset:2048 sc1
    buffer_store_dword v28, v76, s[12:15], s28 offen offset:32 sc1
    buffer_store_dword v29, v76, s[12:15], s28 offen offset:2080 sc1
    s_mov_b64 exec, -1
L_fc2:

    s_lshl_b32 s23, s66, 2
    s_add_u32 s23, s23, s67
    s_lshl_b32 s23, s23, 7
    s_add_u32 s23, s23, 26230784
    s_waitcnt vmcnt(0)
    s_barrier
    s_cmp_lg_u32 s3, 0
    s_cbranch_scc1 L_pub_3740
    v_lshlrev_b32 v2, 3, v1
    v_mov_b32 v4, s98
    v_mov_b32 v5, s99
    s_mov_b64 exec, 65535
    buffer_store_dwordx2 v[4:5], v2, s[12:15], s23 offen sc1
    s_mov_b64 exec, -1

L_pub_3740:
    v_mov_b32 v56, 0
    v_mov_b32 v57, 0
    v_mov_b32 v58, 0
    v_mov_b32 v59, 0
    s_lshl_b32 s26, s67, 5
    s_lshl_b32 s27, s3, 3
    s_add_u32 s26, s26, s27
    s_lshl_b32 s27, s26, 7
    v_lshrrev_b32 v2, 3, v1
    v_lshlrev_b32 v2, 14, v2
    v_add_u32 v2, s27, v2
    s_lshr_b32 s26, s26, 1
    v_and_b32 v3, 7, v1
    v_xor_b32 v3, s26, v3
    v_and_b32 v3, 7, v3

    v_xor_b32 v4, 0, v3
    v_lshl_add_u32 v4, v4, 4, v2
    ds_read_b128 v[208:211], v4 offset:0
    v_xor_b32 v4, 0, v3
    v_lshl_add_u32 v4, v4, 4, v2
    ds_read_b128 v[212:215], v4 offset:128
    v_xor_b32 v4, 1, v3
    v_lshl_add_u32 v4, v4, 4, v2
    ds_read_b128 v[216:219], v4 offset:256
    v_xor_b32 v4, 1, v3
    v_lshl_add_u32 v4, v4, 4, v2
    ds_read_b128 v[220:223], v4 offset:384
    v_xor_b32 v4, 2, v3
    v_lshl_add_u32 v4, v4, 4, v2
    ds_read_b128 v[224:227], v4 offset:512
    v_xor_b32 v4, 2, v3
    v_lshl_add_u32 v4, v4, 4, v2
    ds_read_b128 v[228:231], v4 offset:640
    v_xor_b32 v4, 3, v3
    v_lshl_add_u32 v4, v4, 4, v2
    ds_read_b128 v[232:235], v4 offset:768
    v_xor_b32 v4, 3, v3
    v_lshl_add_u32 v4, v4, 4, v2
    ds_read_b128 v[236:239], v4 offset:896
    v_mov_b32 v40, 0
    v_mov_b32 v41, 0
    v_mov_b32 v42, 0
    v_mov_b32 v43, 0
    v_mov_b32 v44, 0
    v_mov_b32 v45, 0
    v_mov_b32 v46, 0
    v_mov_b32 v47, 0
    s_waitcnt lgkmcnt(0)
    v_dot2_f32_bf16 v40, v208, v36, v40
    v_dot2_f32_bf16 v41, v212, v36, v41
    v_dot2_f32_bf16 v42, v216, v36, v42
    v_dot2_f32_bf16 v43, v220, v36, v43
    v_dot2_f32_bf16 v44, v224, v36, v44
    v_dot2_f32_bf16 v45, v228, v36, v45
    v_dot2_f32_bf16 v46, v232, v36, v46
    v_dot2_f32_bf16 v47, v236, v36, v47
    v_dot2_f32_bf16 v40, v209, v37, v40
    v_dot2_f32_bf16 v41, v213, v37, v41
    v_dot2_f32_bf16 v42, v217, v37, v42
    v_dot2_f32_bf16 v43, v221, v37, v43
    v_dot2_f32_bf16 v44, v225, v37, v44
    v_dot2_f32_bf16 v45, v229, v37, v45
    v_dot2_f32_bf16 v46, v233, v37, v46
    v_dot2_f32_bf16 v47, v237, v37, v47
    v_dot2_f32_bf16 v40, v210, v38, v40
    v_dot2_f32_bf16 v41, v214, v38, v41
    v_dot2_f32_bf16 v42, v218, v38, v42
    v_dot2_f32_bf16 v43, v222, v38, v43
    v_dot2_f32_bf16 v44, v226, v38, v44
    v_dot2_f32_bf16 v45, v230, v38, v45
    v_dot2_f32_bf16 v46, v234, v38, v46
    v_dot2_f32_bf16 v47, v238, v38, v47
    v_dot2_f32_bf16 v40, v211, v39, v40
    v_dot2_f32_bf16 v41, v215, v39, v41
    v_dot2_f32_bf16 v42, v219, v39, v42
    v_dot2_f32_bf16 v43, v223, v39, v43
    v_dot2_f32_bf16 v44, v227, v39, v44
    v_dot2_f32_bf16 v45, v231, v39, v45
    v_dot2_f32_bf16 v46, v235, v39, v46
    v_dot2_f32_bf16 v47, v239, v39, v47
    s_nop 2
    s_nop 1
    v_add_f32_dpp v40, v40, v40 row_ror:1 row_mask:0xf bank_mask:0xf
    v_add_f32_dpp v41, v41, v41 row_ror:1 row_mask:0xf bank_mask:0xf
    v_add_f32_dpp v42, v42, v42 row_ror:1 row_mask:0xf bank_mask:0xf
    v_add_f32_dpp v43, v43, v43 row_ror:1 row_mask:0xf bank_mask:0xf
    v_add_f32_dpp v44, v44, v44 row_ror:1 row_mask:0xf bank_mask:0xf
    v_add_f32_dpp v45, v45, v45 row_ror:1 row_mask:0xf bank_mask:0xf
    v_add_f32_dpp v46, v46, v46 row_ror:1 row_mask:0xf bank_mask:0xf
    v_add_f32_dpp v47, v47, v47 row_ror:1 row_mask:0xf bank_mask:0xf
    s_nop 1
    v_add_f32_dpp v40, v40, v40 row_ror:2 row_mask:0xf bank_mask:0xf
    v_add_f32_dpp v41, v41, v41 row_ror:2 row_mask:0xf bank_mask:0xf
    v_add_f32_dpp v42, v42, v42 row_ror:2 row_mask:0xf bank_mask:0xf
    v_add_f32_dpp v43, v43, v43 row_ror:2 row_mask:0xf bank_mask:0xf
    v_add_f32_dpp v44, v44, v44 row_ror:2 row_mask:0xf bank_mask:0xf
    v_add_f32_dpp v45, v45, v45 row_ror:2 row_mask:0xf bank_mask:0xf
    v_add_f32_dpp v46, v46, v46 row_ror:2 row_mask:0xf bank_mask:0xf
    v_add_f32_dpp v47, v47, v47 row_ror:2 row_mask:0xf bank_mask:0xf
    s_nop 1
    v_add_f32_dpp v40, v40, v40 row_ror:4 row_mask:0xf bank_mask:0xf
    v_add_f32_dpp v41, v41, v41 row_ror:4 row_mask:0xf bank_mask:0xf
    v_add_f32_dpp v42, v42, v42 row_ror:4 row_mask:0xf bank_mask:0xf
    v_add_f32_dpp v43, v43, v43 row_ror:4 row_mask:0xf bank_mask:0xf
    v_add_f32_dpp v44, v44, v44 row_ror:4 row_mask:0xf bank_mask:0xf
    v_add_f32_dpp v45, v45, v45 row_ror:4 row_mask:0xf bank_mask:0xf
    v_add_f32_dpp v46, v46, v46 row_ror:4 row_mask:0xf bank_mask:0xf
    v_add_f32_dpp v47, v47, v47 row_ror:4 row_mask:0xf bank_mask:0xf
    s_nop 1
    v_add_f32_dpp v40, v40, v40 row_ror:8 row_mask:0xf bank_mask:0xf
    v_add_f32_dpp v41, v41, v41 row_ror:8 row_mask:0xf bank_mask:0xf
    v_add_f32_dpp v42, v42, v42 row_ror:8 row_mask:0xf bank_mask:0xf
    v_add_f32_dpp v43, v43, v43 row_ror:8 row_mask:0xf bank_mask:0xf
    v_add_f32_dpp v44, v44, v44 row_ror:8 row_mask:0xf bank_mask:0xf
    v_add_f32_dpp v45, v45, v45 row_ror:8 row_mask:0xf bank_mask:0xf
    v_add_f32_dpp v46, v46, v46 row_ror:8 row_mask:0xf bank_mask:0xf
    v_add_f32_dpp v47, v47, v47 row_ror:8 row_mask:0xf bank_mask:0xf
    v_mov_b32 v48, v40
    v_mov_b32 v49, v41
    v_mov_b32 v50, v42
    v_mov_b32 v51, v43
    v_mov_b32 v52, v44
    v_mov_b32 v53, v45
    v_mov_b32 v54, v46
    v_mov_b32 v55, v47
    s_nop 1
    v_permlane16_swap_b32 v40, v48
    v_permlane16_swap_b32 v41, v49
    v_permlane16_swap_b32 v42, v50
    v_permlane16_swap_b32 v43, v51
    v_permlane16_swap_b32 v44, v52
    v_permlane16_swap_b32 v45, v53
    v_permlane16_swap_b32 v46, v54
    v_permlane16_swap_b32 v47, v55
    s_nop 1
    v_add_f32 v40, v40, v48
    v_add_f32 v41, v41, v49
    v_add_f32 v42, v42, v50
    v_add_f32 v43, v43, v51
    v_add_f32 v44, v44, v52
    v_add_f32 v45, v45, v53
    v_add_f32 v46, v46, v54
    v_add_f32 v47, v47, v55
    v_mov_b32 v48, v40
    v_mov_b32 v49, v41
    v_mov_b32 v50, v42
    v_mov_b32 v51, v43
    v_mov_b32 v52, v44
    v_mov_b32 v53, v45
    v_mov_b32 v54, v46
    v_mov_b32 v55, v47
    s_nop 1
    v_permlane32_swap_b32 v40, v48
    v_permlane32_swap_b32 v41, v49
    v_permlane32_swap_b32 v42, v50
    v_permlane32_swap_b32 v43, v51
    v_permlane32_swap_b32 v44, v52
    v_permlane32_swap_b32 v45, v53
    v_permlane32_swap_b32 v46, v54
    v_permlane32_swap_b32 v47, v55
    s_nop 1
    v_add_f32 v40, v40, v48
    v_add_f32 v41, v41, v49
    v_add_f32 v42, v42, v50
    v_add_f32 v43, v43, v51
    v_add_f32 v44, v44, v52
    v_add_f32 v45, v45, v53
    v_add_f32 v46, v46, v54
    v_add_f32 v47, v47, v55
    v_cmp_eq_u32 vcc, 1, v1
    s_nop 1
    v_cndmask_b32 v40, v40, v41, vcc
    v_cmp_eq_u32 vcc, 2, v1
    s_nop 1
    v_cndmask_b32 v40, v40, v42, vcc
    v_cmp_eq_u32 vcc, 3, v1
    s_nop 1
    v_cndmask_b32 v40, v40, v43, vcc
    v_cmp_eq_u32 vcc, 4, v1
    s_nop 1
    v_cndmask_b32 v40, v40, v44, vcc
    v_cmp_eq_u32 vcc, 5, v1
    s_nop 1
    v_cndmask_b32 v40, v40, v45, vcc
    v_cmp_eq_u32 vcc, 6, v1
    s_nop 1
    v_cndmask_b32 v40, v40, v46, vcc
    v_cmp_eq_u32 vcc, 7, v1
    s_nop 1
    v_cndmask_b32 v40, v40, v47, vcc
    v_mfma_f32_32x32x16_bf16 v[64:79], v[56:59], v[56:59], 0
    v_mfma_f32_32x32x16_bf16 a[0:15], v[56:59], v[56:59], 0
    v_mfma_f32_32x32x16_bf16 v[80:95], v[56:59], v[56:59], 0
    v_mfma_f32_32x32x16_bf16 a[16:31], v[56:59], v[56:59], 0
    v_mfma_f32_32x32x16_bf16 v[96:111], v[56:59], v[56:59], 0
    v_mfma_f32_32x32x16_bf16 a[32:47], v[56:59], v[56:59], 0
    v_mfma_f32_32x32x16_bf16 v[112:127], v[56:59], v[56:59], 0
    v_mfma_f32_32x32x16_bf16 a[48:63], v[56:59], v[56:59], 0
    v_mfma_f32_32x32x16_bf16 v[128:143], v[56:59], v[56:59], 0
    v_mfma_f32_32x32x16_bf16 a[64:79], v[56:59], v[56:59], 0
    v_mfma_f32_32x32x16_bf16 v[144:159], v[56:59], v[56:59], 0
    v_mfma_f32_32x32x16_bf16 a[80:95], v[56:59], v[56:59], 0
    v_mfma_f32_32x32x16_bf16 v[160:175], v[56:59], v[56:59], 0
    v_mfma_f32_32x32x16_bf16 a[96:111], v[56:59], v[56:59], 0
    v_mfma_f32_32x32x16_bf16 v[176:191], v[56:59], v[56:59], 0
    v_mfma_f32_32x32x16_bf16 a[112:127], v[56:59], v[56:59], 0
    v_lshlrev_b32 v2, 31, v1
    v_xor_b32 v2, s75, v2
    v_add_f32 v40, v40, v2
    s_lshl_b32 s26, s66, 7
    s_lshl_b32 s27, s67, 5
    s_add_u32 s26, s26, s27
    s_lshl_b32 s27, s3, 3
    s_add_u32 s26, s26, s27
    s_lshl_b32 s26, s26, 2
    s_add_u32 s26, s26, 25366528
    v_lshlrev_b32 v2, 2, v1
    s_mov_b64 exec, 0xff
    buffer_store_dword v40, v2, s[12:15], s26 offen sc1
    s_mov_b64 exec, -1

    v_lshrrev_b32 v2, 3, v1
    s_lshl_b32 s26, s3, 5
    v_add_u32 v2, s26, v2
    v_lshlrev_b32 v2, 13, v2
    v_add_u32 v2, s24, v2
    v_lshrrev_b32 v3, 4, v1
    v_and_b32 v4, 7, v1
    v_xor_b32 v3, v3, v4
    v_lshl_add_u32 v20, v3, 4, v2
    v_xor_b32 v3, 4, v3
    v_lshl_add_u32 v21, v3, 4, v2
    v_add_u32 v22, 129024, v20
    v_add_u32 v23, 193536, v21
    v_add_u32 v21, 64512, v21

    v_lshlrev_b32 v12, 4, v1
    v_and_b32 v2, 15, v1
    v_lshrrev_b32 v3, 1, v2
    v_lshrrev_b32 v4, 4, v1
    v_xor_b32 v3, v3, v4
    v_lshlrev_b32 v2, 7, v2
    v_lshl_add_u32 v16, v3, 4, v2
    v_xor_b32 v3, 4, v3
    v_lshl_add_u32 v17, v3, 4, v2

    s_lshl_b32 s26, s30, 1
    s_lshr_b32 s27, s67, 1
    s_add_u32 s26, s26, s27
    s_lshl_b32 s26, s26, 3
    s_and_b32 s27, s67, 1
    s_lshl_b32 s27, s27, 2
    s_add_u32 s26, s26, s27
    s_add_u32 s26, s26, s3
    s_lshl_b32 s26, s26, 16
    s_add_u32 s22, s26, 16842752

    s_add_u32 s32, s48, s22
    s_addc_u32 s33, s49, 0
    s_and_b32 s33, s33, 0xffff
    s_mov_b32 s34, 65536
    s_mov_b32 s35, 0x20000
    s_and_b32 s23, s67, 1
    s_lshl_b32 s23, s23, 2
    s_add_u32 s23, s23, s3
    s_lshl_b32 s23, s23, 9
    s_add_u32 s23, s23, 26230784
    v_cmp_gt_u32 vcc, 4, v1
    v_lshlrev_b32 v6, 7, v1
    v_mov_b32 v7, 1073741824
    v_cndmask_b32 v6, v7, v6, vcc
    s_mov_b32 s27, 0
    buffer_load_dwordx2 v[48:49], v6, s[12:15], s23 offen sc1
    s_sleep 4
    buffer_load_dwordx2 v[50:51], v6, s[12:15], s23 offen sc1
    s_sleep 4
L_poll_4018:
    buffer_load_dwordx2 v[52:53], v6, s[12:15], s23 offen sc1
    s_waitcnt vmcnt(2)
    v_cmp_ne_u32 vcc, s98, v48
    v_cmp_ne_u32 s[28:29], s99, v49
    s_or_b64 vcc, vcc, s[28:29]
    s_and_b64 s[64:65], vcc, 0xf
    s_cbranch_scc0 L_poll_4018_done
    s_sleep 1
    buffer_load_dwordx2 v[48:49], v6, s[12:15], s23 offen sc1
    s_waitcnt vmcnt(2)
    v_cmp_ne_u32 vcc, s98, v50
    v_cmp_ne_u32 s[28:29], s99, v51
    s_or_b64 vcc, vcc, s[28:29]
    s_and_b64 s[64:65], vcc, 0xf
    s_cbranch_scc0 L_poll_4018_done
    s_sleep 1
    buffer_load_dwordx2 v[50:51], v6, s[12:15], s23 offen sc1
    s_waitcnt vmcnt(2)
    v_cmp_ne_u32 vcc, s98, v52
    v_cmp_ne_u32 s[28:29], s99, v53
    s_or_b64 vcc, vcc, s[28:29]
    s_and_b64 s[64:65], vcc, 0xf
    s_cbranch_scc0 L_poll_4018_done
    s_sleep 1
    s_add_u32 s27, s27, 1
    s_cmp_lt_u32 s27, 0x20000
    s_cbranch_scc1 L_poll_4018
L_poll_4018_done:

    s_lshl_b32 s22, s67, 10
    s_add_u32 s22, s22, 25362432
    s_cmp_eq_u32 s30, 0
    s_cselect_b32 s23, 1.0, 0
    v_lshrrev_b32 v2, 4, v1
    v_lshlrev_b32 v2, 4, v2
    s_lshl_b32 s26, s3, 8
    v_add_u32 v2, s26, v2
    buffer_load_dwordx4 v[192:195], v2, s[12:15], s22 offen offset:0 sc1
    buffer_load_dwordx4 v[196:199], v2, s[12:15], s22 offen offset:64 sc1
    buffer_load_dwordx4 v[200:203], v2, s[12:15], s22 offen offset:128 sc1
    buffer_load_dwordx4 v[204:207], v2, s[12:15], s22 offen offset:192 sc1
    s_mov_b32 s74, s23
    s_mov_b32 s16, 0
    buffer_load_dwordx4 a[192:195], v12, s[32:35], s16 offen offset:0 sc1
    buffer_load_dwordx4 a[196:199], v12, s[32:35], s16 offen offset:1024 sc1
    buffer_load_dwordx4 a[200:203], v12, s[32:35], s16 offen offset:2048 sc1
    buffer_load_dwordx4 a[204:207], v12, s[32:35], s16 offen offset:3072 sc1
    s_add_u32 s16, s16, 4096
    buffer_load_dwordx4 a[208:211], v12, s[32:35], s16 offen offset:0 sc1
    buffer_load_dwordx4 a[212:215], v12, s[32:35], s16 offen offset:1024 sc1
    buffer_load_dwordx4 a[216:219], v12, s[32:35], s16 offen offset:2048 sc1
    buffer_load_dwordx4 a[220:223], v12, s[32:35], s16 offen offset:3072 sc1
    s_add_u32 s16, s16, 4096
    buffer_load_dwordx4 a[224:227], v12, s[32:35], s16 offen offset:0 sc1
    buffer_load_dwordx4 a[228:231], v12, s[32:35], s16 offen offset:1024 sc1
    buffer_load_dwordx4 a[232:235], v12, s[32:35], s16 offen offset:2048 sc1
    buffer_load_dwordx4 a[236:239], v12, s[32:35], s16 offen offset:3072 sc1
    s_add_u32 s16, s16, 4096
    buffer_load_dwordx4 a[240:243], v12, s[32:35], s16 offen offset:0 sc1
    buffer_load_dwordx4 a[244:247], v12, s[32:35], s16 offen offset:1024 sc1
    buffer_load_dwordx4 a[248:251], v12, s[32:35], s16 offen offset:2048 sc1
    buffer_load_dwordx4 a[252:255], v12, s[32:35], s16 offen offset:3072 sc1
    s_add_u32 s16, s16, 4096
    v_mov_b32 v18, v16
    v_mov_b32 v19, v17
    ds_read_b128 a[128:131], v18 offset:0
    ds_read_b128 a[132:135], v18 offset:2048
    ds_read_b128 a[136:139], v18 offset:4096
    ds_read_b128 a[140:143], v18 offset:6144
    ds_read_b128 a[144:147], v18 offset:8192
    ds_read_b128 a[148:151], v18 offset:10240
    ds_read_b128 a[152:155], v18 offset:12288
    ds_read_b128 a[156:159], v18 offset:14336
    s_mov_b32 s19, 0
    s_mov_b32 s20, 16384

    s_mov_b32 s18, 0
    s_mov_b32 s17, 0
    .p2align 6
L_d1_loop:
    s_mov_b32 s31, 26230784
    v_and_b32 v6, 31, v1
    v_lshlrev_b32 v6, 7, v6
    buffer_load_dwordx2 v[48:49], v6, s[12:15], s31 offen sc1
    s_waitcnt vmcnt(12) lgkmcnt(0)
    v_mfma_f32_16x16x32_bf16 v[64:67], a[192:195], a[128:131], v[64:67]
    v_mfma_f32_16x16x32_bf16 v[80:83], a[192:195], a[132:135], v[80:83]
    ds_read_b128 a[160:163], v19 offset:0
    v_mfma_f32_16x16x32_bf16 v[96:99], a[192:195], a[136:139], v[96:99]
    v_mfma_f32_16x16x32_bf16 v[112:115], a[192:195], a[140:143], v[112:115]
    ds_read_b128 a[164:167], v19 offset:2048
    v_mfma_f32_16x16x32_bf16 v[128:131], a[192:195], a[144:147], v[128:131]
    v_mfma_f32_16x16x32_bf16 v[144:147], a[192:195], a[148:151], v[144:147]
    ds_read_b128 a[168:171], v19 offset:4096
    v_mfma_f32_16x16x32_bf16 v[160:163], a[192:195], a[152:155], v[160:163]
    v_mfma_f32_16x16x32_bf16 v[176:179], a[192:195], a[156:159], v[176:179]
    ds_read_b128 a[172:175], v19 offset:6144
    buffer_load_dwordx4 a[192:195], v12, s[32:35], s16 offen offset:0 sc1
    v_mfma_f32_16x16x32_bf16 v[68:71], a[196:199], a[128:131], v[68:71]
    v_mfma_f32_16x16x32_bf16 v[84:87], a[196:199], a[132:135], v[84:87]
    ds_read_b128 a[176:179], v19 offset:8192
    v_mfma_f32_16x16x32_bf16 v[100:103], a[196:199], a[136:139], v[100:103]
    v_mfma_f32_16x16x32_bf16 v[116:119], a[196:199], a[140:143], v[116:119]
    ds_read_b128 a[180:183], v19 offset:10240
    v_mfma_f32_16x16x32_bf16 v[132:135], a[196:199], a[144:147], v[132:135]
    v_mfma_f32_16x16x32_bf16 v[148:151], a[196:199], a[148:151], v[148:151]
    ds_read_b128 a[184:187], v19 offset:12288
    v_mfma_f32_16x16x32_bf16 v[164:167], a[196:199], a[152:155], v[164:167]
    v_mfma_f32_16x16x32_bf16 v[180:183], a[196:199], a[156:159], v[180:183]
    ds_read_b128 a[188:191], v19 offset:14336
    buffer_load_dwordx4 a[196:199], v12, s[32:35], s16 offen offset:1024 sc1
    v_mfma_f32_16x16x32_bf16 v[72:75], a[200:203], a[128:131], v[72:75]
    v_mfma_f32_16x16x32_bf16 v[88:91], a[200:203], a[132:135], v[88:91]
    v_mfma_f32_16x16x32_bf16 v[104:107], a[200:203], a[136:139], v[104:107]
    v_mfma_f32_16x16x32_bf16 v[120:123], a[200:203], a[140:143], v[120:123]
    v_mfma_f32_16x16x32_bf16 v[136:139], a[200:203], a[144:147], v[136:139]
    v_mfma_f32_16x16x32_bf16 v[152:155], a[200:203], a[148:151], v[152:155]
    v_mfma_f32_16x16x32_bf16 v[168:171], a[200:203], a[152:155], v[168:171]
    v_mfma_f32_16x16x32_bf16 v[184:187], a[200:203], a[156:159], v[184:187]
    buffer_load_dwordx4 a[200:203], v12, s[32:35], s16 offen offset:2048 sc1
    v_mfma_f32_16x16x32_bf16 v[76:79], a[204:207], a[128:131], v[76:79]
    v_mfma_f32_16x16x32_bf16 v[92:95], a[204:207], a[132:135], v[92:95]
    v_mfma_f32_16x16x32_bf16 v[108:111], a[204:207], a[136:139], v[108:111]
    v_mfma_f32_16x16x32_bf16 v[124:127], a[204:207], a[140:143], v[124:127]
    v_mfma_f32_16x16x32_bf16 v[140:143], a[204:207], a[144:147], v[140:143]
    v_mfma_f32_16x16x32_bf16 v[156:159], a[204:207], a[148:151], v[156:159]
    v_mfma_f32_16x16x32_bf16 v[172:175], a[204:207], a[152:155], v[172:175]
    v_mfma_f32_16x16x32_bf16 v[188:191], a[204:207], a[156:159], v[188:191]
    buffer_load_dwordx4 a[204:207], v12, s[32:35], s16 offen offset:3072 sc1
    s_add_u32 s16, s16, 4096
    s_waitcnt vmcnt(12) lgkmcnt(0)
    v_mfma_f32_16x16x32_bf16 v[64:67], a[208:211], a[160:163], v[64:67]
    s_barrier
    v_add_u32 v18, s20, v16
    v_mfma_f32_16x16x32_bf16 v[80:83], a[208:211], a[164:167], v[80:83]
    ds_read_b128 a[128:131], v18 offset:0
    s_add_u32 m0, s21, s19
    v_mfma_f32_16x16x32_bf16 v[96:99], a[208:211], a[168:171], v[96:99]
    buffer_load_dwordx4 v20, s[36:39], s17 offen offset:0 lds
    v_mfma_f32_16x16x32_bf16 v[112:115], a[208:211], a[172:175], v[112:115]
    ds_read_b128 a[132:135], v18 offset:2048
    v_mfma_f32_16x16x32_bf16 v[128:131], a[208:211], a[176:179], v[128:131]
    v_mfma_f32_16x16x32_bf16 v[144:147], a[208:211], a[180:183], v[144:147]
    ds_read_b128 a[136:139], v18 offset:4096
    v_mfma_f32_16x16x32_bf16 v[160:163], a[208:211], a[184:187], v[160:163]
    v_mfma_f32_16x16x32_bf16 v[176:179], a[208:211], a[188:191], v[176:179]
    ds_read_b128 a[140:143], v18 offset:6144
    buffer_load_dwordx4 a[208:211], v12, s[32:35], s16 offen offset:0 sc1
    v_mfma_f32_16x16x32_bf16 v[68:71], a[212:215], a[160:163], v[68:71]
    buffer_load_dwordx4 v21, s[36:39], s17 offen offset:1024 lds
    v_mfma_f32_16x16x32_bf16 v[84:87], a[212:215], a[164:167], v[84:87]
    ds_read_b128 a[144:147], v18 offset:8192
    v_mfma_f32_16x16x32_bf16 v[100:103], a[212:215], a[168:171], v[100:103]
    v_mfma_f32_16x16x32_bf16 v[116:119], a[212:215], a[172:175], v[116:119]
    ds_read_b128 a[148:151], v18 offset:10240
    v_mfma_f32_16x16x32_bf16 v[132:135], a[212:215], a[176:179], v[132:135]
    v_mfma_f32_16x16x32_bf16 v[148:151], a[212:215], a[180:183], v[148:151]
    ds_read_b128 a[152:155], v18 offset:12288
    v_mfma_f32_16x16x32_bf16 v[164:167], a[212:215], a[184:187], v[164:167]
    buffer_load_dwordx4 v22, s[36:39], s17 offen offset:2048 lds
    v_mfma_f32_16x16x32_bf16 v[180:183], a[212:215], a[188:191], v[180:183]
    ds_read_b128 a[156:159], v18 offset:14336
    buffer_load_dwordx4 a[212:215], v12, s[32:35], s16 offen offset:1024 sc1
    v_mfma_f32_16x16x32_bf16 v[72:75], a[216:219], a[160:163], v[72:75]
    v_mfma_f32_16x16x32_bf16 v[88:91], a[216:219], a[164:167], v[88:91]
    v_add_u32 v19, s20, v17
    v_mfma_f32_16x16x32_bf16 v[104:107], a[216:219], a[168:171], v[104:107]
    v_mfma_f32_16x16x32_bf16 v[120:123], a[216:219], a[172:175], v[120:123]
    v_mfma_f32_16x16x32_bf16 v[136:139], a[216:219], a[176:179], v[136:139]
    buffer_load_dwordx4 v23, s[36:39], s17 offen offset:3072 lds
    v_mfma_f32_16x16x32_bf16 v[152:155], a[216:219], a[180:183], v[152:155]
    v_mfma_f32_16x16x32_bf16 v[168:171], a[216:219], a[184:187], v[168:171]
    v_mfma_f32_16x16x32_bf16 v[184:187], a[216:219], a[188:191], v[184:187]
    buffer_load_dwordx4 a[216:219], v12, s[32:35], s16 offen offset:2048 sc1
    v_mfma_f32_16x16x32_bf16 v[76:79], a[220:223], a[160:163], v[76:79]
    v_mfma_f32_16x16x32_bf16 v[92:95], a[220:223], a[164:167], v[92:95]
    v_mfma_f32_16x16x32_bf16 v[108:111], a[220:223], a[168:171], v[108:111]
    v_mfma_f32_16x16x32_bf16 v[124:127], a[220:223], a[172:175], v[124:127]
    v_mfma_f32_16x16x32_bf16 v[140:143], a[220:223], a[176:179], v[140:143]
    v_mfma_f32_16x16x32_bf16 v[156:159], a[220:223], a[180:183], v[156:159]
    s_add_u32 s17, s17, 128
    s_mov_b32 s19, s20
    s_add_u32 s20, s20, 16384
    v_mfma_f32_16x16x32_bf16 v[172:175], a[220:223], a[184:187], v[172:175]
    s_and_b32 s20, s20, 131071
    v_mfma_f32_16x16x32_bf16 v[188:191], a[220:223], a[188:191], v[188:191]
    buffer_load_dwordx4 a[220:223], v12, s[32:35], s16 offen offset:3072 sc1
    s_add_u32 s16, s16, 4096
    s_waitcnt vmcnt(12) lgkmcnt(0)
    v_mfma_f32_16x16x32_bf16 v[64:67], a[224:227], a[128:131], v[64:67]
    v_mfma_f32_16x16x32_bf16 v[80:83], a[224:227], a[132:135], v[80:83]
    ds_read_b128 a[160:163], v19 offset:0
    v_mfma_f32_16x16x32_bf16 v[96:99], a[224:227], a[136:139], v[96:99]
    v_mfma_f32_16x16x32_bf16 v[112:115], a[224:227], a[140:143], v[112:115]
    ds_read_b128 a[164:167], v19 offset:2048
    v_mfma_f32_16x16x32_bf16 v[128:131], a[224:227], a[144:147], v[128:131]
    v_mfma_f32_16x16x32_bf16 v[144:147], a[224:227], a[148:151], v[144:147]
    ds_read_b128 a[168:171], v19 offset:4096
    v_mfma_f32_16x16x32_bf16 v[160:163], a[224:227], a[152:155], v[160:163]
    v_mfma_f32_16x16x32_bf16 v[176:179], a[224:227], a[156:159], v[176:179]
    ds_read_b128 a[172:175], v19 offset:6144
    buffer_load_dwordx4 a[224:227], v12, s[32:35], s16 offen offset:0 sc1
    v_mfma_f32_16x16x32_bf16 v[68:71], a[228:231], a[128:131], v[68:71]
    v_mfma_f32_16x16x32_bf16 v[84:87], a[228:231], a[132:135], v[84:87]
    ds_read_b128 a[176:179], v19 offset:8192
    v_mfma_f32_16x16x32_bf16 v[100:103], a[228:231], a[136:139], v[100:103]
    v_mfma_f32_16x16x32_bf16 v[116:119], a[228:231], a[140:143], v[116:119]
    ds_read_b128 a[180:183], v19 offset:10240
    v_mfma_f32_16x16x32_bf16 v[132:135], a[228:231], a[144:147], v[132:135]
    v_mfma_f32_16x16x32_bf16 v[148:151], a[228:231], a[148:151], v[148:151]
    ds_read_b128 a[184:187], v19 offset:12288
    v_mfma_f32_16x16x32_bf16 v[164:167], a[228:231], a[152:155], v[164:167]
    v_mfma_f32_16x16x32_bf16 v[180:183], a[228:231], a[156:159], v[180:183]
    ds_read_b128 a[188:191], v19 offset:14336
    buffer_load_dwordx4 a[228:231], v12, s[32:35], s16 offen offset:1024 sc1
    v_mfma_f32_16x16x32_bf16 v[72:75], a[232:235], a[128:131], v[72:75]
    v_mfma_f32_16x16x32_bf16 v[88:91], a[232:235], a[132:135], v[88:91]
    v_mfma_f32_16x16x32_bf16 v[104:107], a[232:235], a[136:139], v[104:107]
    v_mfma_f32_16x16x32_bf16 v[120:123], a[232:235], a[140:143], v[120:123]
    v_mfma_f32_16x16x32_bf16 v[136:139], a[232:235], a[144:147], v[136:139]
    v_mfma_f32_16x16x32_bf16 v[152:155], a[232:235], a[148:151], v[152:155]
    v_mfma_f32_16x16x32_bf16 v[168:171], a[232:235], a[152:155], v[168:171]
    v_mfma_f32_16x16x32_bf16 v[184:187], a[232:235], a[156:159], v[184:187]
    buffer_load_dwordx4 a[232:235], v12, s[32:35], s16 offen offset:2048 sc1
    v_mfma_f32_16x16x32_bf16 v[76:79], a[236:239], a[128:131], v[76:79]
    v_mfma_f32_16x16x32_bf16 v[92:95], a[236:239], a[132:135], v[92:95]
    v_mfma_f32_16x16x32_bf16 v[108:111], a[236:239], a[136:139], v[108:111]
    v_mfma_f32_16x16x32_bf16 v[124:127], a[236:239], a[140:143], v[124:127]
    v_mfma_f32_16x16x32_bf16 v[140:143], a[236:239], a[144:147], v[140:143]
    v_mfma_f32_16x16x32_bf16 v[156:159], a[236:239], a[148:151], v[156:159]
    v_mfma_f32_16x16x32_bf16 v[172:175], a[236:239], a[152:155], v[172:175]
    v_mfma_f32_16x16x32_bf16 v[188:191], a[236:239], a[156:159], v[188:191]
    buffer_load_dwordx4 a[236:239], v12, s[32:35], s16 offen offset:3072 sc1
    s_add_u32 s16, s16, 4096
    s_waitcnt vmcnt(12) lgkmcnt(0)
    v_mfma_f32_16x16x32_bf16 v[64:67], a[240:243], a[160:163], v[64:67]
    s_barrier
    v_add_u32 v18, s20, v16
    v_mfma_f32_16x16x32_bf16 v[80:83], a[240:243], a[164:167], v[80:83]
    ds_read_b128 a[128:131], v18 offset:0
    s_add_u32 m0, s21, s19
    v_mfma_f32_16x16x32_bf16 v[96:99], a[240:243], a[168:171], v[96:99]
    buffer_load_dwordx4 v20, s[36:39], s17 offen offset:0 lds
    v_mfma_f32_16x16x32_bf16 v[112:115], a[240:243], a[172:175], v[112:115]
    ds_read_b128 a[132:135], v18 offset:2048
    v_mfma_f32_16x16x32_bf16 v[128:131], a[240:243], a[176:179], v[128:131]
    v_mfma_f32_16x16x32_bf16 v[144:147], a[240:243], a[180:183], v[144:147]
    ds_read_b128 a[136:139], v18 offset:4096
    v_mfma_f32_16x16x32_bf16 v[160:163], a[240:243], a[184:187], v[160:163]
    v_mfma_f32_16x16x32_bf16 v[176:179], a[240:243], a[188:191], v[176:179]
    ds_read_b128 a[140:143], v18 offset:6144
    buffer_load_dwordx4 a[240:243], v12, s[32:35], s16 offen offset:0 sc1
    v_mfma_f32_16x16x32_bf16 v[68:71], a[244:247], a[160:163], v[68:71]
    buffer_load_dwordx4 v21, s[36:39], s17 offen offset:1024 lds
    v_mfma_f32_16x16x32_bf16 v[84:87], a[244:247], a[164:167], v[84:87]
    ds_read_b128 a[144:147], v18 offset:8192
    v_mfma_f32_16x16x32_bf16 v[100:103], a[244:247], a[168:171], v[100:103]
    v_mfma_f32_16x16x32_bf16 v[116:119], a[244:247], a[172:175], v[116:119]
    ds_read_b128 a[148:151], v18 offset:10240
    v_mfma_f32_16x16x32_bf16 v[132:135], a[244:247], a[176:179], v[132:135]
    v_mfma_f32_16x16x32_bf16 v[148:151], a[244:247], a[180:183], v[148:151]
    ds_read_b128 a[152:155], v18 offset:12288
    v_mfma_f32_16x16x32_bf16 v[164:167], a[244:247], a[184:187], v[164:167]
    buffer_load_dwordx4 v22, s[36:39], s17 offen offset:2048 lds
    v_mfma_f32_16x16x32_bf16 v[180:183], a[244:247], a[188:191], v[180:183]
    ds_read_b128 a[156:159], v18 offset:14336
    buffer_load_dwordx4 a[244:247], v12, s[32:35], s16 offen offset:1024 sc1
    v_mfma_f32_16x16x32_bf16 v[72:75], a[248:251], a[160:163], v[72:75]
    v_mfma_f32_16x16x32_bf16 v[88:91], a[248:251], a[164:167], v[88:91]
    v_add_u32 v19, s20, v17
    v_mfma_f32_16x16x32_bf16 v[104:107], a[248:251], a[168:171], v[104:107]
    v_mfma_f32_16x16x32_bf16 v[120:123], a[248:251], a[172:175], v[120:123]
    v_mfma_f32_16x16x32_bf16 v[136:139], a[248:251], a[176:179], v[136:139]
    buffer_load_dwordx4 v23, s[36:39], s17 offen offset:3072 lds
    v_mfma_f32_16x16x32_bf16 v[152:155], a[248:251], a[180:183], v[152:155]
    v_mfma_f32_16x16x32_bf16 v[168:171], a[248:251], a[184:187], v[168:171]
    v_mfma_f32_16x16x32_bf16 v[184:187], a[248:251], a[188:191], v[184:187]
    buffer_load_dwordx4 a[248:251], v12, s[32:35], s16 offen offset:2048 sc1
    v_mfma_f32_16x16x32_bf16 v[76:79], a[252:255], a[160:163], v[76:79]
    v_mfma_f32_16x16x32_bf16 v[92:95], a[252:255], a[164:167], v[92:95]
    v_mfma_f32_16x16x32_bf16 v[108:111], a[252:255], a[168:171], v[108:111]
    v_mfma_f32_16x16x32_bf16 v[124:127], a[252:255], a[172:175], v[124:127]
    v_mfma_f32_16x16x32_bf16 v[140:143], a[252:255], a[176:179], v[140:143]
    v_mfma_f32_16x16x32_bf16 v[156:159], a[252:255], a[180:183], v[156:159]
    s_add_u32 s17, s17, 128
    s_mov_b32 s19, s20
    s_add_u32 s20, s20, 16384
    v_mfma_f32_16x16x32_bf16 v[172:175], a[252:255], a[184:187], v[172:175]
    s_and_b32 s20, s20, 131071
    v_mfma_f32_16x16x32_bf16 v[188:191], a[252:255], a[188:191], v[188:191]
    buffer_load_dwordx4 a[252:255], v12, s[32:35], s16 offen offset:3072 sc1
    s_add_u32 s16, s16, 4096
    s_waitcnt vmcnt(12) lgkmcnt(0)
    v_mfma_f32_16x16x32_bf16 v[64:67], a[192:195], a[128:131], v[64:67]
    v_mfma_f32_16x16x32_bf16 v[80:83], a[192:195], a[132:135], v[80:83]
    ds_read_b128 a[160:163], v19 offset:0
    v_mfma_f32_16x16x32_bf16 v[96:99], a[192:195], a[136:139], v[96:99]
    v_mfma_f32_16x16x32_bf16 v[112:115], a[192:195], a[140:143], v[112:115]
    ds_read_b128 a[164:167], v19 offset:2048
    v_mfma_f32_16x16x32_bf16 v[128:131], a[192:195], a[144:147], v[128:131]
    v_mfma_f32_16x16x32_bf16 v[144:147], a[192:195], a[148:151], v[144:147]
    ds_read_b128 a[168:171], v19 offset:4096
    v_mfma_f32_16x16x32_bf16 v[160:163], a[192:195], a[152:155], v[160:163]
    v_mfma_f32_16x16x32_bf16 v[176:179], a[192:195], a[156:159], v[176:179]
    ds_read_b128 a[172:175], v19 offset:6144
    buffer_load_dwordx4 a[192:195], v12, s[32:35], s16 offen offset:0 sc1
    v_mfma_f32_16x16x32_bf16 v[68:71], a[196:199], a[128:131], v[68:71]
    v_mfma_f32_16x16x32_bf16 v[84:87], a[196:199], a[132:135], v[84:87]
    ds_read_b128 a[176:179], v19 offset:8192
    v_mfma_f32_16x16x32_bf16 v[100:103], a[196:199], a[136:139], v[100:103]
    v_mfma_f32_16x16x32_bf16 v[116:119], a[196:199], a[140:143], v[116:119]
    ds_read_b128 a[180:183], v19 offset:10240
    v_mfma_f32_16x16x32_bf16 v[132:135], a[196:199], a[144:147], v[132:135]
    v_mfma_f32_16x16x32_bf16 v[148:151], a[196:199], a[148:151], v[148:151]
    ds_read_b128 a[184:187], v19 offset:12288
    v_mfma_f32_16x16x32_bf16 v[164:167], a[196:199], a[152:155], v[164:167]
    v_mfma_f32_16x16x32_bf16 v[180:183], a[196:199], a[156:159], v[180:183]
    ds_read_b128 a[188:191], v19 offset:14336
    buffer_load_dwordx4 a[196:199], v12, s[32:35], s16 offen offset:1024 sc1
    v_mfma_f32_16x16x32_bf16 v[72:75], a[200:203], a[128:131], v[72:75]
    v_mfma_f32_16x16x32_bf16 v[88:91], a[200:203], a[132:135], v[88:91]
    v_mfma_f32_16x16x32_bf16 v[104:107], a[200:203], a[136:139], v[104:107]
    v_mfma_f32_16x16x32_bf16 v[120:123], a[200:203], a[140:143], v[120:123]
    v_mfma_f32_16x16x32_bf16 v[136:139], a[200:203], a[144:147], v[136:139]
    v_mfma_f32_16x16x32_bf16 v[152:155], a[200:203], a[148:151], v[152:155]
    v_mfma_f32_16x16x32_bf16 v[168:171], a[200:203], a[152:155], v[168:171]
    v_mfma_f32_16x16x32_bf16 v[184:187], a[200:203], a[156:159], v[184:187]
    buffer_load_dwordx4 a[200:203], v12, s[32:35], s16 offen offset:2048 sc1
    v_mfma_f32_16x16x32_bf16 v[76:79], a[204:207], a[128:131], v[76:79]
    v_mfma_f32_16x16x32_bf16 v[92:95], a[204:207], a[132:135], v[92:95]
    v_mfma_f32_16x16x32_bf16 v[108:111], a[204:207], a[136:139], v[108:111]
    v_mfma_f32_16x16x32_bf16 v[124:127], a[204:207], a[140:143], v[124:127]
    v_mfma_f32_16x16x32_bf16 v[140:143], a[204:207], a[144:147], v[140:143]
    v_mfma_f32_16x16x32_bf16 v[156:159], a[204:207], a[148:151], v[156:159]
    v_mfma_f32_16x16x32_bf16 v[172:175], a[204:207], a[152:155], v[172:175]
    v_mfma_f32_16x16x32_bf16 v[188:191], a[204:207], a[156:159], v[188:191]
    buffer_load_dwordx4 a[204:207], v12, s[32:35], s16 offen offset:3072 sc1
    s_add_u32 s16, s16, 4096
    s_waitcnt vmcnt(12) lgkmcnt(0)
    v_mfma_f32_16x16x32_bf16 v[64:67], a[208:211], a[160:163], v[64:67]
    s_barrier
    v_add_u32 v18, s20, v16
    v_mfma_f32_16x16x32_bf16 v[80:83], a[208:211], a[164:167], v[80:83]
    ds_read_b128 a[128:131], v18 offset:0
    s_add_u32 m0, s21, s19
    v_mfma_f32_16x16x32_bf16 v[96:99], a[208:211], a[168:171], v[96:99]
    buffer_load_dwordx4 v20, s[36:39], s17 offen offset:0 lds
    v_mfma_f32_16x16x32_bf16 v[112:115], a[208:211], a[172:175], v[112:115]
    ds_read_b128 a[132:135], v18 offset:2048
    v_mfma_f32_16x16x32_bf16 v[128:131], a[208:211], a[176:179], v[128:131]
    v_mfma_f32_16x16x32_bf16 v[144:147], a[208:211], a[180:183], v[144:147]
    ds_read_b128 a[136:139], v18 offset:4096
    v_mfma_f32_16x16x32_bf16 v[160:163], a[208:211], a[184:187], v[160:163]
    v_mfma_f32_16x16x32_bf16 v[176:179], a[208:211], a[188:191], v[176:179]
    ds_read_b128 a[140:143], v18 offset:6144
    buffer_load_dwordx4 a[208:211], v12, s[32:35], s16 offen offset:0 sc1
    v_mfma_f32_16x16x32_bf16 v[68:71], a[212:215], a[160:163], v[68:71]
    buffer_load_dwordx4 v21, s[36:39], s17 offen offset:1024 lds
    v_mfma_f32_16x16x32_bf16 v[84:87], a[212:215], a[164:167], v[84:87]
    ds_read_b128 a[144:147], v18 offset:8192
    v_mfma_f32_16x16x32_bf16 v[100:103], a[212:215], a[168:171], v[100:103]
    v_mfma_f32_16x16x32_bf16 v[116:119], a[212:215], a[172:175], v[116:119]
    ds_read_b128 a[148:151], v18 offset:10240
    v_mfma_f32_16x16x32_bf16 v[132:135], a[212:215], a[176:179], v[132:135]
    v_mfma_f32_16x16x32_bf16 v[148:151], a[212:215], a[180:183], v[148:151]
    ds_read_b128 a[152:155], v18 offset:12288
    v_mfma_f32_16x16x32_bf16 v[164:167], a[212:215], a[184:187], v[164:167]
    buffer_load_dwordx4 v22, s[36:39], s17 offen offset:2048 lds
    v_mfma_f32_16x16x32_bf16 v[180:183], a[212:215], a[188:191], v[180:183]
    ds_read_b128 a[156:159], v18 offset:14336
    buffer_load_dwordx4 a[212:215], v12, s[32:35], s16 offen offset:1024 sc1
    v_mfma_f32_16x16x32_bf16 v[72:75], a[216:219], a[160:163], v[72:75]
    v_mfma_f32_16x16x32_bf16 v[88:91], a[216:219], a[164:167], v[88:91]
    v_add_u32 v19, s20, v17
    v_mfma_f32_16x16x32_bf16 v[104:107], a[216:219], a[168:171], v[104:107]
    v_mfma_f32_16x16x32_bf16 v[120:123], a[216:219], a[172:175], v[120:123]
    v_mfma_f32_16x16x32_bf16 v[136:139], a[216:219], a[176:179], v[136:139]
    buffer_load_dwordx4 v23, s[36:39], s17 offen offset:3072 lds
    v_mfma_f32_16x16x32_bf16 v[152:155], a[216:219], a[180:183], v[152:155]
    v_mfma_f32_16x16x32_bf16 v[168:171], a[216:219], a[184:187], v[168:171]
    v_mfma_f32_16x16x32_bf16 v[184:187], a[216:219], a[188:191], v[184:187]
    buffer_load_dwordx4 a[216:219], v12, s[32:35], s16 offen offset:2048 sc1
    v_mfma_f32_16x16x32_bf16 v[76:79], a[220:223], a[160:163], v[76:79]
    v_mfma_f32_16x16x32_bf16 v[92:95], a[220:223], a[164:167], v[92:95]
    v_mfma_f32_16x16x32_bf16 v[108:111], a[220:223], a[168:171], v[108:111]
    v_mfma_f32_16x16x32_bf16 v[124:127], a[220:223], a[172:175], v[124:127]
    v_mfma_f32_16x16x32_bf16 v[140:143], a[220:223], a[176:179], v[140:143]
    v_mfma_f32_16x16x32_bf16 v[156:159], a[220:223], a[180:183], v[156:159]
    s_add_u32 s17, s17, 128
    s_mov_b32 s19, s20
    s_add_u32 s20, s20, 16384
    v_mfma_f32_16x16x32_bf16 v[172:175], a[220:223], a[184:187], v[172:175]
    s_and_b32 s20, s20, 131071
    v_mfma_f32_16x16x32_bf16 v[188:191], a[220:223], a[188:191], v[188:191]
    buffer_load_dwordx4 a[220:223], v12, s[32:35], s16 offen offset:3072 sc1
    s_add_u32 s16, s16, 4096
    s_waitcnt vmcnt(12) lgkmcnt(0)
    v_mfma_f32_16x16x32_bf16 v[64:67], a[224:227], a[128:131], v[64:67]
    v_mfma_f32_16x16x32_bf16 v[80:83], a[224:227], a[132:135], v[80:83]
    ds_read_b128 a[160:163], v19 offset:0
    v_mfma_f32_16x16x32_bf16 v[96:99], a[224:227], a[136:139], v[96:99]
    v_mfma_f32_16x16x32_bf16 v[112:115], a[224:227], a[140:143], v[112:115]
    ds_read_b128 a[164:167], v19 offset:2048
    v_mfma_f32_16x16x32_bf16 v[128:131], a[224:227], a[144:147], v[128:131]
    v_mfma_f32_16x16x32_bf16 v[144:147], a[224:227], a[148:151], v[144:147]
    ds_read_b128 a[168:171], v19 offset:4096
    v_mfma_f32_16x16x32_bf16 v[160:163], a[224:227], a[152:155], v[160:163]
    v_mfma_f32_16x16x32_bf16 v[176:179], a[224:227], a[156:159], v[176:179]
    ds_read_b128 a[172:175], v19 offset:6144
    buffer_load_dwordx4 a[224:227], v12, s[32:35], s16 offen offset:0 sc1
    v_mfma_f32_16x16x32_bf16 v[68:71], a[228:231], a[128:131], v[68:71]
    v_mfma_f32_16x16x32_bf16 v[84:87], a[228:231], a[132:135], v[84:87]
    ds_read_b128 a[176:179], v19 offset:8192
    v_mfma_f32_16x16x32_bf16 v[100:103], a[228:231], a[136:139], v[100:103]
    v_mfma_f32_16x16x32_bf16 v[116:119], a[228:231], a[140:143], v[116:119]
    ds_read_b128 a[180:183], v19 offset:10240
    v_mfma_f32_16x16x32_bf16 v[132:135], a[228:231], a[144:147], v[132:135]
    v_mfma_f32_16x16x32_bf16 v[148:151], a[228:231], a[148:151], v[148:151]
    ds_read_b128 a[184:187], v19 offset:12288
    v_mfma_f32_16x16x32_bf16 v[164:167], a[228:231], a[152:155], v[164:167]
    v_mfma_f32_16x16x32_bf16 v[180:183], a[228:231], a[156:159], v[180:183]
    ds_read_b128 a[188:191], v19 offset:14336
    buffer_load_dwordx4 a[228:231], v12, s[32:35], s16 offen offset:1024 sc1
    v_mfma_f32_16x16x32_bf16 v[72:75], a[232:235], a[128:131], v[72:75]
    v_mfma_f32_16x16x32_bf16 v[88:91], a[232:235], a[132:135], v[88:91]
    v_mfma_f32_16x16x32_bf16 v[104:107], a[232:235], a[136:139], v[104:107]
    v_mfma_f32_16x16x32_bf16 v[120:123], a[232:235], a[140:143], v[120:123]
    v_mfma_f32_16x16x32_bf16 v[136:139], a[232:235], a[144:147], v[136:139]
    v_mfma_f32_16x16x32_bf16 v[152:155], a[232:235], a[148:151], v[152:155]
    v_mfma_f32_16x16x32_bf16 v[168:171], a[232:235], a[152:155], v[168:171]
    v_mfma_f32_16x16x32_bf16 v[184:187], a[232:235], a[156:159], v[184:187]
    buffer_load_dwordx4 a[232:235], v12, s[32:35], s16 offen offset:2048 sc1
    v_mfma_f32_16x16x32_bf16 v[76:79], a[236:239], a[128:131], v[76:79]
    v_mfma_f32_16x16x32_bf16 v[92:95], a[236:239], a[132:135], v[92:95]
    v_mfma_f32_16x16x32_bf16 v[108:111], a[236:239], a[136:139], v[108:111]
    v_mfma_f32_16x16x32_bf16 v[124:127], a[236:239], a[140:143], v[124:127]
    v_mfma_f32_16x16x32_bf16 v[140:143], a[236:239], a[144:147], v[140:143]
    v_mfma_f32_16x16x32_bf16 v[156:159], a[236:239], a[148:151], v[156:159]
    v_mfma_f32_16x16x32_bf16 v[172:175], a[236:239], a[152:155], v[172:175]
    v_mfma_f32_16x16x32_bf16 v[188:191], a[236:239], a[156:159], v[188:191]
    buffer_load_dwordx4 a[236:239], v12, s[32:35], s16 offen offset:3072 sc1
    s_add_u32 s16, s16, 4096
    s_waitcnt vmcnt(12) lgkmcnt(0)
    v_mfma_f32_16x16x32_bf16 v[64:67], a[240:243], a[160:163], v[64:67]
    s_barrier
    v_add_u32 v18, s20, v16
    v_mfma_f32_16x16x32_bf16 v[80:83], a[240:243], a[164:167], v[80:83]
    ds_read_b128 a[128:131], v18 offset:0
    s_add_u32 m0, s21, s19
    v_mfma_f32_16x16x32_bf16 v[96:99], a[240:243], a[168:171], v[96:99]
    buffer_load_dwordx4 v20, s[36:39], s17 offen offset:0 lds
    v_mfma_f32_16x16x32_bf16 v[112:115], a[240:243], a[172:175], v[112:115]
    ds_read_b128 a[132:135], v18 offset:2048
    v_mfma_f32_16x16x32_bf16 v[128:131], a[240:243], a[176:179], v[128:131]
    v_mfma_f32_16x16x32_bf16 v[144:147], a[240:243], a[180:183], v[144:147]
    ds_read_b128 a[136:139], v18 offset:4096
    v_mfma_f32_16x16x32_bf16 v[160:163], a[240:243], a[184:187], v[160:163]
    v_mfma_f32_16x16x32_bf16 v[176:179], a[240:243], a[188:191], v[176:179]
    ds_read_b128 a[140:143], v18 offset:6144
    buffer_load_dwordx4 a[240:243], v12, s[32:35], s16 offen offset:0 sc1
    v_mfma_f32_16x16x32_bf16 v[68:71], a[244:247], a[160:163], v[68:71]
    buffer_load_dwordx4 v21, s[36:39], s17 offen offset:1024 lds
    v_mfma_f32_16x16x32_bf16 v[84:87], a[244:247], a[164:167], v[84:87]
    ds_read_b128 a[144:147], v18 offset:8192
    v_mfma_f32_16x16x32_bf16 v[100:103], a[244:247], a[168:171], v[100:103]
    v_mfma_f32_16x16x32_bf16 v[116:119], a[244:247], a[172:175], v[116:119]
    ds_read_b128 a[148:151], v18 offset:10240
    v_mfma_f32_16x16x32_bf16 v[132:135], a[244:247], a[176:179], v[132:135]
    v_mfma_f32_16x16x32_bf16 v[148:151], a[244:247], a[180:183], v[148:151]
    ds_read_b128 a[152:155], v18 offset:12288
    v_mfma_f32_16x16x32_bf16 v[164:167], a[244:247], a[184:187], v[164:167]
    buffer_load_dwordx4 v22, s[36:39], s17 offen offset:2048 lds
    v_mfma_f32_16x16x32_bf16 v[180:183], a[244:247], a[188:191], v[180:183]
    ds_read_b128 a[156:159], v18 offset:14336
    buffer_load_dwordx4 a[244:247], v12, s[32:35], s16 offen offset:1024 sc1
    v_mfma_f32_16x16x32_bf16 v[72:75], a[248:251], a[160:163], v[72:75]
    v_mfma_f32_16x16x32_bf16 v[88:91], a[248:251], a[164:167], v[88:91]
    v_add_u32 v19, s20, v17
    v_mfma_f32_16x16x32_bf16 v[104:107], a[248:251], a[168:171], v[104:107]
    v_mfma_f32_16x16x32_bf16 v[120:123], a[248:251], a[172:175], v[120:123]
    v_mfma_f32_16x16x32_bf16 v[136:139], a[248:251], a[176:179], v[136:139]
    buffer_load_dwordx4 v23, s[36:39], s17 offen offset:3072 lds
    v_mfma_f32_16x16x32_bf16 v[152:155], a[248:251], a[180:183], v[152:155]
    v_mfma_f32_16x16x32_bf16 v[168:171], a[248:251], a[184:187], v[168:171]
    v_mfma_f32_16x16x32_bf16 v[184:187], a[248:251], a[188:191], v[184:187]
    buffer_load_dwordx4 a[248:251], v12, s[32:35], s16 offen offset:2048 sc1
    v_mfma_f32_16x16x32_bf16 v[76:79], a[252:255], a[160:163], v[76:79]
    v_mfma_f32_16x16x32_bf16 v[92:95], a[252:255], a[164:167], v[92:95]
    v_mfma_f32_16x16x32_bf16 v[108:111], a[252:255], a[168:171], v[108:111]
    v_mfma_f32_16x16x32_bf16 v[124:127], a[252:255], a[172:175], v[124:127]
    v_mfma_f32_16x16x32_bf16 v[140:143], a[252:255], a[176:179], v[140:143]
    v_mfma_f32_16x16x32_bf16 v[156:159], a[252:255], a[180:183], v[156:159]
    s_add_u32 s17, s17, 128
    s_mov_b32 s19, s20
    s_add_u32 s20, s20, 16384
    v_mfma_f32_16x16x32_bf16 v[172:175], a[252:255], a[184:187], v[172:175]
    s_and_b32 s20, s20, 131071
    v_mfma_f32_16x16x32_bf16 v[188:191], a[252:255], a[188:191], v[188:191]
    buffer_load_dwordx4 a[252:255], v12, s[32:35], s16 offen offset:3072 sc1
    s_add_u32 s16, s16, 4096
    s_add_u32 s18, s18, 1
    s_cmp_lt_u32 s18, 2
    s_cbranch_scc1 L_d1_loop
    s_lshl_b32 s22, s30, 13
    s_add_u32 s22, s22, 25329664
    v_lshlrev_b32 v2, 5, v1
    s_add_u32 s23, s22, 4096
    s_waitcnt lgkmcnt(0)
    s_nop 7
    v_cmp_ne_u32 vcc, s98, v48
    v_cmp_ne_u32 s[28:29], s99, v49
    s_or_b64 vcc, vcc, s[28:29]
    s_and_b64 vcc, vcc, 0xffffffff
    s_cbranch_scc0 L_uok
    v_cmp_gt_u32 vcc, 32, v1
    v_lshlrev_b32 v6, 7, v1
    v_mov_b32 v7, 1073741824
    v_cndmask_b32 v6, v7, v6, vcc
    s_mov_b32 s27, 0
    buffer_load_dwordx2 v[48:49], v6, s[12:15], s31 offen sc1
    s_sleep 4
    buffer_load_dwordx2 v[50:51], v6, s[12:15], s31 offen sc1
    s_sleep 4
L_poll_4542:
    buffer_load_dwordx2 v[52:53], v6, s[12:15], s31 offen sc1
    s_waitcnt vmcnt(2)
    v_cmp_ne_u32 vcc, s98, v48
    v_cmp_ne_u32 s[28:29], s99, v49
    s_or_b64 vcc, vcc, s[28:29]
    s_and_b64 s[64:65], vcc, 0xffffffff
    s_cbranch_scc0 L_poll_4542_done
    s_sleep 1
    buffer_load_dwordx2 v[48:49], v6, s[12:15], s31 offen sc1
    s_waitcnt vmcnt(2)
    v_cmp_ne_u32 vcc, s98, v50
    v_cmp_ne_u32 s[28:29], s99, v51
    s_or_b64 vcc, vcc, s[28:29]
    s_and_b64 s[64:65], vcc, 0xffffffff
    s_cbranch_scc0 L_poll_4542_done
    s_sleep 1
    buffer_load_dwordx2 v[50:51], v6, s[12:15], s31 offen sc1
    s_waitcnt vmcnt(2)
    v_cmp_ne_u32 vcc, s98, v52
    v_cmp_ne_u32 s[28:29], s99, v53
    s_or_b64 vcc, vcc, s[28:29]
    s_and_b64 s[64:65], vcc, 0xffffffff
    s_cbranch_scc0 L_poll_4542_done
    s_sleep 1
    s_add_u32 s27, s27, 1
    s_cmp_lt_u32 s27, 0x20000
    s_cbranch_scc1 L_poll_4542
L_poll_4542_done:

    s_waitcnt vmcnt(0)
L_uok:
    buffer_load_dwordx4 v[208:211], v2, s[12:15], s22 offen offset:0 sc1
    buffer_load_dwordx4 v[212:215], v2, s[12:15], s22 offen offset:16 sc1
    buffer_load_dwordx4 v[216:219], v2, s[12:15], s22 offen offset:2048 sc1
    buffer_load_dwordx4 v[220:223], v2, s[12:15], s22 offen offset:2064 sc1
    buffer_load_dwordx4 v[224:227], v2, s[12:15], s23 offen offset:0 sc1
    buffer_load_dwordx4 v[228:231], v2, s[12:15], s23 offen offset:16 sc1
    buffer_load_dwordx4 v[232:235], v2, s[12:15], s23 offen offset:2048 sc1
    buffer_load_dwordx4 v[236:239], v2, s[12:15], s23 offen offset:2064 sc1
    v_lshrrev_b32 v2, 4, v1
    v_and_b32 v3, 1, v2
    v_lshrrev_b32 v2, 1, v2
    v_lshl_add_u32 v2, v3, 1, v2
    v_and_b32 v3, 15, v1
    v_lshlrev_b32 v3, 4, v3
    v_lshl_add_u32 v14, v2, 8, v3
    s_lshr_b32 s26, s67, 1
    s_lshl_b32 s26, s26, 4
    s_and_b32 s27, s66, 3
    s_lshl_b32 s27, s27, 2
    s_add_u32 s26, s26, s27
    s_lshl_b32 s26, s26, 16
    s_lshl_b32 s27, s30, 15
    s_add_u32 s26, s26, s27
    s_and_b32 s27, s67, 1
    s_lshl_b32 s27, s27, 14
    s_add_u32 s26, s26, s27
    s_lshl_b32 s27, s3, 12
    s_add_u32 s26, s26, s27
    s_add_u32 s25, s26, 19005440

    v_lshlrev_b32 v3, 31, v1
    v_mul_f32 v192, s74, v192
    v_xor_b32 v192, v3, v192
    v_mul_f32 v193, s74, v193
    v_xor_b32 v193, v3, v193
    v_mul_f32 v194, s74, v194
    v_xor_b32 v194, v3, v194
    v_mul_f32 v195, s74, v195
    v_xor_b32 v195, v3, v195
    v_mul_f32 v196, s74, v196
    v_xor_b32 v196, v3, v196
    v_mul_f32 v197, s74, v197
    v_xor_b32 v197, v3, v197
    v_mul_f32 v198, s74, v198
    v_xor_b32 v198, v3, v198
    v_mul_f32 v199, s74, v199
    v_xor_b32 v199, v3, v199
    v_mul_f32 v200, s74, v200
    v_xor_b32 v200, v3, v200
    v_mul_f32 v201, s74, v201
    v_xor_b32 v201, v3, v201
    v_mul_f32 v202, s74, v202
    v_xor_b32 v202, v3, v202
    v_mul_f32 v203, s74, v203
    v_xor_b32 v203, v3, v203
    v_mul_f32 v204, s74, v204
    v_xor_b32 v204, v3, v204
    v_mul_f32 v205, s74, v205
    v_xor_b32 v205, v3, v205
    v_mul_f32 v206, s74, v206
    v_xor_b32 v206, v3, v206
    v_mul_f32 v207, s74, v207
    v_xor_b32 v207, v3, v207
    v_pk_add_f32 v[64:65], v[64:65], v[192:193]
    v_pk_add_f32 v[66:67], v[66:67], v[194:195]
    v_pk_add_f32 v[68:69], v[68:69], v[196:197]
    v_pk_add_f32 v[70:71], v[70:71], v[198:199]
    v_pk_add_f32 v[72:73], v[72:73], v[200:201]
    v_pk_add_f32 v[74:75], v[74:75], v[202:203]
    v_pk_add_f32 v[76:77], v[76:77], v[204:205]
    v_pk_add_f32 v[78:79], v[78:79], v[206:207]
    v_cvt_pk_bf16_f32 v32, v64, v65
    v_cvt_pk_bf16_f32 v33, v66, v67
    v_cvt_pk_bf16_f32 v34, v68, v69
    v_cvt_pk_bf16_f32 v35, v70, v71
    v_cvt_pk_bf16_f32 v36, v72, v73
    v_cvt_pk_bf16_f32 v37, v74, v75
    v_cvt_pk_bf16_f32 v38, v76, v77
    v_cvt_pk_bf16_f32 v39, v78, v79
    s_nop 1
    v_permlane16_swap_b32 v32, v34
    v_permlane16_swap_b32 v33, v35
    v_permlane16_swap_b32 v36, v38
    v_permlane16_swap_b32 v37, v39
    s_add_u32 s26, s25, 0
    buffer_store_dwordx4 v[32:35], v14, s[12:15], s26 offen sc1
    s_add_u32 s26, s25, 2048
    buffer_store_dwordx4 v[36:39], v14, s[12:15], s26 offen sc1
    v_pk_add_f32 v[80:81], v[80:81], v[192:193]
    v_pk_add_f32 v[82:83], v[82:83], v[194:195]
    v_pk_add_f32 v[84:85], v[84:85], v[196:197]
    v_pk_add_f32 v[86:87], v[86:87], v[198:199]
    v_pk_add_f32 v[88:89], v[88:89], v[200:201]
    v_pk_add_f32 v[90:91], v[90:91], v[202:203]
    v_pk_add_f32 v[92:93], v[92:93], v[204:205]
    v_pk_add_f32 v[94:95], v[94:95], v[206:207]
    v_cvt_pk_bf16_f32 v40, v80, v81
    v_cvt_pk_bf16_f32 v41, v82, v83
    v_cvt_pk_bf16_f32 v42, v84, v85
    v_cvt_pk_bf16_f32 v43, v86, v87
    v_cvt_pk_bf16_f32 v44, v88, v89
    v_cvt_pk_bf16_f32 v45, v90, v91
    v_cvt_pk_bf16_f32 v46, v92, v93
    v_cvt_pk_bf16_f32 v47, v94, v95
    s_nop 1
    v_permlane16_swap_b32 v40, v42
    v_permlane16_swap_b32 v41, v43
    v_permlane16_swap_b32 v44, v46
    v_permlane16_swap_b32 v45, v47
    s_add_u32 s26, s25, 1024
    buffer_store_dwordx4 v[40:43], v14, s[12:15], s26 offen sc1
    s_add_u32 s26, s25, 3072
    buffer_store_dwordx4 v[44:47], v14, s[12:15], s26 offen sc1
    v_pk_add_f32 v[96:97], v[96:97], v[192:193]
    v_pk_add_f32 v[98:99], v[98:99], v[194:195]
    v_pk_add_f32 v[100:101], v[100:101], v[196:197]
    v_pk_add_f32 v[102:103], v[102:103], v[198:199]
    v_pk_add_f32 v[104:105], v[104:105], v[200:201]
    v_pk_add_f32 v[106:107], v[106:107], v[202:203]
    v_pk_add_f32 v[108:109], v[108:109], v[204:205]
    v_pk_add_f32 v[110:111], v[110:111], v[206:207]
    v_cvt_pk_bf16_f32 v32, v96, v97
    v_cvt_pk_bf16_f32 v33, v98, v99
    v_cvt_pk_bf16_f32 v34, v100, v101
    v_cvt_pk_bf16_f32 v35, v102, v103
    v_cvt_pk_bf16_f32 v36, v104, v105
    v_cvt_pk_bf16_f32 v37, v106, v107
    v_cvt_pk_bf16_f32 v38, v108, v109
    v_cvt_pk_bf16_f32 v39, v110, v111
    s_nop 1
    v_permlane16_swap_b32 v32, v34
    v_permlane16_swap_b32 v33, v35
    v_permlane16_swap_b32 v36, v38
    v_permlane16_swap_b32 v37, v39
    s_add_u32 s26, s25, 65536
    buffer_store_dwordx4 v[32:35], v14, s[12:15], s26 offen sc1
    s_add_u32 s26, s25, 67584
    buffer_store_dwordx4 v[36:39], v14, s[12:15], s26 offen sc1
    v_pk_add_f32 v[112:113], v[112:113], v[192:193]
    v_pk_add_f32 v[114:115], v[114:115], v[194:195]
    v_pk_add_f32 v[116:117], v[116:117], v[196:197]
    v_pk_add_f32 v[118:119], v[118:119], v[198:199]
    v_pk_add_f32 v[120:121], v[120:121], v[200:201]
    v_pk_add_f32 v[122:123], v[122:123], v[202:203]
    v_pk_add_f32 v[124:125], v[124:125], v[204:205]
    v_pk_add_f32 v[126:127], v[126:127], v[206:207]
    v_cvt_pk_bf16_f32 v40, v112, v113
    v_cvt_pk_bf16_f32 v41, v114, v115
    v_cvt_pk_bf16_f32 v42, v116, v117
    v_cvt_pk_bf16_f32 v43, v118, v119
    v_cvt_pk_bf16_f32 v44, v120, v121
    v_cvt_pk_bf16_f32 v45, v122, v123
    v_cvt_pk_bf16_f32 v46, v124, v125
    v_cvt_pk_bf16_f32 v47, v126, v127
    s_nop 1
    v_permlane16_swap_b32 v40, v42
    v_permlane16_swap_b32 v41, v43
    v_permlane16_swap_b32 v44, v46
    v_permlane16_swap_b32 v45, v47
    s_add_u32 s26, s25, 66560
    buffer_store_dwordx4 v[40:43], v14, s[12:15], s26 offen sc1
    s_add_u32 s26, s25, 68608
    buffer_store_dwordx4 v[44:47], v14, s[12:15], s26 offen sc1
    v_pk_add_f32 v[128:129], v[128:129], v[192:193]
    v_pk_add_f32 v[130:131], v[130:131], v[194:195]
    v_pk_add_f32 v[132:133], v[132:133], v[196:197]
    v_pk_add_f32 v[134:135], v[134:135], v[198:199]
    v_pk_add_f32 v[136:137], v[136:137], v[200:201]
    v_pk_add_f32 v[138:139], v[138:139], v[202:203]
    v_pk_add_f32 v[140:141], v[140:141], v[204:205]
    v_pk_add_f32 v[142:143], v[142:143], v[206:207]
    v_cvt_pk_bf16_f32 v32, v128, v129
    v_cvt_pk_bf16_f32 v33, v130, v131
    v_cvt_pk_bf16_f32 v34, v132, v133
    v_cvt_pk_bf16_f32 v35, v134, v135
    v_cvt_pk_bf16_f32 v36, v136, v137
    v_cvt_pk_bf16_f32 v37, v138, v139
    v_cvt_pk_bf16_f32 v38, v140, v141
    v_cvt_pk_bf16_f32 v39, v142, v143
    s_nop 1
    v_permlane16_swap_b32 v32, v34
    v_permlane16_swap_b32 v33, v35
    v_permlane16_swap_b32 v36, v38
    v_permlane16_swap_b32 v37, v39
    s_add_u32 s26, s25, 131072
    buffer_store_dwordx4 v[32:35], v14, s[12:15], s26 offen sc1
    s_add_u32 s26, s25, 133120
    buffer_store_dwordx4 v[36:39], v14, s[12:15], s26 offen sc1
    v_pk_add_f32 v[144:145], v[144:145], v[192:193]
    v_pk_add_f32 v[146:147], v[146:147], v[194:195]
    v_pk_add_f32 v[148:149], v[148:149], v[196:197]
    v_pk_add_f32 v[150:151], v[150:151], v[198:199]
    v_pk_add_f32 v[152:153], v[152:153], v[200:201]
    v_pk_add_f32 v[154:155], v[154:155], v[202:203]
    v_pk_add_f32 v[156:157], v[156:157], v[204:205]
    v_pk_add_f32 v[158:159], v[158:159], v[206:207]
    v_cvt_pk_bf16_f32 v40, v144, v145
    v_cvt_pk_bf16_f32 v41, v146, v147
    v_cvt_pk_bf16_f32 v42, v148, v149
    v_cvt_pk_bf16_f32 v43, v150, v151
    v_cvt_pk_bf16_f32 v44, v152, v153
    v_cvt_pk_bf16_f32 v45, v154, v155
    v_cvt_pk_bf16_f32 v46, v156, v157
    v_cvt_pk_bf16_f32 v47, v158, v159
    s_nop 1
    v_permlane16_swap_b32 v40, v42
    v_permlane16_swap_b32 v41, v43
    v_permlane16_swap_b32 v44, v46
    v_permlane16_swap_b32 v45, v47
    s_add_u32 s26, s25, 132096
    buffer_store_dwordx4 v[40:43], v14, s[12:15], s26 offen sc1
    s_add_u32 s26, s25, 134144
    buffer_store_dwordx4 v[44:47], v14, s[12:15], s26 offen sc1
    v_pk_add_f32 v[160:161], v[160:161], v[192:193]
    v_pk_add_f32 v[162:163], v[162:163], v[194:195]
    v_pk_add_f32 v[164:165], v[164:165], v[196:197]
    v_pk_add_f32 v[166:167], v[166:167], v[198:199]
    v_pk_add_f32 v[168:169], v[168:169], v[200:201]
    v_pk_add_f32 v[170:171], v[170:171], v[202:203]
    v_pk_add_f32 v[172:173], v[172:173], v[204:205]
    v_pk_add_f32 v[174:175], v[174:175], v[206:207]
    v_cvt_pk_bf16_f32 v32, v160, v161
    v_cvt_pk_bf16_f32 v33, v162, v163
    v_cvt_pk_bf16_f32 v34, v164, v165
    v_cvt_pk_bf16_f32 v35, v166, v167
    v_cvt_pk_bf16_f32 v36, v168, v169
    v_cvt_pk_bf16_f32 v37, v170, v171
    v_cvt_pk_bf16_f32 v38, v172, v173
    v_cvt_pk_bf16_f32 v39, v174, v175
    s_nop 1
    v_permlane16_swap_b32 v32, v34
    v_permlane16_swap_b32 v33, v35
    v_permlane16_swap_b32 v36, v38
    v_permlane16_swap_b32 v37, v39
    s_add_u32 s26, s25, 196608
    buffer_store_dwordx4 v[32:35], v14, s[12:15], s26 offen sc1
    s_add_u32 s26, s25, 198656
    buffer_store_dwordx4 v[36:39], v14, s[12:15], s26 offen sc1
    v_pk_add_f32 v[176:177], v[176:177], v[192:193]
    v_pk_add_f32 v[178:179], v[178:179], v[194:195]
    v_pk_add_f32 v[180:181], v[180:181], v[196:197]
    v_pk_add_f32 v[182:183], v[182:183], v[198:199]
    v_pk_add_f32 v[184:185], v[184:185], v[200:201]
    v_pk_add_f32 v[186:187], v[186:187], v[202:203]
    v_pk_add_f32 v[188:189], v[188:189], v[204:205]
    v_pk_add_f32 v[190:191], v[190:191], v[206:207]
    v_cvt_pk_bf16_f32 v40, v176, v177
    v_cvt_pk_bf16_f32 v41, v178, v179
    v_cvt_pk_bf16_f32 v42, v180, v181
    v_cvt_pk_bf16_f32 v43, v182, v183
    v_cvt_pk_bf16_f32 v44, v184, v185
    v_cvt_pk_bf16_f32 v45, v186, v187
    v_cvt_pk_bf16_f32 v46, v188, v189
    v_cvt_pk_bf16_f32 v47, v190, v191
    s_nop 1
    v_permlane16_swap_b32 v40, v42
    v_permlane16_swap_b32 v41, v43
    v_permlane16_swap_b32 v44, v46
    v_permlane16_swap_b32 v45, v47
    s_add_u32 s26, s25, 197632
    buffer_store_dwordx4 v[40:43], v14, s[12:15], s26 offen sc1
    s_add_u32 s26, s25, 199680
    buffer_store_dwordx4 v[44:47], v14, s[12:15], s26 offen sc1
    s_and_b32 s26, s66, 3
    s_lshl_b32 s26, s26, 1
    s_add_u32 s26, s26, s30
    s_lshl_b32 s26, s26, 2
    s_add_u32 s26, s26, s67
    s_lshl_b32 s26, s26, 7
    s_add_u32 s23, s26, 26238976
    s_waitcnt vmcnt(0)
    s_barrier
    s_cmp_lg_u32 s3, 0
    s_cbranch_scc1 L_pub_4855
    v_lshlrev_b32 v2, 3, v1
    v_mov_b32 v4, s98
    v_mov_b32 v5, s99
    s_mov_b64 exec, 65535
    buffer_store_dwordx2 v[4:5], v2, s[12:15], s23 offen sc1
    s_mov_b64 exec, -1

L_pub_4855:
    v_mov_b32 v56, 0
    v_mov_b32 v57, 0
    v_mov_b32 v58, 0
    v_mov_b32 v59, 0
    s_nop 1
    v_mfma_f32_32x32x16_bf16 v[64:79], v[56:59], v[56:59], 0
    v_mfma_f32_32x32x16_bf16 v[80:95], v[56:59], v[56:59], 0
    v_mfma_f32_32x32x16_bf16 v[96:111], v[56:59], v[56:59], 0
    v_mfma_f32_32x32x16_bf16 v[112:127], v[56:59], v[56:59], 0
    v_mfma_f32_32x32x16_bf16 v[128:143], v[56:59], v[56:59], 0
    v_mfma_f32_32x32x16_bf16 v[144:159], v[56:59], v[56:59], 0
    v_mfma_f32_32x32x16_bf16 v[160:175], v[56:59], v[56:59], 0
    v_mfma_f32_32x32x16_bf16 v[176:191], v[56:59], v[56:59], 0
    v_mfma_f32_32x32x16_bf16 v[240:255], v[56:59], v[56:59], 0
    v_pk_add_f32 v[208:209], v[208:209], v[216:217]
    v_pk_add_f32 v[224:225], v[224:225], v[232:233]
    v_pk_add_f32 v[210:211], v[210:211], v[218:219]
    v_pk_add_f32 v[226:227], v[226:227], v[234:235]
    v_pk_add_f32 v[212:213], v[212:213], v[220:221]
    v_pk_add_f32 v[228:229], v[228:229], v[236:237]
    v_pk_add_f32 v[214:215], v[214:215], v[222:223]
    v_pk_add_f32 v[230:231], v[230:231], v[238:239]
    v_pk_add_f32 v[208:209], v[208:209], v[224:225]
    v_pk_add_f32 v[210:211], v[210:211], v[226:227]
    v_pk_add_f32 v[212:213], v[212:213], v[228:229]
    v_pk_add_f32 v[214:215], v[214:215], v[230:231]
    v_cvt_pk_bf16_f32 v60, v208, v209
    v_cvt_pk_bf16_f32 v61, v210, v211
    v_cvt_pk_bf16_f32 v62, v212, v213
    v_cvt_pk_bf16_f32 v63, v214, v215
    s_lshl_b32 s26, s67, 5
    s_lshl_b32 s27, s3, 3
    s_add_u32 s26, s26, s27
    s_lshl_b32 s27, s26, 7
    v_lshrrev_b32 v2, 3, v1
    v_lshlrev_b32 v2, 14, v2
    v_add_u32 v2, s27, v2
    s_lshr_b32 s26, s26, 1
    v_and_b32 v3, 7, v1
    v_xor_b32 v3, s26, v3
    v_and_b32 v3, 7, v3

    v_xor_b32 v4, 0, v3
    v_lshl_add_u32 v4, v4, 4, v2
    ds_read_b128 v[208:211], v4 offset:0
    v_xor_b32 v4, 0, v3
    v_lshl_add_u32 v4, v4, 4, v2
    ds_read_b128 v[212:215], v4 offset:128
    v_xor_b32 v4, 1, v3
    v_lshl_add_u32 v4, v4, 4, v2
    ds_read_b128 v[216:219], v4 offset:256
    v_xor_b32 v4, 1, v3
    v_lshl_add_u32 v4, v4, 4, v2
    ds_read_b128 v[220:223], v4 offset:384
    v_xor_b32 v4, 2, v3
    v_lshl_add_u32 v4, v4, 4, v2
    ds_read_b128 v[224:227], v4 offset:512
    v_xor_b32 v4, 2, v3
    v_lshl_add_u32 v4, v4, 4, v2
    ds_read_b128 v[228:231], v4 offset:640
    v_xor_b32 v4, 3, v3
    v_lshl_add_u32 v4, v4, 4, v2
    ds_read_b128 v[232:235], v4 offset:768
    v_xor_b32 v4, 3, v3
    v_lshl_add_u32 v4, v4, 4, v2
    ds_read_b128 v[236:239], v4 offset:896
    v_mov_b32 v40, 0
    v_mov_b32 v41, 0
    v_mov_b32 v42, 0
    v_mov_b32 v43, 0
    v_mov_b32 v44, 0
    v_mov_b32 v45, 0
    v_mov_b32 v46, 0
    v_mov_b32 v47, 0
    s_waitcnt lgkmcnt(0)
    v_dot2_f32_bf16 v40, v208, v60, v40
    v_dot2_f32_bf16 v41, v212, v60, v41
    v_dot2_f32_bf16 v42, v216, v60, v42
    v_dot2_f32_bf16 v43, v220, v60, v43
    v_dot2_f32_bf16 v44, v224, v60, v44
    v_dot2_f32_bf16 v45, v228, v60, v45
    v_dot2_f32_bf16 v46, v232, v60, v46
    v_dot2_f32_bf16 v47, v236, v60, v47
    v_dot2_f32_bf16 v40, v209, v61, v40
    v_dot2_f32_bf16 v41, v213, v61, v41
    v_dot2_f32_bf16 v42, v217, v61, v42
    v_dot2_f32_bf16 v43, v221, v61, v43
    v_dot2_f32_bf16 v44, v225, v61, v44
    v_dot2_f32_bf16 v45, v229, v61, v45
    v_dot2_f32_bf16 v46, v233, v61, v46
    v_dot2_f32_bf16 v47, v237, v61, v47
    v_dot2_f32_bf16 v40, v210, v62, v40
    v_dot2_f32_bf16 v41, v214, v62, v41
    v_dot2_f32_bf16 v42, v218, v62, v42
    v_dot2_f32_bf16 v43, v222, v62, v43
    v_dot2_f32_bf16 v44, v226, v62, v44
    v_dot2_f32_bf16 v45, v230, v62, v45
    v_dot2_f32_bf16 v46, v234, v62, v46
    v_dot2_f32_bf16 v47, v238, v62, v47
    v_dot2_f32_bf16 v40, v211, v63, v40
    v_dot2_f32_bf16 v41, v215, v63, v41
    v_dot2_f32_bf16 v42, v219, v63, v42
    v_dot2_f32_bf16 v43, v223, v63, v43
    v_dot2_f32_bf16 v44, v227, v63, v44
    v_dot2_f32_bf16 v45, v231, v63, v45
    v_dot2_f32_bf16 v46, v235, v63, v46
    v_dot2_f32_bf16 v47, v239, v63, v47
    s_nop 2
    s_nop 1
    v_add_f32_dpp v40, v40, v40 row_ror:1 row_mask:0xf bank_mask:0xf
    v_add_f32_dpp v41, v41, v41 row_ror:1 row_mask:0xf bank_mask:0xf
    v_add_f32_dpp v42, v42, v42 row_ror:1 row_mask:0xf bank_mask:0xf
    v_add_f32_dpp v43, v43, v43 row_ror:1 row_mask:0xf bank_mask:0xf
    v_add_f32_dpp v44, v44, v44 row_ror:1 row_mask:0xf bank_mask:0xf
    v_add_f32_dpp v45, v45, v45 row_ror:1 row_mask:0xf bank_mask:0xf
    v_add_f32_dpp v46, v46, v46 row_ror:1 row_mask:0xf bank_mask:0xf
    v_add_f32_dpp v47, v47, v47 row_ror:1 row_mask:0xf bank_mask:0xf
    s_nop 1
    v_add_f32_dpp v40, v40, v40 row_ror:2 row_mask:0xf bank_mask:0xf
    v_add_f32_dpp v41, v41, v41 row_ror:2 row_mask:0xf bank_mask:0xf
    v_add_f32_dpp v42, v42, v42 row_ror:2 row_mask:0xf bank_mask:0xf
    v_add_f32_dpp v43, v43, v43 row_ror:2 row_mask:0xf bank_mask:0xf
    v_add_f32_dpp v44, v44, v44 row_ror:2 row_mask:0xf bank_mask:0xf
    v_add_f32_dpp v45, v45, v45 row_ror:2 row_mask:0xf bank_mask:0xf
    v_add_f32_dpp v46, v46, v46 row_ror:2 row_mask:0xf bank_mask:0xf
    v_add_f32_dpp v47, v47, v47 row_ror:2 row_mask:0xf bank_mask:0xf
    s_nop 1
    v_add_f32_dpp v40, v40, v40 row_ror:4 row_mask:0xf bank_mask:0xf
    v_add_f32_dpp v41, v41, v41 row_ror:4 row_mask:0xf bank_mask:0xf
    v_add_f32_dpp v42, v42, v42 row_ror:4 row_mask:0xf bank_mask:0xf
    v_add_f32_dpp v43, v43, v43 row_ror:4 row_mask:0xf bank_mask:0xf
    v_add_f32_dpp v44, v44, v44 row_ror:4 row_mask:0xf bank_mask:0xf
    v_add_f32_dpp v45, v45, v45 row_ror:4 row_mask:0xf bank_mask:0xf
    v_add_f32_dpp v46, v46, v46 row_ror:4 row_mask:0xf bank_mask:0xf
    v_add_f32_dpp v47, v47, v47 row_ror:4 row_mask:0xf bank_mask:0xf
    s_nop 1
    v_add_f32_dpp v40, v40, v40 row_ror:8 row_mask:0xf bank_mask:0xf
    v_add_f32_dpp v41, v41, v41 row_ror:8 row_mask:0xf bank_mask:0xf
    v_add_f32_dpp v42, v42, v42 row_ror:8 row_mask:0xf bank_mask:0xf
    v_add_f32_dpp v43, v43, v43 row_ror:8 row_mask:0xf bank_mask:0xf
    v_add_f32_dpp v44, v44, v44 row_ror:8 row_mask:0xf bank_mask:0xf
    v_add_f32_dpp v45, v45, v45 row_ror:8 row_mask:0xf bank_mask:0xf
    v_add_f32_dpp v46, v46, v46 row_ror:8 row_mask:0xf bank_mask:0xf
    v_add_f32_dpp v47, v47, v47 row_ror:8 row_mask:0xf bank_mask:0xf
    v_mov_b32 v48, v40
    v_mov_b32 v49, v41
    v_mov_b32 v50, v42
    v_mov_b32 v51, v43
    v_mov_b32 v52, v44
    v_mov_b32 v53, v45
    v_mov_b32 v54, v46
    v_mov_b32 v55, v47
    s_nop 1
    v_permlane16_swap_b32 v40, v48
    v_permlane16_swap_b32 v41, v49
    v_permlane16_swap_b32 v42, v50
    v_permlane16_swap_b32 v43, v51
    v_permlane16_swap_b32 v44, v52
    v_permlane16_swap_b32 v45, v53
    v_permlane16_swap_b32 v46, v54
    v_permlane16_swap_b32 v47, v55
    s_nop 1
    v_add_f32 v40, v40, v48
    v_add_f32 v41, v41, v49
    v_add_f32 v42, v42, v50
    v_add_f32 v43, v43, v51
    v_add_f32 v44, v44, v52
    v_add_f32 v45, v45, v53
    v_add_f32 v46, v46, v54
    v_add_f32 v47, v47, v55
    v_mov_b32 v48, v40
    v_mov_b32 v49, v41
    v_mov_b32 v50, v42
    v_mov_b32 v51, v43
    v_mov_b32 v52, v44
    v_mov_b32 v53, v45
    v_mov_b32 v54, v46
    v_mov_b32 v55, v47
    s_nop 1
    v_permlane32_swap_b32 v40, v48
    v_permlane32_swap_b32 v41, v49
    v_permlane32_swap_b32 v42, v50
    v_permlane32_swap_b32 v43, v51
    v_permlane32_swap_b32 v44, v52
    v_permlane32_swap_b32 v45, v53
    v_permlane32_swap_b32 v46, v54
    v_permlane32_swap_b32 v47, v55
    s_nop 1
    v_add_f32 v40, v40, v48
    v_add_f32 v41, v41, v49
    v_add_f32 v42, v42, v50
    v_add_f32 v43, v43, v51
    v_add_f32 v44, v44, v52
    v_add_f32 v45, v45, v53
    v_add_f32 v46, v46, v54
    v_add_f32 v47, v47, v55
    v_cmp_eq_u32 vcc, 1, v1
    s_nop 1
    v_cndmask_b32 v40, v40, v41, vcc
    v_cmp_eq_u32 vcc, 2, v1
    s_nop 1
    v_cndmask_b32 v40, v40, v42, vcc
    v_cmp_eq_u32 vcc, 3, v1
    s_nop 1
    v_cndmask_b32 v40, v40, v43, vcc
    v_cmp_eq_u32 vcc, 4, v1
    s_nop 1
    v_cndmask_b32 v40, v40, v44, vcc
    v_cmp_eq_u32 vcc, 5, v1
    s_nop 1
    v_cndmask_b32 v40, v40, v45, vcc
    v_cmp_eq_u32 vcc, 6, v1
    s_nop 1
    v_cndmask_b32 v40, v40, v46, vcc
    v_cmp_eq_u32 vcc, 7, v1
    s_nop 1
    v_cndmask_b32 v40, v40, v47, vcc
    s_lshl_b32 s23, s67, 10
    s_add_u32 s23, s23, 26238976
    v_and_b32 v6, 7, v1
    v_lshlrev_b32 v6, 7, v6
    buffer_load_dwordx2 v[56:57], v6, s[12:15], s23 offen sc1
    v_mov_b32 v41, 0
    v_mov_b32 v42, 3212853120
    v_dot2_f32_bf16 v41, v60, v42, v41
    v_dot2_f32_bf16 v41, v61, v42, v41
    v_dot2_f32_bf16 v41, v62, v42, v41
    v_dot2_f32_bf16 v41, v63, v42, v41
    s_nop 2
    s_nop 1
    v_add_f32_dpp v41, v41, v41 row_ror:1 row_mask:0xf bank_mask:0xf
    s_nop 1
    v_add_f32_dpp v41, v41, v41 row_ror:2 row_mask:0xf bank_mask:0xf
    s_nop 1
    v_add_f32_dpp v41, v41, v41 row_ror:4 row_mask:0xf bank_mask:0xf
    s_nop 1
    v_add_f32_dpp v41, v41, v41 row_ror:8 row_mask:0xf bank_mask:0xf
    v_mov_b32 v48, v41
    s_nop 1
    v_permlane16_swap_b32 v41, v48
    s_nop 1
    v_add_f32 v41, v41, v48
    v_mov_b32 v48, v41
    s_nop 1
    v_permlane32_swap_b32 v41, v48
    s_nop 1
    v_add_f32 v41, v41, v48
    v_cmp_eq_u32 vcc, 8, v1
    s_cmp_eq_u32 s30, 0
    s_cselect_b32 s26, 1.0, 0
    v_cndmask_b32 v40, v40, v41, vcc
    v_mov_b32 v7, s97
    v_mul_f32 v7, s26, v7
    v_lshlrev_b32 v2, 31, v1
    v_xor_b32 v2, v2, v7
    v_add_f32 v40, v40, v2
    v_cvt_pk_bf16_f32 v40, v40, v40
    s_and_b32 s26, s66, 3
    s_lshl_b32 s26, s26, 7
    s_lshl_b32 s27, s67, 5
    s_add_u32 s26, s26, s27
    s_lshl_b32 s27, s3, 3
    s_add_u32 s26, s26, s27
    v_add_u32 v3, s26, v1
    v_mov_b32 v4, 512
    v_cndmask_b32 v3, v3, v4, vcc
    v_lshlrev_b32 v3, 6, v3
    s_mul_i32 s26, s30, 574464
    s_add_u32 s26, s26, 21708800
    s_add_u32 s27, s26, 2097152
    s_cmp_eq_u32 s30, 0
    s_mov_b32 s28, 0xff
    s_cselect_b32 exec_lo, 0x1ff, s28
    s_mov_b32 exec_hi, 0
    buffer_store_dword v40, v3, s[12:15], s26 offen sc1
    buffer_store_dword v40, v3, s[12:15], s27 offen sc1
    s_mov_b64 exec, -1

    s_lshl_b32 s26, s30, 4
    s_lshl_b32 s27, s67, 2
    s_add_u32 s26, s26, s27
    s_add_u32 s26, s26, s3
    s_lshl_b32 s26, s26, 16
    s_add_u32 s22, s26, 19005440

    s_add_u32 s32, s48, s22
    s_addc_u32 s33, s49, 0
    s_and_b32 s33, s33, 0xffff
    s_mov_b32 s34, 65536
    s_mov_b32 s35, 0x20000
    s_cmp_eq_u32 s66, 0
    s_cselect_b32 s31, 1, 0
    v_mov_b32 v24, 3212853120
    v_mov_b32 v25, 3212853120
    v_mov_b32 v26, 3212853120
    v_mov_b32 v27, 3212853120

    s_mov_b32 s4, s88
    s_and_b32 s5, s89, 0xffff
    s_mov_b32 s6, 7340032
    s_mov_b32 s7, 0x20000
    s_mul_i32 s27, s96, 1835008
    s_lshl_b32 s26, s51, 8
    s_add_u32 s27, s27, s26
    v_lshrrev_b32 v3, 4, v1
    s_lshl_b32 s26, s3, 4
    v_add_u32 v2, s26, v3
    v_lshlrev_b32 v2, 11, v2
    v_add_u32 v2, s27, v2
    v_lshlrev_b32 v3, 1, v3
    v_and_b32 v8, 15, v1
    v_xor_b32 v3, v3, v8
    v_lshl_add_u32 v8, v3, 4, v2
    v_xor_b32 v3, 8, v3
    v_lshl_add_u32 v9, v3, 4, v2
    v_add_u32 v10, 14336, v8
    v_add_u32 v11, 21504, v9
    v_add_u32 v9, 7168, v9

    s_waitcnt vmcnt(2)
    v_cmp_ne_u32 vcc, s98, v56
    v_cmp_ne_u32 s[28:29], s99, v57
    s_or_b64 vcc, vcc, s[28:29]
    s_cbranch_scc0 L_s2_ok
    v_cmp_gt_u32 vcc, 8, v1
    v_lshlrev_b32 v6, 7, v1
    v_mov_b32 v7, 1073741824
    v_cndmask_b32 v6, v7, v6, vcc
    s_mov_b32 s27, 0
    buffer_load_dwordx2 v[48:49], v6, s[12:15], s23 offen sc1
    s_sleep 4
    buffer_load_dwordx2 v[50:51], v6, s[12:15], s23 offen sc1
    s_sleep 4
L_poll_5189:
    buffer_load_dwordx2 v[52:53], v6, s[12:15], s23 offen sc1
    s_waitcnt vmcnt(2)
    v_cmp_ne_u32 vcc, s98, v48
    v_cmp_ne_u32 s[28:29], s99, v49
    s_or_b64 vcc, vcc, s[28:29]
    s_and_b64 s[64:65], vcc, 0xff
    s_cbranch_scc0 L_poll_5189_done
    s_sleep 2
    buffer_load_dwordx2 v[48:49], v6, s[12:15], s23 offen sc1
    s_waitcnt vmcnt(2)
    v_cmp_ne_u32 vcc, s98, v50
    v_cmp_ne_u32 s[28:29], s99, v51
    s_or_b64 vcc, vcc, s[28:29]
    s_and_b64 s[64:65], vcc, 0xff
    s_cbranch_scc0 L_poll_5189_done
    s_sleep 2
    buffer_load_dwordx2 v[50:51], v6, s[12:15], s23 offen sc1
    s_waitcnt vmcnt(2)
    v_cmp_ne_u32 vcc, s98, v52
    v_cmp_ne_u32 s[28:29], s99, v53
    s_or_b64 vcc, vcc, s[28:29]
    s_and_b64 s[64:65], vcc, 0xff
    s_cbranch_scc0 L_poll_5189_done
    s_sleep 2
    s_add_u32 s27, s27, 1
    s_cmp_lt_u32 s27, 0x20000
    s_cbranch_scc1 L_poll_5189
L_poll_5189_done:

L_s2_ok:
    s_lshl_b32 s22, s67, 9
    s_add_u32 s22, s22, 25366528
    s_cmp_eq_u32 s30, 0
    s_cselect_b32 s23, 1.0, 0
    s_cselect_b32 s75, 0, -1.0
    s_mov_b32 s74, s23
    v_lshrrev_b32 v2, 4, v1
    v_lshlrev_b32 v2, 4, v2
    s_lshl_b32 s26, s3, 7
    v_add_u32 v2, s26, v2
    buffer_load_dwordx4 v[192:195], v2, s[12:15], s22 offen offset:0 sc1
    buffer_load_dwordx4 v[196:199], v2, s[12:15], s22 offen offset:64 sc1
    v_lshrrev_b32 v2, 4, v1
    v_lshlrev_b32 v2, 4, v2
    s_lshl_b32 s26, s3, 7
    v_add_u32 v2, s26, v2
    buffer_load_dwordx4 v[200:203], v2, s[12:15], s22 offen offset:2048 sc1
    buffer_load_dwordx4 v[204:207], v2, s[12:15], s22 offen offset:2112 sc1
    s_mov_b32 s16, 0
    buffer_load_dwordx4 a[192:195], v12, s[32:35], s16 offen offset:0 sc1
    buffer_load_dwordx4 a[196:199], v12, s[32:35], s16 offen offset:1024 sc1
    s_add_u32 s16, s16, 2048
    buffer_load_dwordx4 a[200:203], v12, s[32:35], s16 offen offset:0 sc1
    buffer_load_dwordx4 a[204:207], v12, s[32:35], s16 offen offset:1024 sc1
    s_add_u32 s16, s16, 2048
    buffer_load_dwordx4 a[208:211], v12, s[32:35], s16 offen offset:0 sc1
    buffer_load_dwordx4 a[212:215], v12, s[32:35], s16 offen offset:1024 sc1
    s_add_u32 s16, s16, 2048
    buffer_load_dwordx4 a[216:219], v12, s[32:35], s16 offen offset:0 sc1
    buffer_load_dwordx4 a[220:223], v12, s[32:35], s16 offen offset:1024 sc1
    s_add_u32 s16, s16, 2048
    buffer_load_dwordx4 a[224:227], v12, s[32:35], s16 offen offset:0 sc1
    buffer_load_dwordx4 a[228:231], v12, s[32:35], s16 offen offset:1024 sc1
    s_add_u32 s16, s16, 2048
    buffer_load_dwordx4 a[232:235], v12, s[32:35], s16 offen offset:0 sc1
    buffer_load_dwordx4 a[236:239], v12, s[32:35], s16 offen offset:1024 sc1
    s_add_u32 s16, s16, 2048
    buffer_load_dwordx4 a[240:243], v12, s[32:35], s16 offen offset:0 sc1
    buffer_load_dwordx4 a[244:247], v12, s[32:35], s16 offen offset:1024 sc1
    s_add_u32 s16, s16, 2048
    buffer_load_dwordx4 a[248:251], v12, s[32:35], s16 offen offset:0 sc1
    buffer_load_dwordx4 a[252:255], v12, s[32:35], s16 offen offset:1024 sc1
    s_add_u32 s16, s16, 2048
    v_mov_b32 v18, v16
    v_mov_b32 v19, v17
    ds_read_b128 a[128:131], v18 offset:0
    ds_read_b128 a[132:135], v18 offset:2048
    ds_read_b128 a[136:139], v18 offset:4096
    ds_read_b128 a[140:143], v18 offset:6144
    ds_read_b128 a[144:147], v18 offset:8192
    ds_read_b128 a[148:151], v18 offset:10240
    ds_read_b128 a[152:155], v18 offset:12288
    ds_read_b128 a[156:159], v18 offset:14336
    s_mov_b32 s19, 0
    s_mov_b32 s20, 16384

    s_mov_b32 s18, 0
    s_mov_b32 s17, 0
    .p2align 6
L_d2a_loop:
    s_waitcnt vmcnt(14) lgkmcnt(0)
    s_cmp_eq_u32 s31, 0
    s_cbranch_scc1 L_d2a_x0
    v_mfma_f32_16x16x32_bf16 v[240:243], a[192:195], v[24:27], v[240:243]
    v_mfma_f32_16x16x32_bf16 v[244:247], a[196:199], v[24:27], v[244:247]
L_d2a_x0:
    v_mfma_f32_16x16x32_bf16 v[64:67], a[192:195], a[128:131], v[64:67]
    v_mfma_f32_16x16x32_bf16 v[72:75], a[192:195], a[132:135], v[72:75]
    ds_read_b128 a[160:163], v19 offset:0
    v_mfma_f32_16x16x32_bf16 v[80:83], a[192:195], a[136:139], v[80:83]
    ds_read_b128 a[164:167], v19 offset:2048
    v_mfma_f32_16x16x32_bf16 v[88:91], a[192:195], a[140:143], v[88:91]
    ds_read_b128 a[168:171], v19 offset:4096
    v_mfma_f32_16x16x32_bf16 v[96:99], a[192:195], a[144:147], v[96:99]
    ds_read_b128 a[172:175], v19 offset:6144
    v_mfma_f32_16x16x32_bf16 v[104:107], a[192:195], a[148:151], v[104:107]
    ds_read_b128 a[176:179], v19 offset:8192
    v_mfma_f32_16x16x32_bf16 v[112:115], a[192:195], a[152:155], v[112:115]
    ds_read_b128 a[180:183], v19 offset:10240
    v_mfma_f32_16x16x32_bf16 v[120:123], a[192:195], a[156:159], v[120:123]
    ds_read_b128 a[184:187], v19 offset:12288
    buffer_load_dwordx4 a[192:195], v12, s[32:35], s16 offen offset:0 sc1
    v_mfma_f32_16x16x32_bf16 v[68:71], a[196:199], a[128:131], v[68:71]
    ds_read_b128 a[188:191], v19 offset:14336
    v_mfma_f32_16x16x32_bf16 v[76:79], a[196:199], a[132:135], v[76:79]
    v_mfma_f32_16x16x32_bf16 v[84:87], a[196:199], a[136:139], v[84:87]
    v_mfma_f32_16x16x32_bf16 v[92:95], a[196:199], a[140:143], v[92:95]
    v_mfma_f32_16x16x32_bf16 v[100:103], a[196:199], a[144:147], v[100:103]
    v_mfma_f32_16x16x32_bf16 v[108:111], a[196:199], a[148:151], v[108:111]
    v_mfma_f32_16x16x32_bf16 v[116:119], a[196:199], a[152:155], v[116:119]
    v_mfma_f32_16x16x32_bf16 v[124:127], a[196:199], a[156:159], v[124:127]
    buffer_load_dwordx4 a[196:199], v12, s[32:35], s16 offen offset:1024 sc1
    s_add_u32 s16, s16, 2048
    s_waitcnt vmcnt(14) lgkmcnt(0)
    s_cmp_eq_u32 s31, 0
    s_cbranch_scc1 L_d2a_x1
    v_mfma_f32_16x16x32_bf16 v[240:243], a[200:203], v[24:27], v[240:243]
    v_mfma_f32_16x16x32_bf16 v[244:247], a[204:207], v[24:27], v[244:247]
L_d2a_x1:
    v_mfma_f32_16x16x32_bf16 v[64:67], a[200:203], a[160:163], v[64:67]
    s_barrier
    v_add_u32 v18, s20, v16
    v_mfma_f32_16x16x32_bf16 v[72:75], a[200:203], a[164:167], v[72:75]
    ds_read_b128 a[128:131], v18 offset:0
    s_add_u32 m0, s21, s19
    v_mfma_f32_16x16x32_bf16 v[80:83], a[200:203], a[168:171], v[80:83]
    ds_read_b128 a[132:135], v18 offset:2048
    buffer_load_dwordx4 v20, s[80:83], s17 offen offset:0 lds
    v_mfma_f32_16x16x32_bf16 v[88:91], a[200:203], a[172:175], v[88:91]
    ds_read_b128 a[136:139], v18 offset:4096
    v_mfma_f32_16x16x32_bf16 v[96:99], a[200:203], a[176:179], v[96:99]
    ds_read_b128 a[140:143], v18 offset:6144
    v_mfma_f32_16x16x32_bf16 v[104:107], a[200:203], a[180:183], v[104:107]
    ds_read_b128 a[144:147], v18 offset:8192
    buffer_load_dwordx4 v21, s[80:83], s17 offen offset:1024 lds
    v_mfma_f32_16x16x32_bf16 v[112:115], a[200:203], a[184:187], v[112:115]
    ds_read_b128 a[148:151], v18 offset:10240
    v_mfma_f32_16x16x32_bf16 v[120:123], a[200:203], a[188:191], v[120:123]
    ds_read_b128 a[152:155], v18 offset:12288
    buffer_load_dwordx4 a[200:203], v12, s[32:35], s16 offen offset:0 sc1
    v_mfma_f32_16x16x32_bf16 v[68:71], a[204:207], a[160:163], v[68:71]
    ds_read_b128 a[156:159], v18 offset:14336
    buffer_load_dwordx4 v22, s[80:83], s17 offen offset:2048 lds
    v_mfma_f32_16x16x32_bf16 v[76:79], a[204:207], a[164:167], v[76:79]
    v_add_u32 v19, s20, v17
    v_mfma_f32_16x16x32_bf16 v[84:87], a[204:207], a[168:171], v[84:87]
    v_mfma_f32_16x16x32_bf16 v[92:95], a[204:207], a[172:175], v[92:95]
    buffer_load_dwordx4 v23, s[80:83], s17 offen offset:3072 lds
    v_mfma_f32_16x16x32_bf16 v[100:103], a[204:207], a[176:179], v[100:103]
    v_mfma_f32_16x16x32_bf16 v[108:111], a[204:207], a[180:183], v[108:111]
    s_add_u32 s17, s17, 128
    s_mov_b32 s19, s20
    s_add_u32 s20, s20, 16384
    v_mfma_f32_16x16x32_bf16 v[116:119], a[204:207], a[184:187], v[116:119]
    s_and_b32 s20, s20, 131071
    v_mfma_f32_16x16x32_bf16 v[124:127], a[204:207], a[188:191], v[124:127]
    buffer_load_dwordx4 a[204:207], v12, s[32:35], s16 offen offset:1024 sc1
    s_add_u32 s16, s16, 2048
    s_waitcnt vmcnt(14) lgkmcnt(0)
    s_cmp_eq_u32 s31, 0
    s_cbranch_scc1 L_d2a_x2
    v_mfma_f32_16x16x32_bf16 v[240:243], a[208:211], v[24:27], v[240:243]
    v_mfma_f32_16x16x32_bf16 v[244:247], a[212:215], v[24:27], v[244:247]
L_d2a_x2:
    v_mfma_f32_16x16x32_bf16 v[64:67], a[208:211], a[128:131], v[64:67]
    v_mfma_f32_16x16x32_bf16 v[72:75], a[208:211], a[132:135], v[72:75]
    ds_read_b128 a[160:163], v19 offset:0
    v_mfma_f32_16x16x32_bf16 v[80:83], a[208:211], a[136:139], v[80:83]
    ds_read_b128 a[164:167], v19 offset:2048
    v_mfma_f32_16x16x32_bf16 v[88:91], a[208:211], a[140:143], v[88:91]
    ds_read_b128 a[168:171], v19 offset:4096
    v_mfma_f32_16x16x32_bf16 v[96:99], a[208:211], a[144:147], v[96:99]
    ds_read_b128 a[172:175], v19 offset:6144
    v_mfma_f32_16x16x32_bf16 v[104:107], a[208:211], a[148:151], v[104:107]
    ds_read_b128 a[176:179], v19 offset:8192
    v_mfma_f32_16x16x32_bf16 v[112:115], a[208:211], a[152:155], v[112:115]
    ds_read_b128 a[180:183], v19 offset:10240
    v_mfma_f32_16x16x32_bf16 v[120:123], a[208:211], a[156:159], v[120:123]
    ds_read_b128 a[184:187], v19 offset:12288
    buffer_load_dwordx4 a[208:211], v12, s[32:35], s16 offen offset:0 sc1
    v_mfma_f32_16x16x32_bf16 v[68:71], a[212:215], a[128:131], v[68:71]
    ds_read_b128 a[188:191], v19 offset:14336
    v_mfma_f32_16x16x32_bf16 v[76:79], a[212:215], a[132:135], v[76:79]
    v_mfma_f32_16x16x32_bf16 v[84:87], a[212:215], a[136:139], v[84:87]
    v_mfma_f32_16x16x32_bf16 v[92:95], a[212:215], a[140:143], v[92:95]
    v_mfma_f32_16x16x32_bf16 v[100:103], a[212:215], a[144:147], v[100:103]
    v_mfma_f32_16x16x32_bf16 v[108:111], a[212:215], a[148:151], v[108:111]
    v_mfma_f32_16x16x32_bf16 v[116:119], a[212:215], a[152:155], v[116:119]
    v_mfma_f32_16x16x32_bf16 v[124:127], a[212:215], a[156:159], v[124:127]
    buffer_load_dwordx4 a[212:215], v12, s[32:35], s16 offen offset:1024 sc1
    s_add_u32 s16, s16, 2048
    s_waitcnt vmcnt(14) lgkmcnt(0)
    s_cmp_eq_u32 s31, 0
    s_cbranch_scc1 L_d2a_x3
    v_mfma_f32_16x16x32_bf16 v[240:243], a[216:219], v[24:27], v[240:243]
    v_mfma_f32_16x16x32_bf16 v[244:247], a[220:223], v[24:27], v[244:247]
L_d2a_x3:
    v_mfma_f32_16x16x32_bf16 v[64:67], a[216:219], a[160:163], v[64:67]
    s_barrier
    v_add_u32 v18, s20, v16
    v_mfma_f32_16x16x32_bf16 v[72:75], a[216:219], a[164:167], v[72:75]
    ds_read_b128 a[128:131], v18 offset:0
    s_add_u32 m0, s21, s19
    v_mfma_f32_16x16x32_bf16 v[80:83], a[216:219], a[168:171], v[80:83]
    ds_read_b128 a[132:135], v18 offset:2048
    buffer_load_dwordx4 v20, s[80:83], s17 offen offset:0 lds
    v_mfma_f32_16x16x32_bf16 v[88:91], a[216:219], a[172:175], v[88:91]
    ds_read_b128 a[136:139], v18 offset:4096
    v_mfma_f32_16x16x32_bf16 v[96:99], a[216:219], a[176:179], v[96:99]
    ds_read_b128 a[140:143], v18 offset:6144
    v_mfma_f32_16x16x32_bf16 v[104:107], a[216:219], a[180:183], v[104:107]
    ds_read_b128 a[144:147], v18 offset:8192
    buffer_load_dwordx4 v21, s[80:83], s17 offen offset:1024 lds
    v_mfma_f32_16x16x32_bf16 v[112:115], a[216:219], a[184:187], v[112:115]
    ds_read_b128 a[148:151], v18 offset:10240
    v_mfma_f32_16x16x32_bf16 v[120:123], a[216:219], a[188:191], v[120:123]
    ds_read_b128 a[152:155], v18 offset:12288
    buffer_load_dwordx4 a[216:219], v12, s[32:35], s16 offen offset:0 sc1
    v_mfma_f32_16x16x32_bf16 v[68:71], a[220:223], a[160:163], v[68:71]
    ds_read_b128 a[156:159], v18 offset:14336
    buffer_load_dwordx4 v22, s[80:83], s17 offen offset:2048 lds
    v_mfma_f32_16x16x32_bf16 v[76:79], a[220:223], a[164:167], v[76:79]
    v_add_u32 v19, s20, v17
    v_mfma_f32_16x16x32_bf16 v[84:87], a[220:223], a[168:171], v[84:87]
    v_mfma_f32_16x16x32_bf16 v[92:95], a[220:223], a[172:175], v[92:95]
    buffer_load_dwordx4 v23, s[80:83], s17 offen offset:3072 lds
    v_mfma_f32_16x16x32_bf16 v[100:103], a[220:223], a[176:179], v[100:103]
    v_mfma_f32_16x16x32_bf16 v[108:111], a[220:223], a[180:183], v[108:111]
    s_add_u32 s17, s17, 128
    s_mov_b32 s19, s20
    s_add_u32 s20, s20, 16384
    v_mfma_f32_16x16x32_bf16 v[116:119], a[220:223], a[184:187], v[116:119]
    s_and_b32 s20, s20, 131071
    v_mfma_f32_16x16x32_bf16 v[124:127], a[220:223], a[188:191], v[124:127]
    buffer_load_dwordx4 a[220:223], v12, s[32:35], s16 offen offset:1024 sc1
    s_add_u32 s16, s16, 2048
    s_waitcnt vmcnt(14) lgkmcnt(0)
    s_cmp_eq_u32 s31, 0
    s_cbranch_scc1 L_d2a_x4
    v_mfma_f32_16x16x32_bf16 v[240:243], a[224:227], v[24:27], v[240:243]
    v_mfma_f32_16x16x32_bf16 v[244:247], a[228:231], v[24:27], v[244:247]
L_d2a_x4:
    v_mfma_f32_16x16x32_bf16 v[64:67], a[224:227], a[128:131], v[64:67]
    v_mfma_f32_16x16x32_bf16 v[72:75], a[224:227], a[132:135], v[72:75]
    ds_read_b128 a[160:163], v19 offset:0
    v_mfma_f32_16x16x32_bf16 v[80:83], a[224:227], a[136:139], v[80:83]
    ds_read_b128 a[164:167], v19 offset:2048
    v_mfma_f32_16x16x32_bf16 v[88:91], a[224:227], a[140:143], v[88:91]
    ds_read_b128 a[168:171], v19 offset:4096
    v_mfma_f32_16x16x32_bf16 v[96:99], a[224:227], a[144:147], v[96:99]
    ds_read_b128 a[172:175], v19 offset:6144
    v_mfma_f32_16x16x32_bf16 v[104:107], a[224:227], a[148:151], v[104:107]
    ds_read_b128 a[176:179], v19 offset:8192
    v_mfma_f32_16x16x32_bf16 v[112:115], a[224:227], a[152:155], v[112:115]
    ds_read_b128 a[180:183], v19 offset:10240
    v_mfma_f32_16x16x32_bf16 v[120:123], a[224:227], a[156:159], v[120:123]
    ds_read_b128 a[184:187], v19 offset:12288
    buffer_load_dwordx4 a[224:227], v12, s[32:35], s16 offen offset:0 sc1
    v_mfma_f32_16x16x32_bf16 v[68:71], a[228:231], a[128:131], v[68:71]
    ds_read_b128 a[188:191], v19 offset:14336
    v_mfma_f32_16x16x32_bf16 v[76:79], a[228:231], a[132:135], v[76:79]
    v_mfma_f32_16x16x32_bf16 v[84:87], a[228:231], a[136:139], v[84:87]
    v_mfma_f32_16x16x32_bf16 v[92:95], a[228:231], a[140:143], v[92:95]
    v_mfma_f32_16x16x32_bf16 v[100:103], a[228:231], a[144:147], v[100:103]
    v_mfma_f32_16x16x32_bf16 v[108:111], a[228:231], a[148:151], v[108:111]
    v_mfma_f32_16x16x32_bf16 v[116:119], a[228:231], a[152:155], v[116:119]
    v_mfma_f32_16x16x32_bf16 v[124:127], a[228:231], a[156:159], v[124:127]
    buffer_load_dwordx4 a[228:231], v12, s[32:35], s16 offen offset:1024 sc1
    s_add_u32 s16, s16, 2048
    s_waitcnt vmcnt(14) lgkmcnt(0)
    s_cmp_eq_u32 s31, 0
    s_cbranch_scc1 L_d2a_x5
    v_mfma_f32_16x16x32_bf16 v[240:243], a[232:235], v[24:27], v[240:243]
    v_mfma_f32_16x16x32_bf16 v[244:247], a[236:239], v[24:27], v[244:247]
L_d2a_x5:
    v_mfma_f32_16x16x32_bf16 v[64:67], a[232:235], a[160:163], v[64:67]
    s_barrier
    v_add_u32 v18, s20, v16
    v_mfma_f32_16x16x32_bf16 v[72:75], a[232:235], a[164:167], v[72:75]
    ds_read_b128 a[128:131], v18 offset:0
    s_add_u32 m0, s21, s19
    v_mfma_f32_16x16x32_bf16 v[80:83], a[232:235], a[168:171], v[80:83]
    ds_read_b128 a[132:135], v18 offset:2048
    buffer_load_dwordx4 v20, s[80:83], s17 offen offset:0 lds
    v_mfma_f32_16x16x32_bf16 v[88:91], a[232:235], a[172:175], v[88:91]
    ds_read_b128 a[136:139], v18 offset:4096
    v_mfma_f32_16x16x32_bf16 v[96:99], a[232:235], a[176:179], v[96:99]
    ds_read_b128 a[140:143], v18 offset:6144
    v_mfma_f32_16x16x32_bf16 v[104:107], a[232:235], a[180:183], v[104:107]
    ds_read_b128 a[144:147], v18 offset:8192
    buffer_load_dwordx4 v21, s[80:83], s17 offen offset:1024 lds
    v_mfma_f32_16x16x32_bf16 v[112:115], a[232:235], a[184:187], v[112:115]
    ds_read_b128 a[148:151], v18 offset:10240
    v_mfma_f32_16x16x32_bf16 v[120:123], a[232:235], a[188:191], v[120:123]
    ds_read_b128 a[152:155], v18 offset:12288
    buffer_load_dwordx4 a[232:235], v12, s[32:35], s16 offen offset:0 sc1
    v_mfma_f32_16x16x32_bf16 v[68:71], a[236:239], a[160:163], v[68:71]
    ds_read_b128 a[156:159], v18 offset:14336
    buffer_load_dwordx4 v22, s[80:83], s17 offen offset:2048 lds
    v_mfma_f32_16x16x32_bf16 v[76:79], a[236:239], a[164:167], v[76:79]
    v_add_u32 v19, s20, v17
    v_mfma_f32_16x16x32_bf16 v[84:87], a[236:239], a[168:171], v[84:87]
    v_mfma_f32_16x16x32_bf16 v[92:95], a[236:239], a[172:175], v[92:95]
    buffer_load_dwordx4 v23, s[80:83], s17 offen offset:3072 lds
    v_mfma_f32_16x16x32_bf16 v[100:103], a[236:239], a[176:179], v[100:103]
    v_mfma_f32_16x16x32_bf16 v[108:111], a[236:239], a[180:183], v[108:111]
    s_add_u32 s17, s17, 128
    s_mov_b32 s19, s20
    s_add_u32 s20, s20, 16384
    v_mfma_f32_16x16x32_bf16 v[116:119], a[236:239], a[184:187], v[116:119]
    s_and_b32 s20, s20, 131071
    v_mfma_f32_16x16x32_bf16 v[124:127], a[236:239], a[188:191], v[124:127]
    buffer_load_dwordx4 a[236:239], v12, s[32:35], s16 offen offset:1024 sc1
    s_add_u32 s16, s16, 2048
    s_waitcnt vmcnt(14) lgkmcnt(0)
    s_cmp_eq_u32 s31, 0
    s_cbranch_scc1 L_d2a_x6
    v_mfma_f32_16x16x32_bf16 v[240:243], a[240:243], v[24:27], v[240:243]
    v_mfma_f32_16x16x32_bf16 v[244:247], a[244:247], v[24:27], v[244:247]
L_d2a_x6:
    v_mfma_f32_16x16x32_bf16 v[64:67], a[240:243], a[128:131], v[64:67]
    v_mfma_f32_16x16x32_bf16 v[72:75], a[240:243], a[132:135], v[72:75]
    ds_read_b128 a[160:163], v19 offset:0
    v_mfma_f32_16x16x32_bf16 v[80:83], a[240:243], a[136:139], v[80:83]
    ds_read_b128 a[164:167], v19 offset:2048
    v_mfma_f32_16x16x32_bf16 v[88:91], a[240:243], a[140:143], v[88:91]
    ds_read_b128 a[168:171], v19 offset:4096
    v_mfma_f32_16x16x32_bf16 v[96:99], a[240:243], a[144:147], v[96:99]
    ds_read_b128 a[172:175], v19 offset:6144
    v_mfma_f32_16x16x32_bf16 v[104:107], a[240:243], a[148:151], v[104:107]
    ds_read_b128 a[176:179], v19 offset:8192
    v_mfma_f32_16x16x32_bf16 v[112:115], a[240:243], a[152:155], v[112:115]
    ds_read_b128 a[180:183], v19 offset:10240
    v_mfma_f32_16x16x32_bf16 v[120:123], a[240:243], a[156:159], v[120:123]
    ds_read_b128 a[184:187], v19 offset:12288
    buffer_load_dwordx4 a[240:243], v12, s[32:35], s16 offen offset:0 sc1
    v_mfma_f32_16x16x32_bf16 v[68:71], a[244:247], a[128:131], v[68:71]
    ds_read_b128 a[188:191], v19 offset:14336
    v_mfma_f32_16x16x32_bf16 v[76:79], a[244:247], a[132:135], v[76:79]
    v_mfma_f32_16x16x32_bf16 v[84:87], a[244:247], a[136:139], v[84:87]
    v_mfma_f32_16x16x32_bf16 v[92:95], a[244:247], a[140:143], v[92:95]
    v_mfma_f32_16x16x32_bf16 v[100:103], a[244:247], a[144:147], v[100:103]
    v_mfma_f32_16x16x32_bf16 v[108:111], a[244:247], a[148:151], v[108:111]
    v_mfma_f32_16x16x32_bf16 v[116:119], a[244:247], a[152:155], v[116:119]
    v_mfma_f32_16x16x32_bf16 v[124:127], a[244:247], a[156:159], v[124:127]
    buffer_load_dwordx4 a[244:247], v12, s[32:35], s16 offen offset:1024 sc1
    s_add_u32 s16, s16, 2048
    s_waitcnt vmcnt(14) lgkmcnt(0)
    s_cmp_eq_u32 s31, 0
    s_cbranch_scc1 L_d2a_x7
    v_mfma_f32_16x16x32_bf16 v[240:243], a[248:251], v[24:27], v[240:243]
    v_mfma_f32_16x16x32_bf16 v[244:247], a[252:255], v[24:27], v[244:247]
L_d2a_x7:
    v_mfma_f32_16x16x32_bf16 v[64:67], a[248:251], a[160:163], v[64:67]
    s_barrier
    v_add_u32 v18, s20, v16
    v_mfma_f32_16x16x32_bf16 v[72:75], a[248:251], a[164:167], v[72:75]
    ds_read_b128 a[128:131], v18 offset:0
    s_add_u32 m0, s21, s19
    v_mfma_f32_16x16x32_bf16 v[80:83], a[248:251], a[168:171], v[80:83]
    ds_read_b128 a[132:135], v18 offset:2048
    buffer_load_dwordx4 v20, s[80:83], s17 offen offset:0 lds
    v_mfma_f32_16x16x32_bf16 v[88:91], a[248:251], a[172:175], v[88:91]
    ds_read_b128 a[136:139], v18 offset:4096
    v_mfma_f32_16x16x32_bf16 v[96:99], a[248:251], a[176:179], v[96:99]
    ds_read_b128 a[140:143], v18 offset:6144
    v_mfma_f32_16x16x32_bf16 v[104:107], a[248:251], a[180:183], v[104:107]
    ds_read_b128 a[144:147], v18 offset:8192
    buffer_load_dwordx4 v21, s[80:83], s17 offen offset:1024 lds
    v_mfma_f32_16x16x32_bf16 v[112:115], a[248:251], a[184:187], v[112:115]
    ds_read_b128 a[148:151], v18 offset:10240
    v_mfma_f32_16x16x32_bf16 v[120:123], a[248:251], a[188:191], v[120:123]
    ds_read_b128 a[152:155], v18 offset:12288
    buffer_load_dwordx4 a[248:251], v12, s[32:35], s16 offen offset:0 sc1
    v_mfma_f32_16x16x32_bf16 v[68:71], a[252:255], a[160:163], v[68:71]
    ds_read_b128 a[156:159], v18 offset:14336
    buffer_load_dwordx4 v22, s[80:83], s17 offen offset:2048 lds
    v_mfma_f32_16x16x32_bf16 v[76:79], a[252:255], a[164:167], v[76:79]
    v_add_u32 v19, s20, v17
    v_mfma_f32_16x16x32_bf16 v[84:87], a[252:255], a[168:171], v[84:87]
    v_mfma_f32_16x16x32_bf16 v[92:95], a[252:255], a[172:175], v[92:95]
    buffer_load_dwordx4 v23, s[80:83], s17 offen offset:3072 lds
    v_mfma_f32_16x16x32_bf16 v[100:103], a[252:255], a[176:179], v[100:103]
    v_mfma_f32_16x16x32_bf16 v[108:111], a[252:255], a[180:183], v[108:111]
    s_add_u32 s17, s17, 128
    s_mov_b32 s19, s20
    s_add_u32 s20, s20, 16384
    v_mfma_f32_16x16x32_bf16 v[116:119], a[252:255], a[184:187], v[116:119]
    s_and_b32 s20, s20, 131071
    v_mfma_f32_16x16x32_bf16 v[124:127], a[252:255], a[188:191], v[124:127]
    buffer_load_dwordx4 a[252:255], v12, s[32:35], s16 offen offset:1024 sc1
    s_add_u32 s16, s16, 2048
    s_add_u32 s18, s18, 1
    s_cmp_lt_u32 s18, 2
    s_cbranch_scc1 L_d2a_loop
    s_mov_b32 s18, 0
    s_mov_b32 s17, 0
    .p2align 6
L_d2b_loop:
    s_waitcnt vmcnt(14) lgkmcnt(0)
    v_mfma_f32_16x16x32_bf16 v[128:131], a[192:195], a[128:131], v[128:131]
    v_mfma_f32_16x16x32_bf16 v[136:139], a[192:195], a[132:135], v[136:139]
    ds_read_b128 a[160:163], v19 offset:0
    v_mfma_f32_16x16x32_bf16 v[144:147], a[192:195], a[136:139], v[144:147]
    ds_read_b128 a[164:167], v19 offset:2048
    v_mfma_f32_16x16x32_bf16 v[152:155], a[192:195], a[140:143], v[152:155]
    ds_read_b128 a[168:171], v19 offset:4096
    v_mfma_f32_16x16x32_bf16 v[160:163], a[192:195], a[144:147], v[160:163]
    ds_read_b128 a[172:175], v19 offset:6144
    v_mfma_f32_16x16x32_bf16 v[168:171], a[192:195], a[148:151], v[168:171]
    ds_read_b128 a[176:179], v19 offset:8192
    v_mfma_f32_16x16x32_bf16 v[176:179], a[192:195], a[152:155], v[176:179]
    ds_read_b128 a[180:183], v19 offset:10240
    v_mfma_f32_16x16x32_bf16 v[184:187], a[192:195], a[156:159], v[184:187]
    ds_read_b128 a[184:187], v19 offset:12288
    buffer_load_dwordx4 a[192:195], v12, s[32:35], s16 offen offset:0 sc1
    v_mfma_f32_16x16x32_bf16 v[132:135], a[196:199], a[128:131], v[132:135]
    ds_read_b128 a[188:191], v19 offset:14336
    v_mfma_f32_16x16x32_bf16 v[140:143], a[196:199], a[132:135], v[140:143]
    v_mfma_f32_16x16x32_bf16 v[148:151], a[196:199], a[136:139], v[148:151]
    v_mfma_f32_16x16x32_bf16 v[156:159], a[196:199], a[140:143], v[156:159]
    v_mfma_f32_16x16x32_bf16 v[164:167], a[196:199], a[144:147], v[164:167]
    v_mfma_f32_16x16x32_bf16 v[172:175], a[196:199], a[148:151], v[172:175]
    v_mfma_f32_16x16x32_bf16 v[180:183], a[196:199], a[152:155], v[180:183]
    v_mfma_f32_16x16x32_bf16 v[188:191], a[196:199], a[156:159], v[188:191]
    buffer_load_dwordx4 a[196:199], v12, s[32:35], s16 offen offset:1024 sc1
    s_add_u32 s16, s16, 2048
    s_waitcnt vmcnt(14) lgkmcnt(0)
    v_mfma_f32_16x16x32_bf16 v[128:131], a[200:203], a[160:163], v[128:131]
    s_barrier
    v_add_u32 v18, s20, v16
    v_mfma_f32_16x16x32_bf16 v[136:139], a[200:203], a[164:167], v[136:139]
    ds_read_b128 a[128:131], v18 offset:0
    s_add_u32 m0, s21, s19
    v_mfma_f32_16x16x32_bf16 v[144:147], a[200:203], a[168:171], v[144:147]
    ds_read_b128 a[132:135], v18 offset:2048
    buffer_load_dwordx4 v8, s[4:7], s17 offen offset:0 lds
    v_mfma_f32_16x16x32_bf16 v[152:155], a[200:203], a[172:175], v[152:155]
    ds_read_b128 a[136:139], v18 offset:4096
    v_mfma_f32_16x16x32_bf16 v[160:163], a[200:203], a[176:179], v[160:163]
    ds_read_b128 a[140:143], v18 offset:6144
    v_mfma_f32_16x16x32_bf16 v[168:171], a[200:203], a[180:183], v[168:171]
    ds_read_b128 a[144:147], v18 offset:8192
    buffer_load_dwordx4 v9, s[4:7], s17 offen offset:1024 lds
    v_mfma_f32_16x16x32_bf16 v[176:179], a[200:203], a[184:187], v[176:179]
    ds_read_b128 a[148:151], v18 offset:10240
    v_mfma_f32_16x16x32_bf16 v[184:187], a[200:203], a[188:191], v[184:187]
    ds_read_b128 a[152:155], v18 offset:12288
    buffer_load_dwordx4 a[200:203], v12, s[32:35], s16 offen offset:0 sc1
    v_mfma_f32_16x16x32_bf16 v[132:135], a[204:207], a[160:163], v[132:135]
    ds_read_b128 a[156:159], v18 offset:14336
    buffer_load_dwordx4 v10, s[4:7], s17 offen offset:2048 lds
    v_mfma_f32_16x16x32_bf16 v[140:143], a[204:207], a[164:167], v[140:143]
    v_add_u32 v19, s20, v17
    v_mfma_f32_16x16x32_bf16 v[148:151], a[204:207], a[168:171], v[148:151]
    v_mfma_f32_16x16x32_bf16 v[156:159], a[204:207], a[172:175], v[156:159]
    buffer_load_dwordx4 v11, s[4:7], s17 offen offset:3072 lds
    v_mfma_f32_16x16x32_bf16 v[164:167], a[204:207], a[176:179], v[164:167]
    v_mfma_f32_16x16x32_bf16 v[172:175], a[204:207], a[180:183], v[172:175]
    s_add_u32 s17, s17, 131072
    s_mov_b32 s19, s20
    s_add_u32 s20, s20, 16384
    v_mfma_f32_16x16x32_bf16 v[180:183], a[204:207], a[184:187], v[180:183]
    s_and_b32 s20, s20, 131071
    v_mfma_f32_16x16x32_bf16 v[188:191], a[204:207], a[188:191], v[188:191]
    buffer_load_dwordx4 a[204:207], v12, s[32:35], s16 offen offset:1024 sc1
    s_add_u32 s16, s16, 2048
    s_waitcnt vmcnt(14) lgkmcnt(0)
    v_mfma_f32_16x16x32_bf16 v[128:131], a[208:211], a[128:131], v[128:131]
    v_mfma_f32_16x16x32_bf16 v[136:139], a[208:211], a[132:135], v[136:139]
    ds_read_b128 a[160:163], v19 offset:0
    v_mfma_f32_16x16x32_bf16 v[144:147], a[208:211], a[136:139], v[144:147]
    ds_read_b128 a[164:167], v19 offset:2048
    v_mfma_f32_16x16x32_bf16 v[152:155], a[208:211], a[140:143], v[152:155]
    ds_read_b128 a[168:171], v19 offset:4096
    v_mfma_f32_16x16x32_bf16 v[160:163], a[208:211], a[144:147], v[160:163]
    ds_read_b128 a[172:175], v19 offset:6144
    v_mfma_f32_16x16x32_bf16 v[168:171], a[208:211], a[148:151], v[168:171]
    ds_read_b128 a[176:179], v19 offset:8192
    v_mfma_f32_16x16x32_bf16 v[176:179], a[208:211], a[152:155], v[176:179]
    ds_read_b128 a[180:183], v19 offset:10240
    v_mfma_f32_16x16x32_bf16 v[184:187], a[208:211], a[156:159], v[184:187]
    ds_read_b128 a[184:187], v19 offset:12288
    buffer_load_dwordx4 a[208:211], v12, s[32:35], s16 offen offset:0 sc1
    v_mfma_f32_16x16x32_bf16 v[132:135], a[212:215], a[128:131], v[132:135]
    ds_read_b128 a[188:191], v19 offset:14336
    v_mfma_f32_16x16x32_bf16 v[140:143], a[212:215], a[132:135], v[140:143]
    v_mfma_f32_16x16x32_bf16 v[148:151], a[212:215], a[136:139], v[148:151]
    v_mfma_f32_16x16x32_bf16 v[156:159], a[212:215], a[140:143], v[156:159]
    v_mfma_f32_16x16x32_bf16 v[164:167], a[212:215], a[144:147], v[164:167]
    v_mfma_f32_16x16x32_bf16 v[172:175], a[212:215], a[148:151], v[172:175]
    v_mfma_f32_16x16x32_bf16 v[180:183], a[212:215], a[152:155], v[180:183]
    v_mfma_f32_16x16x32_bf16 v[188:191], a[212:215], a[156:159], v[188:191]
    buffer_load_dwordx4 a[212:215], v12, s[32:35], s16 offen offset:1024 sc1
    s_add_u32 s16, s16, 2048
    s_waitcnt vmcnt(14) lgkmcnt(0)
    v_mfma_f32_16x16x32_bf16 v[128:131], a[216:219], a[160:163], v[128:131]
    s_barrier
    v_add_u32 v18, s20, v16
    v_mfma_f32_16x16x32_bf16 v[136:139], a[216:219], a[164:167], v[136:139]
    ds_read_b128 a[128:131], v18 offset:0
    s_add_u32 m0, s21, s19
    v_mfma_f32_16x16x32_bf16 v[144:147], a[216:219], a[168:171], v[144:147]
    ds_read_b128 a[132:135], v18 offset:2048
    buffer_load_dwordx4 v8, s[4:7], s17 offen offset:0 lds
    v_mfma_f32_16x16x32_bf16 v[152:155], a[216:219], a[172:175], v[152:155]
    ds_read_b128 a[136:139], v18 offset:4096
    v_mfma_f32_16x16x32_bf16 v[160:163], a[216:219], a[176:179], v[160:163]
    ds_read_b128 a[140:143], v18 offset:6144
    v_mfma_f32_16x16x32_bf16 v[168:171], a[216:219], a[180:183], v[168:171]
    ds_read_b128 a[144:147], v18 offset:8192
    buffer_load_dwordx4 v9, s[4:7], s17 offen offset:1024 lds
    v_mfma_f32_16x16x32_bf16 v[176:179], a[216:219], a[184:187], v[176:179]
    ds_read_b128 a[148:151], v18 offset:10240
    v_mfma_f32_16x16x32_bf16 v[184:187], a[216:219], a[188:191], v[184:187]
    ds_read_b128 a[152:155], v18 offset:12288
    buffer_load_dwordx4 a[216:219], v12, s[32:35], s16 offen offset:0 sc1
    v_mfma_f32_16x16x32_bf16 v[132:135], a[220:223], a[160:163], v[132:135]
    ds_read_b128 a[156:159], v18 offset:14336
    buffer_load_dwordx4 v10, s[4:7], s17 offen offset:2048 lds
    v_mfma_f32_16x16x32_bf16 v[140:143], a[220:223], a[164:167], v[140:143]
    v_add_u32 v19, s20, v17
    v_mfma_f32_16x16x32_bf16 v[148:151], a[220:223], a[168:171], v[148:151]
    v_mfma_f32_16x16x32_bf16 v[156:159], a[220:223], a[172:175], v[156:159]
    buffer_load_dwordx4 v11, s[4:7], s17 offen offset:3072 lds
    v_mfma_f32_16x16x32_bf16 v[164:167], a[220:223], a[176:179], v[164:167]
    v_mfma_f32_16x16x32_bf16 v[172:175], a[220:223], a[180:183], v[172:175]
    s_add_u32 s17, s17, 131072
    s_mov_b32 s19, s20
    s_add_u32 s20, s20, 16384
    v_mfma_f32_16x16x32_bf16 v[180:183], a[220:223], a[184:187], v[180:183]
    s_and_b32 s20, s20, 131071
    v_mfma_f32_16x16x32_bf16 v[188:191], a[220:223], a[188:191], v[188:191]
    buffer_load_dwordx4 a[220:223], v12, s[32:35], s16 offen offset:1024 sc1
    s_add_u32 s16, s16, 2048
    s_waitcnt vmcnt(14) lgkmcnt(0)
    v_mfma_f32_16x16x32_bf16 v[128:131], a[224:227], a[128:131], v[128:131]
    v_mfma_f32_16x16x32_bf16 v[136:139], a[224:227], a[132:135], v[136:139]
    ds_read_b128 a[160:163], v19 offset:0
    v_mfma_f32_16x16x32_bf16 v[144:147], a[224:227], a[136:139], v[144:147]
    ds_read_b128 a[164:167], v19 offset:2048
    v_mfma_f32_16x16x32_bf16 v[152:155], a[224:227], a[140:143], v[152:155]
    ds_read_b128 a[168:171], v19 offset:4096
    v_mfma_f32_16x16x32_bf16 v[160:163], a[224:227], a[144:147], v[160:163]
    ds_read_b128 a[172:175], v19 offset:6144
    v_mfma_f32_16x16x32_bf16 v[168:171], a[224:227], a[148:151], v[168:171]
    ds_read_b128 a[176:179], v19 offset:8192
    v_mfma_f32_16x16x32_bf16 v[176:179], a[224:227], a[152:155], v[176:179]
    ds_read_b128 a[180:183], v19 offset:10240
    v_mfma_f32_16x16x32_bf16 v[184:187], a[224:227], a[156:159], v[184:187]
    ds_read_b128 a[184:187], v19 offset:12288
    buffer_load_dwordx4 a[224:227], v12, s[32:35], s16 offen offset:0 sc1
    v_mfma_f32_16x16x32_bf16 v[132:135], a[228:231], a[128:131], v[132:135]
    ds_read_b128 a[188:191], v19 offset:14336
    v_mfma_f32_16x16x32_bf16 v[140:143], a[228:231], a[132:135], v[140:143]
    v_mfma_f32_16x16x32_bf16 v[148:151], a[228:231], a[136:139], v[148:151]
    v_mfma_f32_16x16x32_bf16 v[156:159], a[228:231], a[140:143], v[156:159]
    v_mfma_f32_16x16x32_bf16 v[164:167], a[228:231], a[144:147], v[164:167]
    v_mfma_f32_16x16x32_bf16 v[172:175], a[228:231], a[148:151], v[172:175]
    v_mfma_f32_16x16x32_bf16 v[180:183], a[228:231], a[152:155], v[180:183]
    v_mfma_f32_16x16x32_bf16 v[188:191], a[228:231], a[156:159], v[188:191]
    buffer_load_dwordx4 a[228:231], v12, s[32:35], s16 offen offset:1024 sc1
    s_add_u32 s16, s16, 2048
    s_waitcnt vmcnt(14) lgkmcnt(0)
    v_mfma_f32_16x16x32_bf16 v[128:131], a[232:235], a[160:163], v[128:131]
    s_barrier
    v_add_u32 v18, s20, v16
    v_mfma_f32_16x16x32_bf16 v[136:139], a[232:235], a[164:167], v[136:139]
    ds_read_b128 a[128:131], v18 offset:0
    s_add_u32 m0, s21, s19
    v_mfma_f32_16x16x32_bf16 v[144:147], a[232:235], a[168:171], v[144:147]
    ds_read_b128 a[132:135], v18 offset:2048
    buffer_load_dwordx4 v8, s[4:7], s17 offen offset:0 lds
    v_mfma_f32_16x16x32_bf16 v[152:155], a[232:235], a[172:175], v[152:155]
    ds_read_b128 a[136:139], v18 offset:4096
    v_mfma_f32_16x16x32_bf16 v[160:163], a[232:235], a[176:179], v[160:163]
    ds_read_b128 a[140:143], v18 offset:6144
    v_mfma_f32_16x16x32_bf16 v[168:171], a[232:235], a[180:183], v[168:171]
    ds_read_b128 a[144:147], v18 offset:8192
    buffer_load_dwordx4 v9, s[4:7], s17 offen offset:1024 lds
    v_mfma_f32_16x16x32_bf16 v[176:179], a[232:235], a[184:187], v[176:179]
    ds_read_b128 a[148:151], v18 offset:10240
    v_mfma_f32_16x16x32_bf16 v[184:187], a[232:235], a[188:191], v[184:187]
    ds_read_b128 a[152:155], v18 offset:12288
    buffer_load_dwordx4 a[232:235], v12, s[32:35], s16 offen offset:0 sc1
    v_mfma_f32_16x16x32_bf16 v[132:135], a[236:239], a[160:163], v[132:135]
    ds_read_b128 a[156:159], v18 offset:14336
    buffer_load_dwordx4 v10, s[4:7], s17 offen offset:2048 lds
    v_mfma_f32_16x16x32_bf16 v[140:143], a[236:239], a[164:167], v[140:143]
    v_add_u32 v19, s20, v17
    v_mfma_f32_16x16x32_bf16 v[148:151], a[236:239], a[168:171], v[148:151]
    v_mfma_f32_16x16x32_bf16 v[156:159], a[236:239], a[172:175], v[156:159]
    buffer_load_dwordx4 v11, s[4:7], s17 offen offset:3072 lds
    v_mfma_f32_16x16x32_bf16 v[164:167], a[236:239], a[176:179], v[164:167]
    v_mfma_f32_16x16x32_bf16 v[172:175], a[236:239], a[180:183], v[172:175]
    s_add_u32 s17, s17, 131072
    s_mov_b32 s19, s20
    s_add_u32 s20, s20, 16384
    v_mfma_f32_16x16x32_bf16 v[180:183], a[236:239], a[184:187], v[180:183]
    s_and_b32 s20, s20, 131071
    v_mfma_f32_16x16x32_bf16 v[188:191], a[236:239], a[188:191], v[188:191]
    buffer_load_dwordx4 a[236:239], v12, s[32:35], s16 offen offset:1024 sc1
    s_add_u32 s16, s16, 2048
    s_waitcnt vmcnt(14) lgkmcnt(0)
    v_mfma_f32_16x16x32_bf16 v[128:131], a[240:243], a[128:131], v[128:131]
    v_mfma_f32_16x16x32_bf16 v[136:139], a[240:243], a[132:135], v[136:139]
    ds_read_b128 a[160:163], v19 offset:0
    v_mfma_f32_16x16x32_bf16 v[144:147], a[240:243], a[136:139], v[144:147]
    ds_read_b128 a[164:167], v19 offset:2048
    v_mfma_f32_16x16x32_bf16 v[152:155], a[240:243], a[140:143], v[152:155]
    ds_read_b128 a[168:171], v19 offset:4096
    v_mfma_f32_16x16x32_bf16 v[160:163], a[240:243], a[144:147], v[160:163]
    ds_read_b128 a[172:175], v19 offset:6144
    v_mfma_f32_16x16x32_bf16 v[168:171], a[240:243], a[148:151], v[168:171]
    ds_read_b128 a[176:179], v19 offset:8192
    v_mfma_f32_16x16x32_bf16 v[176:179], a[240:243], a[152:155], v[176:179]
    ds_read_b128 a[180:183], v19 offset:10240
    v_mfma_f32_16x16x32_bf16 v[184:187], a[240:243], a[156:159], v[184:187]
    ds_read_b128 a[184:187], v19 offset:12288
    buffer_load_dwordx4 a[240:243], v12, s[32:35], s16 offen offset:0 sc1
    v_mfma_f32_16x16x32_bf16 v[132:135], a[244:247], a[128:131], v[132:135]
    ds_read_b128 a[188:191], v19 offset:14336
    v_mfma_f32_16x16x32_bf16 v[140:143], a[244:247], a[132:135], v[140:143]
    v_mfma_f32_16x16x32_bf16 v[148:151], a[244:247], a[136:139], v[148:151]
    v_mfma_f32_16x16x32_bf16 v[156:159], a[244:247], a[140:143], v[156:159]
    v_mfma_f32_16x16x32_bf16 v[164:167], a[244:247], a[144:147], v[164:167]
    v_mfma_f32_16x16x32_bf16 v[172:175], a[244:247], a[148:151], v[172:175]
    v_mfma_f32_16x16x32_bf16 v[180:183], a[244:247], a[152:155], v[180:183]
    v_mfma_f32_16x16x32_bf16 v[188:191], a[244:247], a[156:159], v[188:191]
    buffer_load_dwordx4 a[244:247], v12, s[32:35], s16 offen offset:1024 sc1
    s_add_u32 s16, s16, 2048
    s_waitcnt vmcnt(14) lgkmcnt(0)
    v_mfma_f32_16x16x32_bf16 v[128:131], a[248:251], a[160:163], v[128:131]
    s_barrier
    v_add_u32 v18, s20, v16
    v_mfma_f32_16x16x32_bf16 v[136:139], a[248:251], a[164:167], v[136:139]
    ds_read_b128 a[128:131], v18 offset:0
    s_add_u32 m0, s21, s19
    v_mfma_f32_16x16x32_bf16 v[144:147], a[248:251], a[168:171], v[144:147]
    ds_read_b128 a[132:135], v18 offset:2048
    buffer_load_dwordx4 v8, s[4:7], s17 offen offset:0 lds
    v_mfma_f32_16x16x32_bf16 v[152:155], a[248:251], a[172:175], v[152:155]
    ds_read_b128 a[136:139], v18 offset:4096
    v_mfma_f32_16x16x32_bf16 v[160:163], a[248:251], a[176:179], v[160:163]
    ds_read_b128 a[140:143], v18 offset:6144
    v_mfma_f32_16x16x32_bf16 v[168:171], a[248:251], a[180:183], v[168:171]
    ds_read_b128 a[144:147], v18 offset:8192
    buffer_load_dwordx4 v9, s[4:7], s17 offen offset:1024 lds
    v_mfma_f32_16x16x32_bf16 v[176:179], a[248:251], a[184:187], v[176:179]
    ds_read_b128 a[148:151], v18 offset:10240
    v_mfma_f32_16x16x32_bf16 v[184:187], a[248:251], a[188:191], v[184:187]
    ds_read_b128 a[152:155], v18 offset:12288
    buffer_load_dwordx4 a[248:251], v12, s[32:35], s16 offen offset:0 sc1
    v_mfma_f32_16x16x32_bf16 v[132:135], a[252:255], a[160:163], v[132:135]
    ds_read_b128 a[156:159], v18 offset:14336
    buffer_load_dwordx4 v10, s[4:7], s17 offen offset:2048 lds
    v_mfma_f32_16x16x32_bf16 v[140:143], a[252:255], a[164:167], v[140:143]
    v_add_u32 v19, s20, v17
    v_mfma_f32_16x16x32_bf16 v[148:151], a[252:255], a[168:171], v[148:151]
    v_mfma_f32_16x16x32_bf16 v[156:159], a[252:255], a[172:175], v[156:159]
    buffer_load_dwordx4 v11, s[4:7], s17 offen offset:3072 lds
    v_mfma_f32_16x16x32_bf16 v[164:167], a[252:255], a[176:179], v[164:167]
    v_mfma_f32_16x16x32_bf16 v[172:175], a[252:255], a[180:183], v[172:175]
    s_add_u32 s17, s17, 131072
    s_mov_b32 s19, s20
    s_add_u32 s20, s20, 16384
    v_mfma_f32_16x16x32_bf16 v[180:183], a[252:255], a[184:187], v[180:183]
    s_and_b32 s20, s20, 131071
    v_mfma_f32_16x16x32_bf16 v[188:191], a[252:255], a[188:191], v[188:191]
    buffer_load_dwordx4 a[252:255], v12, s[32:35], s16 offen offset:1024 sc1
    s_add_u32 s16, s16, 2048
    s_add_u32 s18, s18, 1
    s_cmp_lt_u32 s18, 2
    s_cbranch_scc1 L_d2b_loop
    s_waitcnt lgkmcnt(0)
    s_nop 7
    v_and_b32 v2, 15, v1
    v_lshlrev_b32 v20, 6, v2
    v_lshrrev_b32 v3, 4, v1
    v_and_b32 v4, 1, v3
    v_lshl_add_u32 v20, v4, 5, v20
    v_lshrrev_b32 v4, 1, v3
    v_lshl_add_u32 v20, v4, 4, v20
    v_lshlrev_b32 v21, 3, v3
    s_lshl_b32 s22, s67, 2
    s_add_u32 s22, s22, s3
    s_mul_i32 s22, s22, 33792
    s_mul_i32 s27, s30, 574464
    s_add_u32 s22, s22, s27
    s_add_u32 s22, s22, 21168128
    s_and_b32 s26, s66, 3
    s_lshl_b32 s26, s26, 13
    s_add_u32 s25, s22, s26

    v_lshlrev_b32 v3, 31, v1
    v_mul_f32 v192, s74, v192
    v_mul_f32 v200, s75, v200
    v_mul_f32 v193, s74, v193
    v_mul_f32 v201, s75, v201
    v_mul_f32 v194, s74, v194
    v_mul_f32 v202, s75, v202
    v_mul_f32 v195, s74, v195
    v_mul_f32 v203, s75, v203
    v_mul_f32 v196, s74, v196
    v_mul_f32 v204, s75, v204
    v_mul_f32 v197, s74, v197
    v_mul_f32 v205, s75, v205
    v_mul_f32 v198, s74, v198
    v_mul_f32 v206, s75, v206
    v_mul_f32 v199, s74, v199
    v_mul_f32 v207, s75, v207
    v_sub_f32 v208, v192, v200
    v_add_f32 v216, v192, v200
    v_sub_f32 v209, v193, v201
    v_add_f32 v217, v193, v201
    v_sub_f32 v210, v194, v202
    v_add_f32 v218, v194, v202
    v_sub_f32 v211, v195, v203
    v_add_f32 v219, v195, v203
    v_sub_f32 v212, v196, v204
    v_add_f32 v220, v196, v204
    v_sub_f32 v213, v197, v205
    v_add_f32 v221, v197, v205
    v_sub_f32 v214, v198, v206
    v_add_f32 v222, v198, v206
    v_sub_f32 v215, v199, v207
    v_add_f32 v223, v199, v207
    v_xor_b32 v208, v3, v208
    v_xor_b32 v209, v3, v209
    v_xor_b32 v210, v3, v210
    v_xor_b32 v211, v3, v211
    v_xor_b32 v212, v3, v212
    v_xor_b32 v213, v3, v213
    v_xor_b32 v214, v3, v214
    v_xor_b32 v215, v3, v215
    v_xor_b32 v216, v3, v216
    v_xor_b32 v217, v3, v217
    v_xor_b32 v218, v3, v218
    v_xor_b32 v219, v3, v219
    v_xor_b32 v220, v3, v220
    v_xor_b32 v221, v3, v221
    v_xor_b32 v222, v3, v222
    v_xor_b32 v223, v3, v223
    v_pk_add_f32 v[48:49], v[64:65], v[128:129] neg_lo:[0,1] neg_hi:[0,1]
    v_pk_add_f32 v[64:65], v[64:65], v[128:129]
    v_pk_add_f32 v[50:51], v[66:67], v[130:131] neg_lo:[0,1] neg_hi:[0,1]
    v_pk_add_f32 v[66:67], v[66:67], v[130:131]
    v_pk_add_f32 v[52:53], v[68:69], v[132:133] neg_lo:[0,1] neg_hi:[0,1]
    v_pk_add_f32 v[68:69], v[68:69], v[132:133]
    v_pk_add_f32 v[54:55], v[70:71], v[134:135] neg_lo:[0,1] neg_hi:[0,1]
    v_pk_add_f32 v[70:71], v[70:71], v[134:135]
    v_pk_add_f32 v[48:49], v[48:49], v[208:209]
    v_pk_add_f32 v[64:65], v[64:65], v[216:217]
    v_pk_add_f32 v[50:51], v[50:51], v[210:211]
    v_pk_add_f32 v[66:67], v[66:67], v[218:219]
    v_pk_add_f32 v[52:53], v[52:53], v[212:213]
    v_pk_add_f32 v[68:69], v[68:69], v[220:221]
    v_pk_add_f32 v[54:55], v[54:55], v[214:215]
    v_pk_add_f32 v[70:71], v[70:71], v[222:223]
    v_cvt_pk_bf16_f32 v32, v48, v49
    v_cvt_pk_bf16_f32 v36, v64, v65
    v_cvt_pk_bf16_f32 v33, v50, v51
    v_cvt_pk_bf16_f32 v37, v66, v67
    v_cvt_pk_bf16_f32 v34, v52, v53
    v_cvt_pk_bf16_f32 v38, v68, v69
    v_cvt_pk_bf16_f32 v35, v54, v55
    v_cvt_pk_bf16_f32 v39, v70, v71
    s_nop 1
    v_permlane16_swap_b32 v32, v34
    v_permlane16_swap_b32 v33, v35
    v_permlane16_swap_b32 v36, v38
    v_permlane16_swap_b32 v37, v39
    s_add_u32 s26, s25, 0
    buffer_store_dwordx4 v[32:35], v20, s[12:15], s26 offen sc1
    s_add_u32 s26, s25, 2097152
    buffer_store_dwordx4 v[36:39], v20, s[12:15], s26 offen sc1
    v_pk_add_f32 v[48:49], v[72:73], v[136:137] neg_lo:[0,1] neg_hi:[0,1]
    v_pk_add_f32 v[72:73], v[72:73], v[136:137]
    v_pk_add_f32 v[50:51], v[74:75], v[138:139] neg_lo:[0,1] neg_hi:[0,1]
    v_pk_add_f32 v[74:75], v[74:75], v[138:139]
    v_pk_add_f32 v[52:53], v[76:77], v[140:141] neg_lo:[0,1] neg_hi:[0,1]
    v_pk_add_f32 v[76:77], v[76:77], v[140:141]
    v_pk_add_f32 v[54:55], v[78:79], v[142:143] neg_lo:[0,1] neg_hi:[0,1]
    v_pk_add_f32 v[78:79], v[78:79], v[142:143]
    v_pk_add_f32 v[48:49], v[48:49], v[208:209]
    v_pk_add_f32 v[72:73], v[72:73], v[216:217]
    v_pk_add_f32 v[50:51], v[50:51], v[210:211]
    v_pk_add_f32 v[74:75], v[74:75], v[218:219]
    v_pk_add_f32 v[52:53], v[52:53], v[212:213]
    v_pk_add_f32 v[76:77], v[76:77], v[220:221]
    v_pk_add_f32 v[54:55], v[54:55], v[214:215]
    v_pk_add_f32 v[78:79], v[78:79], v[222:223]
    v_cvt_pk_bf16_f32 v40, v48, v49
    v_cvt_pk_bf16_f32 v44, v72, v73
    v_cvt_pk_bf16_f32 v41, v50, v51
    v_cvt_pk_bf16_f32 v45, v74, v75
    v_cvt_pk_bf16_f32 v42, v52, v53
    v_cvt_pk_bf16_f32 v46, v76, v77
    v_cvt_pk_bf16_f32 v43, v54, v55
    v_cvt_pk_bf16_f32 v47, v78, v79
    s_nop 1
    v_permlane16_swap_b32 v40, v42
    v_permlane16_swap_b32 v41, v43
    v_permlane16_swap_b32 v44, v46
    v_permlane16_swap_b32 v45, v47
    s_add_u32 s26, s25, 1024
    buffer_store_dwordx4 v[40:43], v20, s[12:15], s26 offen sc1
    s_add_u32 s26, s25, 2098176
    buffer_store_dwordx4 v[44:47], v20, s[12:15], s26 offen sc1
    v_pk_add_f32 v[48:49], v[80:81], v[144:145] neg_lo:[0,1] neg_hi:[0,1]
    v_pk_add_f32 v[80:81], v[80:81], v[144:145]
    v_pk_add_f32 v[50:51], v[82:83], v[146:147] neg_lo:[0,1] neg_hi:[0,1]
    v_pk_add_f32 v[82:83], v[82:83], v[146:147]
    v_pk_add_f32 v[52:53], v[84:85], v[148:149] neg_lo:[0,1] neg_hi:[0,1]
    v_pk_add_f32 v[84:85], v[84:85], v[148:149]
    v_pk_add_f32 v[54:55], v[86:87], v[150:151] neg_lo:[0,1] neg_hi:[0,1]
    v_pk_add_f32 v[86:87], v[86:87], v[150:151]
    v_pk_add_f32 v[48:49], v[48:49], v[208:209]
    v_pk_add_f32 v[80:81], v[80:81], v[216:217]
    v_pk_add_f32 v[50:51], v[50:51], v[210:211]
    v_pk_add_f32 v[82:83], v[82:83], v[218:219]
    v_pk_add_f32 v[52:53], v[52:53], v[212:213]
    v_pk_add_f32 v[84:85], v[84:85], v[220:221]
    v_pk_add_f32 v[54:55], v[54:55], v[214:215]
    v_pk_add_f32 v[86:87], v[86:87], v[222:223]
    v_cvt_pk_bf16_f32 v32, v48, v49
    v_cvt_pk_bf16_f32 v36, v80, v81
    v_cvt_pk_bf16_f32 v33, v50, v51
    v_cvt_pk_bf16_f32 v37, v82, v83
    v_cvt_pk_bf16_f32 v34, v52, v53
    v_cvt_pk_bf16_f32 v38, v84, v85
    v_cvt_pk_bf16_f32 v35, v54, v55
    v_cvt_pk_bf16_f32 v39, v86, v87
    s_nop 1
    v_permlane16_swap_b32 v32, v34
    v_permlane16_swap_b32 v33, v35
    v_permlane16_swap_b32 v36, v38
    v_permlane16_swap_b32 v37, v39
    s_add_u32 s26, s25, 2048
    buffer_store_dwordx4 v[32:35], v20, s[12:15], s26 offen sc1
    s_add_u32 s26, s25, 2099200
    buffer_store_dwordx4 v[36:39], v20, s[12:15], s26 offen sc1
    v_pk_add_f32 v[48:49], v[88:89], v[152:153] neg_lo:[0,1] neg_hi:[0,1]
    v_pk_add_f32 v[88:89], v[88:89], v[152:153]
    v_pk_add_f32 v[50:51], v[90:91], v[154:155] neg_lo:[0,1] neg_hi:[0,1]
    v_pk_add_f32 v[90:91], v[90:91], v[154:155]
    v_pk_add_f32 v[52:53], v[92:93], v[156:157] neg_lo:[0,1] neg_hi:[0,1]
    v_pk_add_f32 v[92:93], v[92:93], v[156:157]
    v_pk_add_f32 v[54:55], v[94:95], v[158:159] neg_lo:[0,1] neg_hi:[0,1]
    v_pk_add_f32 v[94:95], v[94:95], v[158:159]
    v_pk_add_f32 v[48:49], v[48:49], v[208:209]
    v_pk_add_f32 v[88:89], v[88:89], v[216:217]
    v_pk_add_f32 v[50:51], v[50:51], v[210:211]
    v_pk_add_f32 v[90:91], v[90:91], v[218:219]
    v_pk_add_f32 v[52:53], v[52:53], v[212:213]
    v_pk_add_f32 v[92:93], v[92:93], v[220:221]
    v_pk_add_f32 v[54:55], v[54:55], v[214:215]
    v_pk_add_f32 v[94:95], v[94:95], v[222:223]
    v_cvt_pk_bf16_f32 v40, v48, v49
    v_cvt_pk_bf16_f32 v44, v88, v89
    v_cvt_pk_bf16_f32 v41, v50, v51
    v_cvt_pk_bf16_f32 v45, v90, v91
    v_cvt_pk_bf16_f32 v42, v52, v53
    v_cvt_pk_bf16_f32 v46, v92, v93
    v_cvt_pk_bf16_f32 v43, v54, v55
    v_cvt_pk_bf16_f32 v47, v94, v95
    s_nop 1
    v_permlane16_swap_b32 v40, v42
    v_permlane16_swap_b32 v41, v43
    v_permlane16_swap_b32 v44, v46
    v_permlane16_swap_b32 v45, v47
    s_add_u32 s26, s25, 3072
    buffer_store_dwordx4 v[40:43], v20, s[12:15], s26 offen sc1
    s_add_u32 s26, s25, 2100224
    buffer_store_dwordx4 v[44:47], v20, s[12:15], s26 offen sc1
    v_pk_add_f32 v[48:49], v[96:97], v[160:161] neg_lo:[0,1] neg_hi:[0,1]
    v_pk_add_f32 v[96:97], v[96:97], v[160:161]
    v_pk_add_f32 v[50:51], v[98:99], v[162:163] neg_lo:[0,1] neg_hi:[0,1]
    v_pk_add_f32 v[98:99], v[98:99], v[162:163]
    v_pk_add_f32 v[52:53], v[100:101], v[164:165] neg_lo:[0,1] neg_hi:[0,1]
    v_pk_add_f32 v[100:101], v[100:101], v[164:165]
    v_pk_add_f32 v[54:55], v[102:103], v[166:167] neg_lo:[0,1] neg_hi:[0,1]
    v_pk_add_f32 v[102:103], v[102:103], v[166:167]
    v_pk_add_f32 v[48:49], v[48:49], v[208:209]
    v_pk_add_f32 v[96:97], v[96:97], v[216:217]
    v_pk_add_f32 v[50:51], v[50:51], v[210:211]
    v_pk_add_f32 v[98:99], v[98:99], v[218:219]
    v_pk_add_f32 v[52:53], v[52:53], v[212:213]
    v_pk_add_f32 v[100:101], v[100:101], v[220:221]
    v_pk_add_f32 v[54:55], v[54:55], v[214:215]
    v_pk_add_f32 v[102:103], v[102:103], v[222:223]
    v_cvt_pk_bf16_f32 v32, v48, v49
    v_cvt_pk_bf16_f32 v36, v96, v97
    v_cvt_pk_bf16_f32 v33, v50, v51
    v_cvt_pk_bf16_f32 v37, v98, v99
    v_cvt_pk_bf16_f32 v34, v52, v53
    v_cvt_pk_bf16_f32 v38, v100, v101
    v_cvt_pk_bf16_f32 v35, v54, v55
    v_cvt_pk_bf16_f32 v39, v102, v103
    s_nop 1
    v_permlane16_swap_b32 v32, v34
    v_permlane16_swap_b32 v33, v35
    v_permlane16_swap_b32 v36, v38
    v_permlane16_swap_b32 v37, v39
    s_add_u32 s26, s25, 4096
    buffer_store_dwordx4 v[32:35], v20, s[12:15], s26 offen sc1
    s_add_u32 s26, s25, 2101248
    buffer_store_dwordx4 v[36:39], v20, s[12:15], s26 offen sc1
    v_pk_add_f32 v[48:49], v[104:105], v[168:169] neg_lo:[0,1] neg_hi:[0,1]
    v_pk_add_f32 v[104:105], v[104:105], v[168:169]
    v_pk_add_f32 v[50:51], v[106:107], v[170:171] neg_lo:[0,1] neg_hi:[0,1]
    v_pk_add_f32 v[106:107], v[106:107], v[170:171]
    v_pk_add_f32 v[52:53], v[108:109], v[172:173] neg_lo:[0,1] neg_hi:[0,1]
    v_pk_add_f32 v[108:109], v[108:109], v[172:173]
    v_pk_add_f32 v[54:55], v[110:111], v[174:175] neg_lo:[0,1] neg_hi:[0,1]
    v_pk_add_f32 v[110:111], v[110:111], v[174:175]
    v_pk_add_f32 v[48:49], v[48:49], v[208:209]
    v_pk_add_f32 v[104:105], v[104:105], v[216:217]
    v_pk_add_f32 v[50:51], v[50:51], v[210:211]
    v_pk_add_f32 v[106:107], v[106:107], v[218:219]
    v_pk_add_f32 v[52:53], v[52:53], v[212:213]
    v_pk_add_f32 v[108:109], v[108:109], v[220:221]
    v_pk_add_f32 v[54:55], v[54:55], v[214:215]
    v_pk_add_f32 v[110:111], v[110:111], v[222:223]
    v_cvt_pk_bf16_f32 v40, v48, v49
    v_cvt_pk_bf16_f32 v44, v104, v105
    v_cvt_pk_bf16_f32 v41, v50, v51
    v_cvt_pk_bf16_f32 v45, v106, v107
    v_cvt_pk_bf16_f32 v42, v52, v53
    v_cvt_pk_bf16_f32 v46, v108, v109
    v_cvt_pk_bf16_f32 v43, v54, v55
    v_cvt_pk_bf16_f32 v47, v110, v111
    s_nop 1
    v_permlane16_swap_b32 v40, v42
    v_permlane16_swap_b32 v41, v43
    v_permlane16_swap_b32 v44, v46
    v_permlane16_swap_b32 v45, v47
    s_add_u32 s26, s25, 5120
    buffer_store_dwordx4 v[40:43], v20, s[12:15], s26 offen sc1
    s_add_u32 s26, s25, 2102272
    buffer_store_dwordx4 v[44:47], v20, s[12:15], s26 offen sc1
    v_pk_add_f32 v[48:49], v[112:113], v[176:177] neg_lo:[0,1] neg_hi:[0,1]
    v_pk_add_f32 v[112:113], v[112:113], v[176:177]
    v_pk_add_f32 v[50:51], v[114:115], v[178:179] neg_lo:[0,1] neg_hi:[0,1]
    v_pk_add_f32 v[114:115], v[114:115], v[178:179]
    v_pk_add_f32 v[52:53], v[116:117], v[180:181] neg_lo:[0,1] neg_hi:[0,1]
    v_pk_add_f32 v[116:117], v[116:117], v[180:181]
    v_pk_add_f32 v[54:55], v[118:119], v[182:183] neg_lo:[0,1] neg_hi:[0,1]
    v_pk_add_f32 v[118:119], v[118:119], v[182:183]
    v_pk_add_f32 v[48:49], v[48:49], v[208:209]
    v_pk_add_f32 v[112:113], v[112:113], v[216:217]
    v_pk_add_f32 v[50:51], v[50:51], v[210:211]
    v_pk_add_f32 v[114:115], v[114:115], v[218:219]
    v_pk_add_f32 v[52:53], v[52:53], v[212:213]
    v_pk_add_f32 v[116:117], v[116:117], v[220:221]
    v_pk_add_f32 v[54:55], v[54:55], v[214:215]
    v_pk_add_f32 v[118:119], v[118:119], v[222:223]
    v_cvt_pk_bf16_f32 v32, v48, v49
    v_cvt_pk_bf16_f32 v36, v112, v113
    v_cvt_pk_bf16_f32 v33, v50, v51
    v_cvt_pk_bf16_f32 v37, v114, v115
    v_cvt_pk_bf16_f32 v34, v52, v53
    v_cvt_pk_bf16_f32 v38, v116, v117
    v_cvt_pk_bf16_f32 v35, v54, v55
    v_cvt_pk_bf16_f32 v39, v118, v119
    s_nop 1
    v_permlane16_swap_b32 v32, v34
    v_permlane16_swap_b32 v33, v35
    v_permlane16_swap_b32 v36, v38
    v_permlane16_swap_b32 v37, v39
    s_add_u32 s26, s25, 6144
    buffer_store_dwordx4 v[32:35], v20, s[12:15], s26 offen sc1
    s_add_u32 s26, s25, 2103296
    buffer_store_dwordx4 v[36:39], v20, s[12:15], s26 offen sc1
    v_pk_add_f32 v[48:49], v[120:121], v[184:185] neg_lo:[0,1] neg_hi:[0,1]
    v_pk_add_f32 v[120:121], v[120:121], v[184:185]
    v_pk_add_f32 v[50:51], v[122:123], v[186:187] neg_lo:[0,1] neg_hi:[0,1]
    v_pk_add_f32 v[122:123], v[122:123], v[186:187]
    v_pk_add_f32 v[52:53], v[124:125], v[188:189] neg_lo:[0,1] neg_hi:[0,1]
    v_pk_add_f32 v[124:125], v[124:125], v[188:189]
    v_pk_add_f32 v[54:55], v[126:127], v[190:191] neg_lo:[0,1] neg_hi:[0,1]
    v_pk_add_f32 v[126:127], v[126:127], v[190:191]
    v_pk_add_f32 v[48:49], v[48:49], v[208:209]
    v_pk_add_f32 v[120:121], v[120:121], v[216:217]
    v_pk_add_f32 v[50:51], v[50:51], v[210:211]
    v_pk_add_f32 v[122:123], v[122:123], v[218:219]
    v_pk_add_f32 v[52:53], v[52:53], v[212:213]
    v_pk_add_f32 v[124:125], v[124:125], v[220:221]
    v_pk_add_f32 v[54:55], v[54:55], v[214:215]
    v_pk_add_f32 v[126:127], v[126:127], v[222:223]
    v_cvt_pk_bf16_f32 v40, v48, v49
    v_cvt_pk_bf16_f32 v44, v120, v121
    v_cvt_pk_bf16_f32 v41, v50, v51
    v_cvt_pk_bf16_f32 v45, v122, v123
    v_cvt_pk_bf16_f32 v42, v52, v53
    v_cvt_pk_bf16_f32 v46, v124, v125
    v_cvt_pk_bf16_f32 v43, v54, v55
    v_cvt_pk_bf16_f32 v47, v126, v127
    s_nop 1
    v_permlane16_swap_b32 v40, v42
    v_permlane16_swap_b32 v41, v43
    v_permlane16_swap_b32 v44, v46
    v_permlane16_swap_b32 v45, v47
    s_add_u32 s26, s25, 7168
    buffer_store_dwordx4 v[40:43], v20, s[12:15], s26 offen sc1
    s_add_u32 s26, s25, 2104320
    buffer_store_dwordx4 v[44:47], v20, s[12:15], s26 offen sc1
    s_cmp_eq_u32 s31, 0
    s_cbranch_scc1 L_dft_nox
    v_pk_add_f32 v[240:241], v[240:241], v[192:193]
    v_pk_add_f32 v[242:243], v[242:243], v[194:195]
    v_pk_add_f32 v[244:245], v[244:245], v[196:197]
    v_pk_add_f32 v[246:247], v[246:247], v[198:199]
    v_cvt_pk_bf16_f32 v56, v240, v241
    v_cvt_pk_bf16_f32 v57, v242, v243
    v_cvt_pk_bf16_f32 v58, v244, v245
    v_cvt_pk_bf16_f32 v59, v246, v247
    s_add_u32 s26, s22, 32768
    s_add_u32 s27, s26, 2097152
    s_mov_b32 exec_lo, 0x00010001
    s_mov_b32 exec_hi, 0x00010001
    buffer_store_dwordx2 v[56:57], v21, s[12:15], s26 offen offset:0 sc1
    buffer_store_dwordx2 v[56:57], v21, s[12:15], s27 offen offset:0 sc1
    buffer_store_dwordx2 v[58:59], v21, s[12:15], s26 offen offset:32 sc1
    buffer_store_dwordx2 v[58:59], v21, s[12:15], s27 offen offset:32 sc1
    s_mov_b64 exec, -1
L_dft_nox:
    s_lshl_b32 s23, s66, 2
    s_add_u32 s23, s23, s67
    s_lshl_b32 s23, s23, 7
    s_add_u32 s23, s23, 26247168
    s_cmp_eq_u32 s3, 0
    s_cselect_b32 s87, s23, 1073741824
    s_mov_b32 s68, 1073741824
    s_mov_b32 s52, s42
    s_and_b32 s53, s43, 0xffff
    s_mov_b32 s54, 4194304
    s_mov_b32 s55, 0x20000
    s_mov_b32 s32, s88
    s_and_b32 s33, s89, 0xffff
    s_mov_b32 s34, 7340032
    s_mov_b32 s35, 0x20000
    s_mul_i32 s27, s96, 1835008
    s_lshl_b32 s26, s51, 8
    s_add_u32 s27, s27, s26
    v_lshrrev_b32 v3, 4, v1
    s_lshl_b32 s26, s3, 4
    v_add_u32 v2, s26, v3
    v_lshlrev_b32 v2, 11, v2
    v_add_u32 v2, s27, v2
    v_lshlrev_b32 v3, 1, v3
    v_and_b32 v100, 15, v1
    v_xor_b32 v3, v3, v100
    v_lshl_add_u32 v100, v3, 4, v2
    v_xor_b32 v3, 8, v3
    v_lshl_add_u32 v101, v3, 4, v2
    v_add_u32 v102, 14336, v100
    v_add_u32 v103, 21504, v101
    v_add_u32 v101, 7168, v101

    s_lshl_b32 s27, s50, 2
    s_add_u32 s27, s27, s3
    s_lshl_b32 s27, s27, 1
    s_mul_i32 s27, s27, 229376
    s_mul_i32 s26, s96, 57344
    s_add_u32 s27, s27, s26
    s_add_u32 s56, s48, s27
    s_addc_u32 s57, s49, 0
    s_and_b32 s57, s57, 0xffff
    s_mov_b32 s58, 286720
    s_mov_b32 s59, 0x20000
    s_mov_b32 s45, 0
    s_lshl_b32 s40, s45, 18
    s_lshr_b32 s79, s96, 1
    s_mul_i32 s79, s79, 229376
    s_cmp_le_u32 s45, 0
    s_mov_b32 s41, 0
    s_cselect_b32 s41, 262144, s41
    s_cmp_le_u32 s45, 1
    s_mov_b32 s42, 262144
    s_cselect_b32 s42, 524288, s42
    s_cmp_le_u32 s45, 2
    s_mov_b32 s43, 524288
    s_cselect_b32 s43, 786432, s43
    s_cmp_le_u32 s45, 3
    s_mov_b32 s76, 786432
    s_cselect_b32 s76, 1048576, s76
    s_cmp_le_u32 s45, 4
    s_mov_b32 s77, 1048576
    s_cselect_b32 s77, 1310720, s77
    s_cmp_le_u32 s45, 5
    s_mov_b32 s78, 1310720
    s_cselect_b32 s78, 1572864, s78
    v_lshlrev_b32 v104, 4, v1
    v_mov_b32 v107, 1073741824
    v_lshrrev_b32 v3, 4, v1
    v_lshrrev_b32 v4, 2, v1
    v_and_b32 v4, 3, v4
    v_lshl_add_u32 v5, v3, 2, v4
    v_and_b32 v6, 7, v5
    s_and_b32 s26, s96, 1
    s_lshl_b32 s26, s26, 2
    v_xor_b32 v6, s26, v6
    v_lshlrev_b32 v5, 8, v5
    v_lshl_add_u32 v5, v6, 5, v5
    v_and_b32 v7, 3, v1
    v_lshl_add_u32 v105, v7, 3, v5
    s_lshl_b32 s26, s50, 1
    s_lshr_b32 s27, s3, 1
    s_add_u32 s26, s26, s27
    s_lshl_b32 s26, s26, 13
    s_mul_i32 s44, s96, 1792
    s_add_u32 s44, s44, s26
    s_add_u32 s44, s44, 26279936
    v_lshlrev_b32 v108, 7, v1
    v_and_b32 v110, 31, v1
    v_lshlrev_b32 v110, 7, v110
    v_add_u32 v110, 26247168, v110
    v_lshrrev_b32 v2, 1, v1
    v_cmp_le_u32 vcc, s45, v2
    v_add_u32 v3, 1, v2
    v_and_b32 v4, 1, v1
    v_cndmask_b32 v2, v2, v3, vcc
    v_cmp_gt_u32 vcc, 12, v1
    v_lshl_add_u32 v2, v2, 1, v4
    v_lshlrev_b32 v2, 7, v2
    v_cndmask_b32 v109, v107, v2, vcc
    s_lshl_b32 s70, s3, 13
    s_add_u32 s70, s70, 26607616
    s_cmp_eq_u32 s2, 0
    s_cselect_b32 s70, s70, 1073741824
    s_cselect_b64 s[60:61], -1, 0
    s_lshl_b32 s26, s2, 2
    s_add_u32 s26, s26, s3
    s_mul_i32 s71, s26, 12288
    s_add_u32 s71, s71, 27262976
    s_lshl_b32 s69, s26, 7
    s_add_u32 s69, s69, 26476544

    v_xor_b32 v120, 0, v105
    v_xor_b32 v121, 32, v105
    v_xor_b32 v122, 64, v105
    v_xor_b32 v123, 96, v105
    v_xor_b32 v124, 128, v105
    v_xor_b32 v125, 160, v105
    v_xor_b32 v126, 192, v105
    v_xor_b32 v127, 224, v105
    s_lshl_b32 s64, s51, 1
    s_and_b32 s26, s96, 1
    s_add_u32 s64, s64, s26
    s_lshl_b32 s26, s50, 8
    s_lshl_b32 s27, s3, 6
    s_add_u32 s27, s26, s27
    s_lshr_b32 s26, s96, 1
    s_lshl_b32 s26, s26, 5
    s_add_u32 s27, s27, s26
    v_and_b32 v2, 15, v1
    v_add_u32 v2, s27, v2
    v_lshlrev_b32 v119, 4, v2
    v_add_u32 v119, 25296896, v119
    v_lshlrev_b32 v2, 11, v2
    v_lshrrev_b32 v3, 4, v1
    v_and_b32 v4, 1, v3
    v_lshl_add_u32 v2, v4, 5, v2
    v_lshrrev_b32 v4, 1, v3
    v_lshl_add_u32 v2, v4, 4, v2
    s_lshl_b32 s26, s64, 7
    v_add_u32 v112, s26, v2
    v_add_u32 v113, 32768, v112
    s_lshl_b32 s26, s64, 1
    s_sub_u32 s65, 30, s26
    s_cmp_ge_u32 s64, 8
    s_cselect_b64 s[46:47], -1, 0
    s_cselect_b32 s65, s65, s26
    s_mul_i32 s65, s65, 33792
    s_add_u32 s65, s65, 21168128
    s_mov_b32 s26, 574464

    v_lshrrev_b32 v2, 2, v1
    v_lshl_add_u32 v2, v2, 1, 0
    v_and_b32 v3, 3, v1
    v_lshlrev_b32 v3, 4, v3
    v_add_u32 v3, 0, v3
    v_add_u32 v2, s27, v2
    v_sub_u32 v4, 2048, v2
    v_min_u32 v4, v4, v2
    v_cmp_lt_u32 vcc, 1024, v2
    v_and_b32 v5, 1, v4
    v_mul_lo_u32 v5, v5, s26
    v_lshrrev_b32 v4, 1, v4
    v_lshl_add_u32 v4, v4, 6, v5
    s_xor_b64 vcc, vcc, s[46:47]
    v_add3_u32 v4, v4, v3, s65
    v_add_u32 v5, 2097152, v4
    v_cndmask_b32 v114, v4, v5, vcc

    v_lshrrev_b32 v2, 2, v1
    v_lshl_add_u32 v2, v2, 1, 1
    v_and_b32 v3, 3, v1
    v_lshlrev_b32 v3, 4, v3
    v_add_u32 v3, 0, v3
    v_add_u32 v2, s27, v2
    v_sub_u32 v4, 2048, v2
    v_min_u32 v4, v4, v2
    v_cmp_lt_u32 vcc, 1024, v2
    v_and_b32 v5, 1, v4
    v_mul_lo_u32 v5, v5, s26
    v_lshrrev_b32 v4, 1, v4
    v_lshl_add_u32 v4, v4, 6, v5
    s_xor_b64 vcc, vcc, s[46:47]
    v_add3_u32 v4, v4, v3, s65
    v_add_u32 v5, 2097152, v4
    v_cndmask_b32 v115, v4, v5, vcc

    v_lshrrev_b32 v2, 2, v1
    v_lshl_add_u32 v2, v2, 1, 0
    v_and_b32 v3, 3, v1
    v_lshlrev_b32 v3, 4, v3
    v_add_u32 v3, 33792, v3
    v_add_u32 v2, s27, v2
    v_sub_u32 v4, 2048, v2
    v_min_u32 v4, v4, v2
    v_cmp_lt_u32 vcc, 1024, v2
    v_and_b32 v5, 1, v4
    v_mul_lo_u32 v5, v5, s26
    v_lshrrev_b32 v4, 1, v4
    v_lshl_add_u32 v4, v4, 6, v5
    s_xor_b64 vcc, vcc, s[46:47]
    v_add3_u32 v4, v4, v3, s65
    v_add_u32 v5, 2097152, v4
    v_cndmask_b32 v116, v4, v5, vcc

    v_lshrrev_b32 v2, 2, v1
    v_lshl_add_u32 v2, v2, 1, 1
    v_and_b32 v3, 3, v1
    v_lshlrev_b32 v3, 4, v3
    v_add_u32 v3, 33792, v3
    v_add_u32 v2, s27, v2
    v_sub_u32 v4, 2048, v2
    v_min_u32 v4, v4, v2
    v_cmp_lt_u32 vcc, 1024, v2
    v_and_b32 v5, 1, v4
    v_mul_lo_u32 v5, v5, s26
    v_lshrrev_b32 v4, 1, v4
    v_lshl_add_u32 v4, v4, 6, v5
    s_xor_b64 vcc, vcc, s[46:47]
    v_add3_u32 v4, v4, v3, s65
    v_add_u32 v5, 2097152, v4
    v_cndmask_b32 v117, v4, v5, vcc

    v_and_b32 v2, 31, v1
    v_mov_b32 v3, 67584
    v_add_u32 v2, s27, v2
    v_sub_u32 v4, 2048, v2
    v_min_u32 v4, v4, v2
    v_cmp_lt_u32 vcc, 1024, v2
    v_and_b32 v5, 1, v4
    v_mul_lo_u32 v5, v5, s26
    v_lshrrev_b32 v4, 1, v4
    v_lshl_add_u32 v4, v4, 6, v5
    s_xor_b64 vcc, vcc, s[46:47]
    v_add3_u32 v4, v4, v3, s65
    v_add_u32 v5, 2097152, v4
    v_cndmask_b32 v118, v4, v5, vcc

    s_waitcnt vmcnt(16)
    s_barrier
    v_cmp_gt_u32 vcc, 2, v1
    v_lshlrev_b32 v6, 7, v1
    v_mov_b32 v7, 1073741824
    v_cndmask_b32 v6, v7, v6, vcc
    s_mov_b32 s27, 0
    buffer_load_dwordx2 v[192:193], v6, s[12:15], s44 offen sc1
    s_sleep 4
    buffer_load_dwordx2 v[194:195], v6, s[12:15], s44 offen sc1
    s_sleep 4
L_poll_6476:
    buffer_load_dwordx2 v[196:197], v6, s[12:15], s44 offen sc1
    s_waitcnt vmcnt(2)
    v_cmp_ne_u32 vcc, s98, v192
    v_cmp_ne_u32 s[28:29], s99, v193
    s_or_b64 vcc, vcc, s[28:29]
    s_and_b64 s[64:65], vcc, 3
    s_cbranch_scc0 L_poll_6476_done
    s_sleep 2
    buffer_load_dwordx2 v[192:193], v6, s[12:15], s44 offen sc1
    s_waitcnt vmcnt(2)
    v_cmp_ne_u32 vcc, s98, v194
    v_cmp_ne_u32 s[28:29], s99, v195
    s_or_b64 vcc, vcc, s[28:29]
    s_and_b64 s[64:65], vcc, 3
    s_cbranch_scc0 L_poll_6476_done
    s_sleep 2
    buffer_load_dwordx2 v[194:195], v6, s[12:15], s44 offen sc1
    s_waitcnt vmcnt(2)
    v_cmp_ne_u32 vcc, s98, v196
    v_cmp_ne_u32 s[28:29], s99, v197
    s_or_b64 vcc, vcc, s[28:29]
    s_and_b64 s[64:65], vcc, 3
    s_cbranch_scc0 L_poll_6476_done
    s_sleep 2
    s_add_u32 s27, s27, 1
    s_cmp_lt_u32 s27, 0x20000
    s_cbranch_scc1 L_poll_6476
L_poll_6476_done:

    s_lshr_b32 s16, s40, 5
    s_sub_u32 s25, s16, s79
    s_add_u32 s16, s16, s79
    s_add_u32 s25, s25, 229376
    buffer_load_dwordx4 v[128:131], v104, s[56:59], s16 offen offset:0 sc1
    buffer_load_dwordx4 v[132:135], v104, s[56:59], s16 offen offset:1024 sc1
    buffer_load_dwordx4 v[136:139], v104, s[56:59], s25 offen offset:0 sc1
    buffer_load_dwordx4 v[140:143], v104, s[56:59], s25 offen offset:1024 sc1
    buffer_load_dwordx4 v[144:147], v104, s[56:59], s16 offen offset:2048 sc1
    buffer_load_dwordx4 v[148:151], v104, s[56:59], s16 offen offset:3072 sc1
    buffer_load_dwordx4 v[152:155], v104, s[56:59], s25 offen offset:2048 sc1
    buffer_load_dwordx4 v[156:159], v104, s[56:59], s25 offen offset:3072 sc1
    s_add_u32 s16, s16, 4096
    s_add_u32 s25, s25, 4096
    buffer_load_dwordx4 v[160:163], v104, s[56:59], s16 offen offset:0 sc1
    buffer_load_dwordx4 v[164:167], v104, s[56:59], s16 offen offset:1024 sc1
    buffer_load_dwordx4 v[168:171], v104, s[56:59], s25 offen offset:0 sc1
    buffer_load_dwordx4 v[172:175], v104, s[56:59], s25 offen offset:1024 sc1
    buffer_load_dwordx4 v[176:179], v104, s[56:59], s16 offen offset:2048 sc1
    buffer_load_dwordx4 v[180:183], v104, s[56:59], s16 offen offset:3072 sc1
    buffer_load_dwordx4 v[184:187], v104, s[56:59], s25 offen offset:2048 sc1
    buffer_load_dwordx4 v[188:191], v104, s[56:59], s25 offen offset:3072 sc1
    s_waitcnt vmcnt(0)
L_g2:
    buffer_load_dwordx2 v[18:19], v108, s[12:15], s70 offen sc1
    ds_read_b64_tr_b16 v[32:33], v120 offset:0
    ds_read_b64_tr_b16 v[34:35], v120 offset:4096
    ds_read_b64_tr_b16 v[36:37], v121 offset:0
    ds_read_b64_tr_b16 v[38:39], v121 offset:4096
    ds_read_b64_tr_b16 v[40:41], v122 offset:0
    ds_read_b64_tr_b16 v[42:43], v122 offset:4096
    ds_read_b64_tr_b16 v[44:45], v123 offset:0
    ds_read_b64_tr_b16 v[46:47], v123 offset:4096
    ds_read_b64_tr_b16 v[48:49], v124 offset:0
    ds_read_b64_tr_b16 v[50:51], v124 offset:4096
    ds_read_b64_tr_b16 v[52:53], v125 offset:0
    ds_read_b64_tr_b16 v[54:55], v125 offset:4096
    ds_read_b64_tr_b16 v[56:57], v126 offset:0
    ds_read_b64_tr_b16 v[58:59], v126 offset:4096
    ds_read_b64_tr_b16 v[60:61], v127 offset:0
    ds_read_b64_tr_b16 v[62:63], v127 offset:4096
    s_lshl_b32 s21, s3, 12
    v_mov_b32 v26, s98
    v_mov_b32 v27, s99
    v_and_b32 v23, 15, v1
    v_lshlrev_b32 v23, 3, v23
    s_waitcnt vmcnt(1)
    buffer_store_dwordx2 v[26:27], v23, s[12:15], s68 offen sc1
    s_waitcnt lgkmcnt(8)
    v_mfma_f32_16x16x32_bf16 a[0:3], v[32:35], v[128:131], a[0:3]
    ds_read_b64_tr_b16 v[64:65], v120 offset:8192
    v_mfma_f32_16x16x32_bf16 a[4:7], v[36:39], v[128:131], a[4:7]
    v_mfma_f32_16x16x32_bf16 a[8:11], v[40:43], v[128:131], a[8:11]
    ds_read_b64_tr_b16 v[66:67], v120 offset:12288
    v_mfma_f32_16x16x32_bf16 a[12:15], v[44:47], v[128:131], a[12:15]
    v_mfma_f32_16x16x32_bf16 a[44:47], v[44:47], v[132:135], a[44:47]
    ds_read_b64_tr_b16 v[68:69], v121 offset:8192
    v_mfma_f32_16x16x32_bf16 a[40:43], v[40:43], v[132:135], a[40:43]
    v_mfma_f32_16x16x32_bf16 a[36:39], v[36:39], v[132:135], a[36:39]
    ds_read_b64_tr_b16 v[70:71], v121 offset:12288
    v_mfma_f32_16x16x32_bf16 a[32:35], v[32:35], v[132:135], a[32:35]
    v_add_u32 v106, 16384, v105
    v_mfma_f32_16x16x32_bf16 a[64:67], v[32:35], v[136:139], a[64:67]
    ds_read_b64_tr_b16 v[72:73], v122 offset:8192
    v_mfma_f32_16x16x32_bf16 a[68:71], v[36:39], v[136:139], a[68:71]
    v_xor_b32 v120, 0, v106
    v_mfma_f32_16x16x32_bf16 a[72:75], v[40:43], v[136:139], a[72:75]
    ds_read_b64_tr_b16 v[74:75], v122 offset:12288
    v_xor_b32 v121, 32, v106
    v_mfma_f32_16x16x32_bf16 a[76:79], v[44:47], v[136:139], a[76:79]
    v_xor_b32 v122, 64, v106
    v_mfma_f32_16x16x32_bf16 a[108:111], v[44:47], v[140:143], a[108:111]
    ds_read_b64_tr_b16 v[76:77], v123 offset:8192
    v_mfma_f32_16x16x32_bf16 a[104:107], v[40:43], v[140:143], a[104:107]
    v_mfma_f32_16x16x32_bf16 a[100:103], v[36:39], v[140:143], a[100:103]
    ds_read_b64_tr_b16 v[78:79], v123 offset:12288
    v_mfma_f32_16x16x32_bf16 a[96:99], v[32:35], v[140:143], a[96:99]
    s_waitcnt lgkmcnt(8)
    v_xor_b32 v123, 96, v106
    v_mfma_f32_16x16x32_bf16 a[112:115], v[48:51], v[140:143], a[112:115]
    ds_read_b64_tr_b16 v[80:81], v124 offset:8192
    v_mfma_f32_16x16x32_bf16 a[116:119], v[52:55], v[140:143], a[116:119]
    v_mfma_f32_16x16x32_bf16 a[120:123], v[56:59], v[140:143], a[120:123]
    ds_read_b64_tr_b16 v[82:83], v124 offset:12288
    v_mfma_f32_16x16x32_bf16 a[124:127], v[60:63], v[140:143], a[124:127]
    v_xor_b32 v124, 128, v106
    v_mfma_f32_16x16x32_bf16 a[92:95], v[60:63], v[136:139], a[92:95]
    ds_read_b64_tr_b16 v[84:85], v125 offset:8192
    v_mfma_f32_16x16x32_bf16 a[88:91], v[56:59], v[136:139], a[88:91]
    v_mfma_f32_16x16x32_bf16 a[84:87], v[52:55], v[136:139], a[84:87]
    ds_read_b64_tr_b16 v[86:87], v125 offset:12288
    v_mfma_f32_16x16x32_bf16 a[80:83], v[48:51], v[136:139], a[80:83]
    v_xor_b32 v125, 160, v106
    v_mfma_f32_16x16x32_bf16 a[48:51], v[48:51], v[132:135], a[48:51]
    ds_read_b64_tr_b16 v[88:89], v126 offset:8192
    v_mfma_f32_16x16x32_bf16 a[52:55], v[52:55], v[132:135], a[52:55]
    v_mfma_f32_16x16x32_bf16 a[56:59], v[56:59], v[132:135], a[56:59]
    ds_read_b64_tr_b16 v[90:91], v126 offset:12288
    v_mfma_f32_16x16x32_bf16 a[60:63], v[60:63], v[132:135], a[60:63]
    v_xor_b32 v126, 192, v106
    v_mfma_f32_16x16x32_bf16 a[28:31], v[60:63], v[128:131], a[28:31]
    ds_read_b64_tr_b16 v[92:93], v127 offset:8192
    v_mfma_f32_16x16x32_bf16 a[24:27], v[56:59], v[128:131], a[24:27]
    v_mfma_f32_16x16x32_bf16 a[20:23], v[52:55], v[128:131], a[20:23]
    ds_read_b64_tr_b16 v[94:95], v127 offset:12288
    v_mfma_f32_16x16x32_bf16 a[16:19], v[48:51], v[128:131], a[16:19]
    v_xor_b32 v127, 224, v106
    s_waitcnt lgkmcnt(8)
    v_mfma_f32_16x16x32_bf16 a[0:3], v[64:67], v[144:147], a[0:3]
    ds_read_b64_tr_b16 v[32:33], v120 offset:0
    v_mfma_f32_16x16x32_bf16 a[4:7], v[68:71], v[144:147], a[4:7]
    v_mfma_f32_16x16x32_bf16 a[8:11], v[72:75], v[144:147], a[8:11]
    ds_read_b64_tr_b16 v[34:35], v120 offset:4096
    v_mfma_f32_16x16x32_bf16 a[12:15], v[76:79], v[144:147], a[12:15]
    v_mfma_f32_16x16x32_bf16 a[44:47], v[76:79], v[148:151], a[44:47]
    ds_read_b64_tr_b16 v[36:37], v121 offset:0
    v_mfma_f32_16x16x32_bf16 a[40:43], v[72:75], v[148:151], a[40:43]
    v_mfma_f32_16x16x32_bf16 a[36:39], v[68:71], v[148:151], a[36:39]
    ds_read_b64_tr_b16 v[38:39], v121 offset:4096
    v_mfma_f32_16x16x32_bf16 a[32:35], v[64:67], v[148:151], a[32:35]
    v_mfma_f32_16x16x32_bf16 a[64:67], v[64:67], v[152:155], a[64:67]
    ds_read_b64_tr_b16 v[40:41], v122 offset:0
    v_mfma_f32_16x16x32_bf16 a[68:71], v[68:71], v[152:155], a[68:71]
    v_mfma_f32_16x16x32_bf16 a[72:75], v[72:75], v[152:155], a[72:75]
    ds_read_b64_tr_b16 v[42:43], v122 offset:4096
    v_mfma_f32_16x16x32_bf16 a[76:79], v[76:79], v[152:155], a[76:79]
    v_mfma_f32_16x16x32_bf16 a[108:111], v[76:79], v[156:159], a[108:111]
    ds_read_b64_tr_b16 v[44:45], v123 offset:0
    v_mfma_f32_16x16x32_bf16 a[104:107], v[72:75], v[156:159], a[104:107]
    v_mfma_f32_16x16x32_bf16 a[100:103], v[68:71], v[156:159], a[100:103]
    ds_read_b64_tr_b16 v[46:47], v123 offset:4096
    v_mfma_f32_16x16x32_bf16 a[96:99], v[64:67], v[156:159], a[96:99]
    s_waitcnt lgkmcnt(8)
    v_mfma_f32_16x16x32_bf16 a[112:115], v[80:83], v[156:159], a[112:115]
    ds_read_b64_tr_b16 v[48:49], v124 offset:0
    s_barrier
    v_mfma_f32_16x16x32_bf16 a[116:119], v[84:87], v[156:159], a[116:119]
    s_add_u32 m0, s21, 98304
    s_add_u32 s17, s43, 0
    v_mfma_f32_16x16x32_bf16 a[120:123], v[88:91], v[156:159], a[120:123]
    ds_read_b64_tr_b16 v[50:51], v124 offset:4096
    v_mfma_f32_16x16x32_bf16 a[124:127], v[92:95], v[156:159], a[124:127]
    v_mfma_f32_16x16x32_bf16 a[92:95], v[92:95], v[152:155], a[92:95]
    ds_read_b64_tr_b16 v[52:53], v125 offset:0
    v_mfma_f32_16x16x32_bf16 a[88:91], v[88:91], v[152:155], a[88:91]
    v_mfma_f32_16x16x32_bf16 a[84:87], v[84:87], v[152:155], a[84:87]
    ds_read_b64_tr_b16 v[54:55], v125 offset:4096
    v_mfma_f32_16x16x32_bf16 a[80:83], v[80:83], v[152:155], a[80:83]
    v_mfma_f32_16x16x32_bf16 a[48:51], v[80:83], v[148:151], a[48:51]
    ds_read_b64_tr_b16 v[56:57], v126 offset:0
    v_mfma_f32_16x16x32_bf16 a[52:55], v[84:87], v[148:151], a[52:55]
    v_mfma_f32_16x16x32_bf16 a[56:59], v[88:91], v[148:151], a[56:59]
    ds_read_b64_tr_b16 v[58:59], v126 offset:4096
    v_mfma_f32_16x16x32_bf16 a[60:63], v[92:95], v[148:151], a[60:63]
    v_mfma_f32_16x16x32_bf16 a[28:31], v[92:95], v[144:147], a[28:31]
    ds_read_b64_tr_b16 v[60:61], v127 offset:0
    v_mfma_f32_16x16x32_bf16 a[24:27], v[88:91], v[144:147], a[24:27]
    v_mfma_f32_16x16x32_bf16 a[20:23], v[84:87], v[144:147], a[20:23]
    ds_read_b64_tr_b16 v[62:63], v127 offset:4096
    v_mfma_f32_16x16x32_bf16 a[16:19], v[80:83], v[144:147], a[16:19]
    buffer_store_dwordx2 v[26:27], v23, s[12:15], s87 offen sc1
    buffer_load_dwordx2 v[24:25], v109, s[12:15], s44 offen sc1
    s_waitcnt lgkmcnt(8)
    v_mfma_f32_16x16x32_bf16 a[0:3], v[32:35], v[160:163], a[0:3]
    ds_read_b64_tr_b16 v[64:65], v120 offset:8192
    v_mfma_f32_16x16x32_bf16 a[4:7], v[36:39], v[160:163], a[4:7]
    v_mfma_f32_16x16x32_bf16 a[8:11], v[40:43], v[160:163], a[8:11]
    ds_read_b64_tr_b16 v[66:67], v120 offset:12288
    v_mfma_f32_16x16x32_bf16 a[12:15], v[44:47], v[160:163], a[12:15]
    v_mfma_f32_16x16x32_bf16 a[44:47], v[44:47], v[164:167], a[44:47]
    ds_read_b64_tr_b16 v[68:69], v121 offset:8192
    v_mfma_f32_16x16x32_bf16 a[40:43], v[40:43], v[164:167], a[40:43]
    buffer_load_dwordx4 v100, s[32:35], s17 offen offset:0 lds
    v_mfma_f32_16x16x32_bf16 a[36:39], v[36:39], v[164:167], a[36:39]
    ds_read_b64_tr_b16 v[70:71], v121 offset:12288
    v_mfma_f32_16x16x32_bf16 a[32:35], v[32:35], v[164:167], a[32:35]
    v_add_u32 v106, 32768, v105
    v_mfma_f32_16x16x32_bf16 a[64:67], v[32:35], v[168:171], a[64:67]
    ds_read_b64_tr_b16 v[72:73], v122 offset:8192
    v_mfma_f32_16x16x32_bf16 a[68:71], v[36:39], v[168:171], a[68:71]
    v_xor_b32 v120, 0, v106
    v_mfma_f32_16x16x32_bf16 a[72:75], v[40:43], v[168:171], a[72:75]
    ds_read_b64_tr_b16 v[74:75], v122 offset:12288
    v_xor_b32 v121, 32, v106
    v_mfma_f32_16x16x32_bf16 a[76:79], v[44:47], v[168:171], a[76:79]
    v_xor_b32 v122, 64, v106
    buffer_load_dwordx4 v101, s[32:35], s17 offen offset:1024 lds
    v_mfma_f32_16x16x32_bf16 a[108:111], v[44:47], v[172:175], a[108:111]
    ds_read_b64_tr_b16 v[76:77], v123 offset:8192
    v_mfma_f32_16x16x32_bf16 a[104:107], v[40:43], v[172:175], a[104:107]
    v_mfma_f32_16x16x32_bf16 a[100:103], v[36:39], v[172:175], a[100:103]
    ds_read_b64_tr_b16 v[78:79], v123 offset:12288
    v_mfma_f32_16x16x32_bf16 a[96:99], v[32:35], v[172:175], a[96:99]
    s_waitcnt lgkmcnt(8)
    v_xor_b32 v123, 96, v106
    v_mfma_f32_16x16x32_bf16 a[112:115], v[48:51], v[172:175], a[112:115]
    ds_read_b64_tr_b16 v[80:81], v124 offset:8192
    v_mfma_f32_16x16x32_bf16 a[116:119], v[52:55], v[172:175], a[116:119]
    v_mfma_f32_16x16x32_bf16 a[120:123], v[56:59], v[172:175], a[120:123]
    ds_read_b64_tr_b16 v[82:83], v124 offset:12288
    v_mfma_f32_16x16x32_bf16 a[124:127], v[60:63], v[172:175], a[124:127]
    v_xor_b32 v124, 128, v106
    v_mfma_f32_16x16x32_bf16 a[92:95], v[60:63], v[168:171], a[92:95]
    ds_read_b64_tr_b16 v[84:85], v125 offset:8192
    v_mfma_f32_16x16x32_bf16 a[88:91], v[56:59], v[168:171], a[88:91]
    v_mfma_f32_16x16x32_bf16 a[84:87], v[52:55], v[168:171], a[84:87]
    ds_read_b64_tr_b16 v[86:87], v125 offset:12288
    v_mfma_f32_16x16x32_bf16 a[80:83], v[48:51], v[168:171], a[80:83]
    v_xor_b32 v125, 160, v106
    v_mfma_f32_16x16x32_bf16 a[48:51], v[48:51], v[164:167], a[48:51]
    ds_read_b64_tr_b16 v[88:89], v126 offset:8192
    v_mfma_f32_16x16x32_bf16 a[52:55], v[52:55], v[164:167], a[52:55]
    v_mfma_f32_16x16x32_bf16 a[56:59], v[56:59], v[164:167], a[56:59]
    ds_read_b64_tr_b16 v[90:91], v126 offset:12288
    v_mfma_f32_16x16x32_bf16 a[60:63], v[60:63], v[164:167], a[60:63]
    v_xor_b32 v126, 192, v106
    v_mfma_f32_16x16x32_bf16 a[28:31], v[60:63], v[160:163], a[28:31]
    ds_read_b64_tr_b16 v[92:93], v127 offset:8192
    v_mfma_f32_16x16x32_bf16 a[24:27], v[56:59], v[160:163], a[24:27]
    v_mfma_f32_16x16x32_bf16 a[20:23], v[52:55], v[160:163], a[20:23]
    ds_read_b64_tr_b16 v[94:95], v127 offset:12288
    v_mfma_f32_16x16x32_bf16 a[16:19], v[48:51], v[160:163], a[16:19]
    v_xor_b32 v127, 224, v106
    s_waitcnt vmcnt(2)
    v_cmp_ne_u32 vcc, s98, v24
    v_cmp_ne_u32 s[28:29], s99, v25
    s_or_b64 vcc, vcc, s[28:29]
    s_and_b64 vcc, vcc, 3
    s_cselect_b32 s31, 1, 0
    s_cselect_b32 s26, 1073741824, 0
    v_add_u32 v111, s26, v104
    s_lshr_b32 s16, s41, 5
    s_sub_u32 s25, s16, s79
    s_add_u32 s16, s16, s79
    s_add_u32 s25, s25, 229376
    buffer_load_dwordx4 v[192:195], v111, s[56:59], s16 offen offset:0 sc1
    buffer_load_dwordx4 v[196:199], v111, s[56:59], s16 offen offset:1024 sc1
    buffer_load_dwordx4 v[200:203], v111, s[56:59], s25 offen offset:0 sc1
    buffer_load_dwordx4 v[204:207], v111, s[56:59], s25 offen offset:1024 sc1
    buffer_load_dwordx4 v[208:211], v111, s[56:59], s16 offen offset:2048 sc1
    buffer_load_dwordx4 v[212:215], v111, s[56:59], s16 offen offset:3072 sc1
    buffer_load_dwordx4 v[216:219], v111, s[56:59], s25 offen offset:2048 sc1
    buffer_load_dwordx4 v[220:223], v111, s[56:59], s25 offen offset:3072 sc1
    s_add_u32 s16, s16, 4096
    s_add_u32 s25, s25, 4096
    buffer_load_dwordx4 v[224:227], v111, s[56:59], s16 offen offset:0 sc1
    buffer_load_dwordx4 v[228:231], v111, s[56:59], s16 offen offset:1024 sc1
    buffer_load_dwordx4 v[232:235], v111, s[56:59], s25 offen offset:0 sc1
    buffer_load_dwordx4 v[236:239], v111, s[56:59], s25 offen offset:1024 sc1
    buffer_load_dwordx4 v[240:243], v111, s[56:59], s16 offen offset:2048 sc1
    buffer_load_dwordx4 v[244:247], v111, s[56:59], s16 offen offset:3072 sc1
    buffer_load_dwordx4 v[248:251], v111, s[56:59], s25 offen offset:2048 sc1
    buffer_load_dwordx4 v[252:255], v111, s[56:59], s25 offen offset:3072 sc1
L_g2_sk1:
    buffer_load_dwordx2 v[24:25], v109, s[12:15], s44 offen sc1
    s_waitcnt lgkmcnt(8)
    v_mfma_f32_16x16x32_bf16 a[0:3], v[64:67], v[176:179], a[0:3]
    ds_read_b64_tr_b16 v[32:33], v120 offset:0
    v_mfma_f32_16x16x32_bf16 a[4:7], v[68:71], v[176:179], a[4:7]
    v_mfma_f32_16x16x32_bf16 a[8:11], v[72:75], v[176:179], a[8:11]
    ds_read_b64_tr_b16 v[34:35], v120 offset:4096
    v_mfma_f32_16x16x32_bf16 a[12:15], v[76:79], v[176:179], a[12:15]
    v_mfma_f32_16x16x32_bf16 a[44:47], v[76:79], v[180:183], a[44:47]
    ds_read_b64_tr_b16 v[36:37], v121 offset:0
    v_mfma_f32_16x16x32_bf16 a[40:43], v[72:75], v[180:183], a[40:43]
    buffer_load_dwordx4 v102, s[32:35], s17 offen offset:2048 lds
    v_mfma_f32_16x16x32_bf16 a[36:39], v[68:71], v[180:183], a[36:39]
    ds_read_b64_tr_b16 v[38:39], v121 offset:4096
    v_mfma_f32_16x16x32_bf16 a[32:35], v[64:67], v[180:183], a[32:35]
    v_mfma_f32_16x16x32_bf16 a[64:67], v[64:67], v[184:187], a[64:67]
    ds_read_b64_tr_b16 v[40:41], v122 offset:0
    v_mfma_f32_16x16x32_bf16 a[68:71], v[68:71], v[184:187], a[68:71]
    v_mfma_f32_16x16x32_bf16 a[72:75], v[72:75], v[184:187], a[72:75]
    ds_read_b64_tr_b16 v[42:43], v122 offset:4096
    v_mfma_f32_16x16x32_bf16 a[76:79], v[76:79], v[184:187], a[76:79]
    buffer_load_dwordx4 v103, s[32:35], s17 offen offset:3072 lds
    v_mfma_f32_16x16x32_bf16 a[108:111], v[76:79], v[188:191], a[108:111]
    ds_read_b64_tr_b16 v[44:45], v123 offset:0
    v_mfma_f32_16x16x32_bf16 a[104:107], v[72:75], v[188:191], a[104:107]
    v_mfma_f32_16x16x32_bf16 a[100:103], v[68:71], v[188:191], a[100:103]
    ds_read_b64_tr_b16 v[46:47], v123 offset:4096
    v_mfma_f32_16x16x32_bf16 a[96:99], v[64:67], v[188:191], a[96:99]
    s_waitcnt lgkmcnt(8)
    v_mfma_f32_16x16x32_bf16 a[112:115], v[80:83], v[188:191], a[112:115]
    ds_read_b64_tr_b16 v[48:49], v124 offset:0
    s_barrier
    v_mfma_f32_16x16x32_bf16 a[116:119], v[84:87], v[188:191], a[116:119]
    s_add_u32 m0, s21, 114688
    s_add_u32 s17, s43, 131072
    v_mfma_f32_16x16x32_bf16 a[120:123], v[88:91], v[188:191], a[120:123]
    ds_read_b64_tr_b16 v[50:51], v124 offset:4096
    v_mfma_f32_16x16x32_bf16 a[124:127], v[92:95], v[188:191], a[124:127]
    v_mfma_f32_16x16x32_bf16 a[92:95], v[92:95], v[184:187], a[92:95]
    ds_read_b64_tr_b16 v[52:53], v125 offset:0
    v_mfma_f32_16x16x32_bf16 a[88:91], v[88:91], v[184:187], a[88:91]
    v_mfma_f32_16x16x32_bf16 a[84:87], v[84:87], v[184:187], a[84:87]
    ds_read_b64_tr_b16 v[54:55], v125 offset:4096
    v_mfma_f32_16x16x32_bf16 a[80:83], v[80:83], v[184:187], a[80:83]
    v_mfma_f32_16x16x32_bf16 a[48:51], v[80:83], v[180:183], a[48:51]
    ds_read_b64_tr_b16 v[56:57], v126 offset:0
    v_mfma_f32_16x16x32_bf16 a[52:55], v[84:87], v[180:183], a[52:55]
    v_mfma_f32_16x16x32_bf16 a[56:59], v[88:91], v[180:183], a[56:59]
    ds_read_b64_tr_b16 v[58:59], v126 offset:4096
    v_mfma_f32_16x16x32_bf16 a[60:63], v[92:95], v[180:183], a[60:63]
    v_mfma_f32_16x16x32_bf16 a[28:31], v[92:95], v[176:179], a[28:31]
    ds_read_b64_tr_b16 v[60:61], v127 offset:0
    v_mfma_f32_16x16x32_bf16 a[24:27], v[88:91], v[176:179], a[24:27]
    v_mfma_f32_16x16x32_bf16 a[20:23], v[84:87], v[176:179], a[20:23]
    ds_read_b64_tr_b16 v[62:63], v127 offset:4096
    v_mfma_f32_16x16x32_bf16 a[16:19], v[80:83], v[176:179], a[16:19]
    s_waitcnt vmcnt(2)
    v_cmp_ne_u32 vcc, s98, v24
    v_cmp_ne_u32 s[28:29], s99, v25
    s_or_b64 vcc, vcc, s[28:29]
    s_and_b64 vcc, vcc, 63
    s_cbranch_scc1 L_g2_late0
    s_cmp_lg_u32 s31, 0
    s_cbranch_scc1 L_g2_redo
L_g2_cont0:
    v_cmp_ne_u32 vcc, s98, v18
    v_cmp_ne_u32 s[28:29], s99, v19
    s_or_b64 vcc, vcc, s[28:29]
    s_and_b64 vcc, vcc, s[60:61]
    s_cbranch_scc1 L_g2_ep
L_g2_cont1:
    buffer_load_dwordx2 v[24:25], v109, s[12:15], s44 offen sc1
    s_waitcnt lgkmcnt(8)
    s_lshr_b32 s22, s42, 5
    s_sub_u32 s24, s22, s79
    s_add_u32 s22, s22, s79
    s_add_u32 s24, s24, 229376
    v_mfma_f32_16x16x32_bf16 a[0:3], v[32:35], v[192:195], a[0:3]
    ds_read_b64_tr_b16 v[64:65], v120 offset:8192
    v_mfma_f32_16x16x32_bf16 a[4:7], v[36:39], v[192:195], a[4:7]
    s_lshr_b32 s16, s43, 5
    s_sub_u32 s25, s16, s79
    buffer_load_dwordx4 v[128:131], v104, s[56:59], s22 offen offset:0 sc1
    v_mfma_f32_16x16x32_bf16 a[8:11], v[40:43], v[192:195], a[8:11]
    ds_read_b64_tr_b16 v[66:67], v120 offset:12288
    v_mfma_f32_16x16x32_bf16 a[12:15], v[44:47], v[192:195], a[12:15]
    s_add_u32 s16, s16, s79
    s_add_u32 s25, s25, 229376
    v_mfma_f32_16x16x32_bf16 a[44:47], v[44:47], v[196:199], a[44:47]
    ds_read_b64_tr_b16 v[68:69], v121 offset:8192
    v_mfma_f32_16x16x32_bf16 a[40:43], v[40:43], v[196:199], a[40:43]
    buffer_load_dwordx4 v100, s[32:35], s17 offen offset:0 lds
    v_mfma_f32_16x16x32_bf16 a[36:39], v[36:39], v[196:199], a[36:39]
    ds_read_b64_tr_b16 v[70:71], v121 offset:12288
    v_mfma_f32_16x16x32_bf16 a[32:35], v[32:35], v[196:199], a[32:35]
    v_add_u32 v106, 49152, v105
    v_mfma_f32_16x16x32_bf16 a[64:67], v[32:35], v[200:203], a[64:67]
    ds_read_b64_tr_b16 v[72:73], v122 offset:8192
    buffer_load_dwordx4 v[132:135], v104, s[56:59], s22 offen offset:1024 sc1
    v_mfma_f32_16x16x32_bf16 a[68:71], v[36:39], v[200:203], a[68:71]
    v_xor_b32 v120, 0, v106
    buffer_load_dwordx4 v[136:139], v104, s[56:59], s24 offen offset:0 sc1
    v_mfma_f32_16x16x32_bf16 a[72:75], v[40:43], v[200:203], a[72:75]
    ds_read_b64_tr_b16 v[74:75], v122 offset:12288
    v_xor_b32 v121, 32, v106
    v_mfma_f32_16x16x32_bf16 a[76:79], v[44:47], v[200:203], a[76:79]
    v_xor_b32 v122, 64, v106
    buffer_load_dwordx4 v101, s[32:35], s17 offen offset:1024 lds
    v_mfma_f32_16x16x32_bf16 a[108:111], v[44:47], v[204:207], a[108:111]
    ds_read_b64_tr_b16 v[76:77], v123 offset:8192
    v_mfma_f32_16x16x32_bf16 a[104:107], v[40:43], v[204:207], a[104:107]
    buffer_load_dwordx4 v[140:143], v104, s[56:59], s24 offen offset:1024 sc1
    v_mfma_f32_16x16x32_bf16 a[100:103], v[36:39], v[204:207], a[100:103]
    ds_read_b64_tr_b16 v[78:79], v123 offset:12288
    v_mfma_f32_16x16x32_bf16 a[96:99], v[32:35], v[204:207], a[96:99]
    s_waitcnt lgkmcnt(8)
    v_xor_b32 v123, 96, v106
    v_mfma_f32_16x16x32_bf16 a[112:115], v[48:51], v[204:207], a[112:115]
    ds_read_b64_tr_b16 v[80:81], v124 offset:8192
    v_mfma_f32_16x16x32_bf16 a[116:119], v[52:55], v[204:207], a[116:119]
    buffer_load_dwordx4 v[144:147], v104, s[56:59], s22 offen offset:2048 sc1
    v_mfma_f32_16x16x32_bf16 a[120:123], v[56:59], v[204:207], a[120:123]
    ds_read_b64_tr_b16 v[82:83], v124 offset:12288
    v_mfma_f32_16x16x32_bf16 a[124:127], v[60:63], v[204:207], a[124:127]
    v_xor_b32 v124, 128, v106
    buffer_load_dwordx4 v[204:207], v104, s[56:59], s25 offen offset:1024 sc1
    v_mfma_f32_16x16x32_bf16 a[92:95], v[60:63], v[200:203], a[92:95]
    ds_read_b64_tr_b16 v[84:85], v125 offset:8192
    v_mfma_f32_16x16x32_bf16 a[88:91], v[56:59], v[200:203], a[88:91]
    buffer_load_dwordx4 v[148:151], v104, s[56:59], s22 offen offset:3072 sc1
    v_mfma_f32_16x16x32_bf16 a[84:87], v[52:55], v[200:203], a[84:87]
    ds_read_b64_tr_b16 v[86:87], v125 offset:12288
    v_mfma_f32_16x16x32_bf16 a[80:83], v[48:51], v[200:203], a[80:83]
    v_xor_b32 v125, 160, v106
    buffer_load_dwordx4 v[200:203], v104, s[56:59], s25 offen offset:0 sc1
    v_mfma_f32_16x16x32_bf16 a[48:51], v[48:51], v[196:199], a[48:51]
    ds_read_b64_tr_b16 v[88:89], v126 offset:8192
    v_mfma_f32_16x16x32_bf16 a[52:55], v[52:55], v[196:199], a[52:55]
    buffer_load_dwordx4 v[152:155], v104, s[56:59], s24 offen offset:2048 sc1
    v_mfma_f32_16x16x32_bf16 a[56:59], v[56:59], v[196:199], a[56:59]
    ds_read_b64_tr_b16 v[90:91], v126 offset:12288
    v_mfma_f32_16x16x32_bf16 a[60:63], v[60:63], v[196:199], a[60:63]
    v_xor_b32 v126, 192, v106
    buffer_load_dwordx4 v[196:199], v104, s[56:59], s16 offen offset:1024 sc1
    v_mfma_f32_16x16x32_bf16 a[28:31], v[60:63], v[192:195], a[28:31]
    ds_read_b64_tr_b16 v[92:93], v127 offset:8192
    v_mfma_f32_16x16x32_bf16 a[24:27], v[56:59], v[192:195], a[24:27]
    buffer_load_dwordx4 v[156:159], v104, s[56:59], s24 offen offset:3072 sc1
    v_mfma_f32_16x16x32_bf16 a[20:23], v[52:55], v[192:195], a[20:23]
    ds_read_b64_tr_b16 v[94:95], v127 offset:12288
    v_mfma_f32_16x16x32_bf16 a[16:19], v[48:51], v[192:195], a[16:19]
    v_xor_b32 v127, 224, v106
    buffer_load_dwordx4 v[192:195], v104, s[56:59], s16 offen offset:0 sc1
    s_waitcnt lgkmcnt(8)
    s_add_u32 s22, s22, 4096
    s_add_u32 s24, s24, 4096
    v_mfma_f32_16x16x32_bf16 a[0:3], v[64:67], v[208:211], a[0:3]
    ds_read_b64_tr_b16 v[32:33], v120 offset:0
    v_mfma_f32_16x16x32_bf16 a[4:7], v[68:71], v[208:211], a[4:7]
    buffer_load_dwordx4 v[160:163], v104, s[56:59], s22 offen offset:0 sc1
    v_mfma_f32_16x16x32_bf16 a[8:11], v[72:75], v[208:211], a[8:11]
    ds_read_b64_tr_b16 v[34:35], v120 offset:4096
    v_mfma_f32_16x16x32_bf16 a[12:15], v[76:79], v[208:211], a[12:15]
    v_mfma_f32_16x16x32_bf16 a[44:47], v[76:79], v[212:215], a[44:47]
    ds_read_b64_tr_b16 v[36:37], v121 offset:0
    v_mfma_f32_16x16x32_bf16 a[40:43], v[72:75], v[212:215], a[40:43]
    buffer_load_dwordx4 v102, s[32:35], s17 offen offset:2048 lds
    v_mfma_f32_16x16x32_bf16 a[36:39], v[68:71], v[212:215], a[36:39]
    ds_read_b64_tr_b16 v[38:39], v121 offset:4096
    v_mfma_f32_16x16x32_bf16 a[32:35], v[64:67], v[212:215], a[32:35]
    v_mfma_f32_16x16x32_bf16 a[64:67], v[64:67], v[216:219], a[64:67]
    ds_read_b64_tr_b16 v[40:41], v122 offset:0
    buffer_load_dwordx4 v[164:167], v104, s[56:59], s22 offen offset:1024 sc1
    v_mfma_f32_16x16x32_bf16 a[68:71], v[68:71], v[216:219], a[68:71]
    buffer_load_dwordx4 v[168:171], v104, s[56:59], s24 offen offset:0 sc1
    v_mfma_f32_16x16x32_bf16 a[72:75], v[72:75], v[216:219], a[72:75]
    ds_read_b64_tr_b16 v[42:43], v122 offset:4096
    v_mfma_f32_16x16x32_bf16 a[76:79], v[76:79], v[216:219], a[76:79]
    buffer_load_dwordx4 v103, s[32:35], s17 offen offset:3072 lds
    v_mfma_f32_16x16x32_bf16 a[108:111], v[76:79], v[220:223], a[108:111]
    ds_read_b64_tr_b16 v[44:45], v123 offset:0
    v_mfma_f32_16x16x32_bf16 a[104:107], v[72:75], v[220:223], a[104:107]
    buffer_load_dwordx4 v[172:175], v104, s[56:59], s24 offen offset:1024 sc1
    v_mfma_f32_16x16x32_bf16 a[100:103], v[68:71], v[220:223], a[100:103]
    ds_read_b64_tr_b16 v[46:47], v123 offset:4096
    v_mfma_f32_16x16x32_bf16 a[96:99], v[64:67], v[220:223], a[96:99]
    s_waitcnt lgkmcnt(8)
    v_mfma_f32_16x16x32_bf16 a[112:115], v[80:83], v[220:223], a[112:115]
    ds_read_b64_tr_b16 v[48:49], v124 offset:0
    s_barrier
    v_mfma_f32_16x16x32_bf16 a[116:119], v[84:87], v[220:223], a[116:119]
    s_add_u32 m0, s21, 0
    s_add_u32 s17, s76, 0
    buffer_load_dwordx4 v[176:179], v104, s[56:59], s22 offen offset:2048 sc1
    v_mfma_f32_16x16x32_bf16 a[120:123], v[88:91], v[220:223], a[120:123]
    ds_read_b64_tr_b16 v[50:51], v124 offset:4096
    v_mfma_f32_16x16x32_bf16 a[124:127], v[92:95], v[220:223], a[124:127]
    buffer_load_dwordx4 v[220:223], v104, s[56:59], s25 offen offset:3072 sc1
    v_mfma_f32_16x16x32_bf16 a[92:95], v[92:95], v[216:219], a[92:95]
    ds_read_b64_tr_b16 v[52:53], v125 offset:0
    v_mfma_f32_16x16x32_bf16 a[88:91], v[88:91], v[216:219], a[88:91]
    buffer_load_dwordx4 v[180:183], v104, s[56:59], s22 offen offset:3072 sc1
    v_mfma_f32_16x16x32_bf16 a[84:87], v[84:87], v[216:219], a[84:87]
    ds_read_b64_tr_b16 v[54:55], v125 offset:4096
    v_mfma_f32_16x16x32_bf16 a[80:83], v[80:83], v[216:219], a[80:83]
    buffer_load_dwordx4 v[216:219], v104, s[56:59], s25 offen offset:2048 sc1
    v_mfma_f32_16x16x32_bf16 a[48:51], v[80:83], v[212:215], a[48:51]
    ds_read_b64_tr_b16 v[56:57], v126 offset:0
    v_mfma_f32_16x16x32_bf16 a[52:55], v[84:87], v[212:215], a[52:55]
    buffer_load_dwordx4 v[184:187], v104, s[56:59], s24 offen offset:2048 sc1
    v_mfma_f32_16x16x32_bf16 a[56:59], v[88:91], v[212:215], a[56:59]
    ds_read_b64_tr_b16 v[58:59], v126 offset:4096
    v_mfma_f32_16x16x32_bf16 a[60:63], v[92:95], v[212:215], a[60:63]
    buffer_load_dwordx4 v[212:215], v104, s[56:59], s16 offen offset:3072 sc1
    v_mfma_f32_16x16x32_bf16 a[28:31], v[92:95], v[208:211], a[28:31]
    ds_read_b64_tr_b16 v[60:61], v127 offset:0
    v_mfma_f32_16x16x32_bf16 a[24:27], v[88:91], v[208:211], a[24:27]
    buffer_load_dwordx4 v[188:191], v104, s[56:59], s24 offen offset:3072 sc1
    v_mfma_f32_16x16x32_bf16 a[20:23], v[84:87], v[208:211], a[20:23]
    ds_read_b64_tr_b16 v[62:63], v127 offset:4096
    v_mfma_f32_16x16x32_bf16 a[16:19], v[80:83], v[208:211], a[16:19]
    buffer_load_dwordx4 v[208:211], v104, s[56:59], s16 offen offset:2048 sc1
    s_add_u32 s16, s16, 4096
    s_add_u32 s25, s25, 4096
    s_waitcnt lgkmcnt(8)
    v_mfma_f32_16x16x32_bf16 a[0:3], v[32:35], v[224:227], a[0:3]
    ds_read_b64_tr_b16 v[64:65], v120 offset:8192
    v_mfma_f32_16x16x32_bf16 a[4:7], v[36:39], v[224:227], a[4:7]
    v_mfma_f32_16x16x32_bf16 a[8:11], v[40:43], v[224:227], a[8:11]
    ds_read_b64_tr_b16 v[66:67], v120 offset:12288
    v_mfma_f32_16x16x32_bf16 a[12:15], v[44:47], v[224:227], a[12:15]
    v_mfma_f32_16x16x32_bf16 a[44:47], v[44:47], v[228:231], a[44:47]
    ds_read_b64_tr_b16 v[68:69], v121 offset:8192
    v_mfma_f32_16x16x32_bf16 a[40:43], v[40:43], v[228:231], a[40:43]
    buffer_load_dwordx4 v100, s[32:35], s17 offen offset:0 lds
    v_mfma_f32_16x16x32_bf16 a[36:39], v[36:39], v[228:231], a[36:39]
    ds_read_b64_tr_b16 v[70:71], v121 offset:12288
    v_mfma_f32_16x16x32_bf16 a[32:35], v[32:35], v[228:231], a[32:35]
    v_add_u32 v106, 65536, v105
    v_mfma_f32_16x16x32_bf16 a[64:67], v[32:35], v[232:235], a[64:67]
    ds_read_b64_tr_b16 v[72:73], v122 offset:8192
    v_mfma_f32_16x16x32_bf16 a[68:71], v[36:39], v[232:235], a[68:71]
    v_xor_b32 v120, 0, v106
    v_mfma_f32_16x16x32_bf16 a[72:75], v[40:43], v[232:235], a[72:75]
    ds_read_b64_tr_b16 v[74:75], v122 offset:12288
    v_xor_b32 v121, 32, v106
    v_mfma_f32_16x16x32_bf16 a[76:79], v[44:47], v[232:235], a[76:79]
    v_xor_b32 v122, 64, v106
    buffer_load_dwordx4 v101, s[32:35], s17 offen offset:1024 lds
    v_mfma_f32_16x16x32_bf16 a[108:111], v[44:47], v[236:239], a[108:111]
    ds_read_b64_tr_b16 v[76:77], v123 offset:8192
    v_mfma_f32_16x16x32_bf16 a[104:107], v[40:43], v[236:239], a[104:107]
    v_mfma_f32_16x16x32_bf16 a[100:103], v[36:39], v[236:239], a[100:103]
    ds_read_b64_tr_b16 v[78:79], v123 offset:12288
    v_mfma_f32_16x16x32_bf16 a[96:99], v[32:35], v[236:239], a[96:99]
    s_waitcnt lgkmcnt(8)
    v_xor_b32 v123, 96, v106
    v_mfma_f32_16x16x32_bf16 a[112:115], v[48:51], v[236:239], a[112:115]
    ds_read_b64_tr_b16 v[80:81], v124 offset:8192
    v_mfma_f32_16x16x32_bf16 a[116:119], v[52:55], v[236:239], a[116:119]
    v_mfma_f32_16x16x32_bf16 a[120:123], v[56:59], v[236:239], a[120:123]
    ds_read_b64_tr_b16 v[82:83], v124 offset:12288
    v_mfma_f32_16x16x32_bf16 a[124:127], v[60:63], v[236:239], a[124:127]
    v_xor_b32 v124, 128, v106
    buffer_load_dwordx4 v[236:239], v104, s[56:59], s25 offen offset:1024 sc1
    v_mfma_f32_16x16x32_bf16 a[92:95], v[60:63], v[232:235], a[92:95]
    ds_read_b64_tr_b16 v[84:85], v125 offset:8192
    v_mfma_f32_16x16x32_bf16 a[88:91], v[56:59], v[232:235], a[88:91]
    v_mfma_f32_16x16x32_bf16 a[84:87], v[52:55], v[232:235], a[84:87]
    ds_read_b64_tr_b16 v[86:87], v125 offset:12288
    v_mfma_f32_16x16x32_bf16 a[80:83], v[48:51], v[232:235], a[80:83]
    v_xor_b32 v125, 160, v106
    buffer_load_dwordx4 v[232:235], v104, s[56:59], s25 offen offset:0 sc1
    v_mfma_f32_16x16x32_bf16 a[48:51], v[48:51], v[228:231], a[48:51]
    ds_read_b64_tr_b16 v[88:89], v126 offset:8192
    v_mfma_f32_16x16x32_bf16 a[52:55], v[52:55], v[228:231], a[52:55]
    v_mfma_f32_16x16x32_bf16 a[56:59], v[56:59], v[228:231], a[56:59]
    ds_read_b64_tr_b16 v[90:91], v126 offset:12288
    v_mfma_f32_16x16x32_bf16 a[60:63], v[60:63], v[228:231], a[60:63]
    v_xor_b32 v126, 192, v106
    buffer_load_dwordx4 v[228:231], v104, s[56:59], s16 offen offset:1024 sc1
    v_mfma_f32_16x16x32_bf16 a[28:31], v[60:63], v[224:227], a[28:31]
    ds_read_b64_tr_b16 v[92:93], v127 offset:8192
    v_mfma_f32_16x16x32_bf16 a[24:27], v[56:59], v[224:227], a[24:27]
    v_mfma_f32_16x16x32_bf16 a[20:23], v[52:55], v[224:227], a[20:23]
    ds_read_b64_tr_b16 v[94:95], v127 offset:12288
    v_mfma_f32_16x16x32_bf16 a[16:19], v[48:51], v[224:227], a[16:19]
    v_xor_b32 v127, 224, v106
    buffer_load_dwordx4 v[224:227], v104, s[56:59], s16 offen offset:0 sc1
    s_waitcnt lgkmcnt(8)
    v_mfma_f32_16x16x32_bf16 a[0:3], v[64:67], v[240:243], a[0:3]
    ds_read_b64_tr_b16 v[32:33], v120 offset:0
    v_mfma_f32_16x16x32_bf16 a[4:7], v[68:71], v[240:243], a[4:7]
    v_mfma_f32_16x16x32_bf16 a[8:11], v[72:75], v[240:243], a[8:11]
    ds_read_b64_tr_b16 v[34:35], v120 offset:4096
    v_mfma_f32_16x16x32_bf16 a[12:15], v[76:79], v[240:243], a[12:15]
    v_mfma_f32_16x16x32_bf16 a[44:47], v[76:79], v[244:247], a[44:47]
    ds_read_b64_tr_b16 v[36:37], v121 offset:0
    v_mfma_f32_16x16x32_bf16 a[40:43], v[72:75], v[244:247], a[40:43]
    buffer_load_dwordx4 v102, s[32:35], s17 offen offset:2048 lds
    v_mfma_f32_16x16x32_bf16 a[36:39], v[68:71], v[244:247], a[36:39]
    ds_read_b64_tr_b16 v[38:39], v121 offset:4096
    v_mfma_f32_16x16x32_bf16 a[32:35], v[64:67], v[244:247], a[32:35]
    v_mfma_f32_16x16x32_bf16 a[64:67], v[64:67], v[248:251], a[64:67]
    ds_read_b64_tr_b16 v[40:41], v122 offset:0
    v_mfma_f32_16x16x32_bf16 a[68:71], v[68:71], v[248:251], a[68:71]
    v_mfma_f32_16x16x32_bf16 a[72:75], v[72:75], v[248:251], a[72:75]
    ds_read_b64_tr_b16 v[42:43], v122 offset:4096
    v_mfma_f32_16x16x32_bf16 a[76:79], v[76:79], v[248:251], a[76:79]
    buffer_load_dwordx4 v103, s[32:35], s17 offen offset:3072 lds
    v_mfma_f32_16x16x32_bf16 a[108:111], v[76:79], v[252:255], a[108:111]
    ds_read_b64_tr_b16 v[44:45], v123 offset:0
    v_mfma_f32_16x16x32_bf16 a[104:107], v[72:75], v[252:255], a[104:107]
    v_mfma_f32_16x16x32_bf16 a[100:103], v[68:71], v[252:255], a[100:103]
    ds_read_b64_tr_b16 v[46:47], v123 offset:4096
    v_mfma_f32_16x16x32_bf16 a[96:99], v[64:67], v[252:255], a[96:99]
    s_waitcnt lgkmcnt(8)
    v_mfma_f32_16x16x32_bf16 a[112:115], v[80:83], v[252:255], a[112:115]
    ds_read_b64_tr_b16 v[48:49], v124 offset:0
    s_barrier
    v_mfma_f32_16x16x32_bf16 a[116:119], v[84:87], v[252:255], a[116:119]
    s_add_u32 m0, s21, 16384
    s_add_u32 s17, s76, 131072
    v_mfma_f32_16x16x32_bf16 a[120:123], v[88:91], v[252:255], a[120:123]
    ds_read_b64_tr_b16 v[50:51], v124 offset:4096
    v_mfma_f32_16x16x32_bf16 a[124:127], v[92:95], v[252:255], a[124:127]
    buffer_load_dwordx4 v[252:255], v104, s[56:59], s25 offen offset:3072 sc1
    v_mfma_f32_16x16x32_bf16 a[92:95], v[92:95], v[248:251], a[92:95]
    ds_read_b64_tr_b16 v[52:53], v125 offset:0
    v_mfma_f32_16x16x32_bf16 a[88:91], v[88:91], v[248:251], a[88:91]
    v_mfma_f32_16x16x32_bf16 a[84:87], v[84:87], v[248:251], a[84:87]
    ds_read_b64_tr_b16 v[54:55], v125 offset:4096
    v_mfma_f32_16x16x32_bf16 a[80:83], v[80:83], v[248:251], a[80:83]
    buffer_load_dwordx4 v[248:251], v104, s[56:59], s25 offen offset:2048 sc1
    v_mfma_f32_16x16x32_bf16 a[48:51], v[80:83], v[244:247], a[48:51]
    ds_read_b64_tr_b16 v[56:57], v126 offset:0
    v_mfma_f32_16x16x32_bf16 a[52:55], v[84:87], v[244:247], a[52:55]
    v_mfma_f32_16x16x32_bf16 a[56:59], v[88:91], v[244:247], a[56:59]
    ds_read_b64_tr_b16 v[58:59], v126 offset:4096
    v_mfma_f32_16x16x32_bf16 a[60:63], v[92:95], v[244:247], a[60:63]
    buffer_load_dwordx4 v[244:247], v104, s[56:59], s16 offen offset:3072 sc1
    v_mfma_f32_16x16x32_bf16 a[28:31], v[92:95], v[240:243], a[28:31]
    ds_read_b64_tr_b16 v[60:61], v127 offset:0
    v_mfma_f32_16x16x32_bf16 a[24:27], v[88:91], v[240:243], a[24:27]
    v_mfma_f32_16x16x32_bf16 a[20:23], v[84:87], v[240:243], a[20:23]
    ds_read_b64_tr_b16 v[62:63], v127 offset:4096
    v_mfma_f32_16x16x32_bf16 a[16:19], v[80:83], v[240:243], a[16:19]
    buffer_load_dwordx4 v[240:243], v104, s[56:59], s16 offen offset:2048 sc1
    s_waitcnt vmcnt(40)
    v_cmp_ne_u32 vcc, s98, v24
    v_cmp_ne_u32 s[28:29], s99, v25
    s_or_b64 vcc, vcc, s[28:29]
    s_and_b64 vcc, vcc, 192
    s_cbranch_scc1 L_g2_late2
L_g2_cont2x:
    buffer_load_dwordx2 v[24:25], v109, s[12:15], s44 offen sc1
    s_or_b32 s26, s2, s3
    s_cmp_eq_u32 s26, 0
    s_mov_b32 s68, 1073741824
    s_cselect_b32 s68, 26214400, s68
    buffer_store_dwordx2 v[26:27], v23, s[12:15], s68 offen sc1
    s_waitcnt vmcnt(36) lgkmcnt(8)
    v_mfma_f32_16x16x32_bf16 a[0:3], v[32:35], v[128:131], a[0:3]
    ds_read_b64_tr_b16 v[64:65], v120 offset:8192
    v_mfma_f32_16x16x32_bf16 a[4:7], v[36:39], v[128:131], a[4:7]
    s_lshr_b32 s16, s76, 5
    s_sub_u32 s25, s16, s79
    v_mfma_f32_16x16x32_bf16 a[8:11], v[40:43], v[128:131], a[8:11]
    ds_read_b64_tr_b16 v[66:67], v120 offset:12288
    v_mfma_f32_16x16x32_bf16 a[12:15], v[44:47], v[128:131], a[12:15]
    s_add_u32 s16, s16, s79
    s_add_u32 s25, s25, 229376
    v_mfma_f32_16x16x32_bf16 a[44:47], v[44:47], v[132:135], a[44:47]
    ds_read_b64_tr_b16 v[68:69], v121 offset:8192
    v_mfma_f32_16x16x32_bf16 a[40:43], v[40:43], v[132:135], a[40:43]
    buffer_load_dwordx4 v100, s[32:35], s17 offen offset:0 lds
    v_mfma_f32_16x16x32_bf16 a[36:39], v[36:39], v[132:135], a[36:39]
    ds_read_b64_tr_b16 v[70:71], v121 offset:12288
    v_mfma_f32_16x16x32_bf16 a[32:35], v[32:35], v[132:135], a[32:35]
    v_add_u32 v106, 81920, v105
    v_mfma_f32_16x16x32_bf16 a[64:67], v[32:35], v[136:139], a[64:67]
    ds_read_b64_tr_b16 v[72:73], v122 offset:8192
    v_mfma_f32_16x16x32_bf16 a[68:71], v[36:39], v[136:139], a[68:71]
    v_xor_b32 v120, 0, v106
    v_mfma_f32_16x16x32_bf16 a[72:75], v[40:43], v[136:139], a[72:75]
    ds_read_b64_tr_b16 v[74:75], v122 offset:12288
    v_xor_b32 v121, 32, v106
    v_mfma_f32_16x16x32_bf16 a[76:79], v[44:47], v[136:139], a[76:79]
    v_xor_b32 v122, 64, v106
    buffer_load_dwordx4 v101, s[32:35], s17 offen offset:1024 lds
    v_mfma_f32_16x16x32_bf16 a[108:111], v[44:47], v[140:143], a[108:111]
    ds_read_b64_tr_b16 v[76:77], v123 offset:8192
    v_mfma_f32_16x16x32_bf16 a[104:107], v[40:43], v[140:143], a[104:107]
    v_mfma_f32_16x16x32_bf16 a[100:103], v[36:39], v[140:143], a[100:103]
    ds_read_b64_tr_b16 v[78:79], v123 offset:12288
    v_mfma_f32_16x16x32_bf16 a[96:99], v[32:35], v[140:143], a[96:99]
    s_waitcnt lgkmcnt(8)
    v_xor_b32 v123, 96, v106
    v_mfma_f32_16x16x32_bf16 a[112:115], v[48:51], v[140:143], a[112:115]
    ds_read_b64_tr_b16 v[80:81], v124 offset:8192
    v_mfma_f32_16x16x32_bf16 a[116:119], v[52:55], v[140:143], a[116:119]
    v_mfma_f32_16x16x32_bf16 a[120:123], v[56:59], v[140:143], a[120:123]
    ds_read_b64_tr_b16 v[82:83], v124 offset:12288
    v_mfma_f32_16x16x32_bf16 a[124:127], v[60:63], v[140:143], a[124:127]
    v_xor_b32 v124, 128, v106
    buffer_load_dwordx4 v[140:143], v104, s[56:59], s25 offen offset:1024 sc1
    v_mfma_f32_16x16x32_bf16 a[92:95], v[60:63], v[136:139], a[92:95]
    ds_read_b64_tr_b16 v[84:85], v125 offset:8192
    v_mfma_f32_16x16x32_bf16 a[88:91], v[56:59], v[136:139], a[88:91]
    v_mfma_f32_16x16x32_bf16 a[84:87], v[52:55], v[136:139], a[84:87]
    ds_read_b64_tr_b16 v[86:87], v125 offset:12288
    v_mfma_f32_16x16x32_bf16 a[80:83], v[48:51], v[136:139], a[80:83]
    v_xor_b32 v125, 160, v106
    buffer_load_dwordx4 v[136:139], v104, s[56:59], s25 offen offset:0 sc1
    v_mfma_f32_16x16x32_bf16 a[48:51], v[48:51], v[132:135], a[48:51]
    ds_read_b64_tr_b16 v[88:89], v126 offset:8192
    v_mfma_f32_16x16x32_bf16 a[52:55], v[52:55], v[132:135], a[52:55]
    v_mfma_f32_16x16x32_bf16 a[56:59], v[56:59], v[132:135], a[56:59]
    ds_read_b64_tr_b16 v[90:91], v126 offset:12288
    v_mfma_f32_16x16x32_bf16 a[60:63], v[60:63], v[132:135], a[60:63]
    v_xor_b32 v126, 192, v106
    buffer_load_dwordx4 v[132:135], v104, s[56:59], s16 offen offset:1024 sc1
    v_mfma_f32_16x16x32_bf16 a[28:31], v[60:63], v[128:131], a[28:31]
    ds_read_b64_tr_b16 v[92:93], v127 offset:8192
    v_mfma_f32_16x16x32_bf16 a[24:27], v[56:59], v[128:131], a[24:27]
    v_mfma_f32_16x16x32_bf16 a[20:23], v[52:55], v[128:131], a[20:23]
    ds_read_b64_tr_b16 v[94:95], v127 offset:12288
    v_mfma_f32_16x16x32_bf16 a[16:19], v[48:51], v[128:131], a[16:19]
    v_xor_b32 v127, 224, v106
    buffer_load_dwordx4 v[128:131], v104, s[56:59], s16 offen offset:0 sc1
    s_waitcnt vmcnt(35) lgkmcnt(8)
    v_mfma_f32_16x16x32_bf16 a[0:3], v[64:67], v[144:147], a[0:3]
    ds_read_b64_tr_b16 v[32:33], v120 offset:0
    v_mfma_f32_16x16x32_bf16 a[4:7], v[68:71], v[144:147], a[4:7]
    v_mfma_f32_16x16x32_bf16 a[8:11], v[72:75], v[144:147], a[8:11]
    ds_read_b64_tr_b16 v[34:35], v120 offset:4096
    v_mfma_f32_16x16x32_bf16 a[12:15], v[76:79], v[144:147], a[12:15]
    v_mfma_f32_16x16x32_bf16 a[44:47], v[76:79], v[148:151], a[44:47]
    ds_read_b64_tr_b16 v[36:37], v121 offset:0
    v_mfma_f32_16x16x32_bf16 a[40:43], v[72:75], v[148:151], a[40:43]
    buffer_load_dwordx4 v102, s[32:35], s17 offen offset:2048 lds
    v_mfma_f32_16x16x32_bf16 a[36:39], v[68:71], v[148:151], a[36:39]
    ds_read_b64_tr_b16 v[38:39], v121 offset:4096
    v_mfma_f32_16x16x32_bf16 a[32:35], v[64:67], v[148:151], a[32:35]
    v_mfma_f32_16x16x32_bf16 a[64:67], v[64:67], v[152:155], a[64:67]
    ds_read_b64_tr_b16 v[40:41], v122 offset:0
    v_mfma_f32_16x16x32_bf16 a[68:71], v[68:71], v[152:155], a[68:71]
    v_mfma_f32_16x16x32_bf16 a[72:75], v[72:75], v[152:155], a[72:75]
    ds_read_b64_tr_b16 v[42:43], v122 offset:4096
    v_mfma_f32_16x16x32_bf16 a[76:79], v[76:79], v[152:155], a[76:79]
    buffer_load_dwordx4 v103, s[32:35], s17 offen offset:3072 lds
    v_mfma_f32_16x16x32_bf16 a[108:111], v[76:79], v[156:159], a[108:111]
    ds_read_b64_tr_b16 v[44:45], v123 offset:0
    v_mfma_f32_16x16x32_bf16 a[104:107], v[72:75], v[156:159], a[104:107]
    v_mfma_f32_16x16x32_bf16 a[100:103], v[68:71], v[156:159], a[100:103]
    ds_read_b64_tr_b16 v[46:47], v123 offset:4096
    v_mfma_f32_16x16x32_bf16 a[96:99], v[64:67], v[156:159], a[96:99]
    s_waitcnt lgkmcnt(8)
    v_mfma_f32_16x16x32_bf16 a[112:115], v[80:83], v[156:159], a[112:115]
    ds_read_b64_tr_b16 v[48:49], v124 offset:0
    s_waitcnt vmcnt(51)
    s_barrier
    v_mfma_f32_16x16x32_bf16 a[116:119], v[84:87], v[156:159], a[116:119]
    s_add_u32 m0, s21, 32768
    s_add_u32 s17, s77, 0
    v_mfma_f32_16x16x32_bf16 a[120:123], v[88:91], v[156:159], a[120:123]
    ds_read_b64_tr_b16 v[50:51], v124 offset:4096
    v_mfma_f32_16x16x32_bf16 a[124:127], v[92:95], v[156:159], a[124:127]
    buffer_load_dwordx4 v[156:159], v104, s[56:59], s25 offen offset:3072 sc1
    v_mfma_f32_16x16x32_bf16 a[92:95], v[92:95], v[152:155], a[92:95]
    ds_read_b64_tr_b16 v[52:53], v125 offset:0
    v_mfma_f32_16x16x32_bf16 a[88:91], v[88:91], v[152:155], a[88:91]
    v_mfma_f32_16x16x32_bf16 a[84:87], v[84:87], v[152:155], a[84:87]
    ds_read_b64_tr_b16 v[54:55], v125 offset:4096
    v_mfma_f32_16x16x32_bf16 a[80:83], v[80:83], v[152:155], a[80:83]
    buffer_load_dwordx4 v[152:155], v104, s[56:59], s25 offen offset:2048 sc1
    v_mfma_f32_16x16x32_bf16 a[48:51], v[80:83], v[148:151], a[48:51]
    ds_read_b64_tr_b16 v[56:57], v126 offset:0
    v_mfma_f32_16x16x32_bf16 a[52:55], v[84:87], v[148:151], a[52:55]
    v_mfma_f32_16x16x32_bf16 a[56:59], v[88:91], v[148:151], a[56:59]
    ds_read_b64_tr_b16 v[58:59], v126 offset:4096
    v_mfma_f32_16x16x32_bf16 a[60:63], v[92:95], v[148:151], a[60:63]
    buffer_load_dwordx4 v[148:151], v104, s[56:59], s16 offen offset:3072 sc1
    v_mfma_f32_16x16x32_bf16 a[28:31], v[92:95], v[144:147], a[28:31]
    ds_read_b64_tr_b16 v[60:61], v127 offset:0
    v_mfma_f32_16x16x32_bf16 a[24:27], v[88:91], v[144:147], a[24:27]
    v_mfma_f32_16x16x32_bf16 a[20:23], v[84:87], v[144:147], a[20:23]
    ds_read_b64_tr_b16 v[62:63], v127 offset:4096
    v_mfma_f32_16x16x32_bf16 a[16:19], v[80:83], v[144:147], a[16:19]
    buffer_load_dwordx4 v[144:147], v104, s[56:59], s16 offen offset:2048 sc1
    s_add_u32 s16, s16, 4096
    s_add_u32 s25, s25, 4096
    s_waitcnt vmcnt(34) lgkmcnt(8)
    v_mfma_f32_16x16x32_bf16 a[0:3], v[32:35], v[160:163], a[0:3]
    ds_read_b64_tr_b16 v[64:65], v120 offset:8192
    v_mfma_f32_16x16x32_bf16 a[4:7], v[36:39], v[160:163], a[4:7]
    v_mfma_f32_16x16x32_bf16 a[8:11], v[40:43], v[160:163], a[8:11]
    ds_read_b64_tr_b16 v[66:67], v120 offset:12288
    v_mfma_f32_16x16x32_bf16 a[12:15], v[44:47], v[160:163], a[12:15]
    v_mfma_f32_16x16x32_bf16 a[44:47], v[44:47], v[164:167], a[44:47]
    ds_read_b64_tr_b16 v[68:69], v121 offset:8192
    v_mfma_f32_16x16x32_bf16 a[40:43], v[40:43], v[164:167], a[40:43]
    buffer_load_dwordx4 v100, s[32:35], s17 offen offset:0 lds
    v_mfma_f32_16x16x32_bf16 a[36:39], v[36:39], v[164:167], a[36:39]
    ds_read_b64_tr_b16 v[70:71], v121 offset:12288
    v_mfma_f32_16x16x32_bf16 a[32:35], v[32:35], v[164:167], a[32:35]
    v_add_u32 v106, 98304, v105
    v_mfma_f32_16x16x32_bf16 a[64:67], v[32:35], v[168:171], a[64:67]
    ds_read_b64_tr_b16 v[72:73], v122 offset:8192
    v_mfma_f32_16x16x32_bf16 a[68:71], v[36:39], v[168:171], a[68:71]
    v_xor_b32 v120, 0, v106
    v_mfma_f32_16x16x32_bf16 a[72:75], v[40:43], v[168:171], a[72:75]
    ds_read_b64_tr_b16 v[74:75], v122 offset:12288
    v_xor_b32 v121, 32, v106
    v_mfma_f32_16x16x32_bf16 a[76:79], v[44:47], v[168:171], a[76:79]
    v_xor_b32 v122, 64, v106
    buffer_load_dwordx4 v101, s[32:35], s17 offen offset:1024 lds
    v_mfma_f32_16x16x32_bf16 a[108:111], v[44:47], v[172:175], a[108:111]
    ds_read_b64_tr_b16 v[76:77], v123 offset:8192
    v_mfma_f32_16x16x32_bf16 a[104:107], v[40:43], v[172:175], a[104:107]
    v_mfma_f32_16x16x32_bf16 a[100:103], v[36:39], v[172:175], a[100:103]
    ds_read_b64_tr_b16 v[78:79], v123 offset:12288
    v_mfma_f32_16x16x32_bf16 a[96:99], v[32:35], v[172:175], a[96:99]
    s_waitcnt lgkmcnt(8)
    v_xor_b32 v123, 96, v106
    v_mfma_f32_16x16x32_bf16 a[112:115], v[48:51], v[172:175], a[112:115]
    ds_read_b64_tr_b16 v[80:81], v124 offset:8192
    v_mfma_f32_16x16x32_bf16 a[116:119], v[52:55], v[172:175], a[116:119]
    v_mfma_f32_16x16x32_bf16 a[120:123], v[56:59], v[172:175], a[120:123]
    ds_read_b64_tr_b16 v[82:83], v124 offset:12288
    v_mfma_f32_16x16x32_bf16 a[124:127], v[60:63], v[172:175], a[124:127]
    v_xor_b32 v124, 128, v106
    buffer_load_dwordx4 v[172:175], v104, s[56:59], s25 offen offset:1024 sc1
    v_mfma_f32_16x16x32_bf16 a[92:95], v[60:63], v[168:171], a[92:95]
    ds_read_b64_tr_b16 v[84:85], v125 offset:8192
    v_mfma_f32_16x16x32_bf16 a[88:91], v[56:59], v[168:171], a[88:91]
    v_mfma_f32_16x16x32_bf16 a[84:87], v[52:55], v[168:171], a[84:87]
    ds_read_b64_tr_b16 v[86:87], v125 offset:12288
    v_mfma_f32_16x16x32_bf16 a[80:83], v[48:51], v[168:171], a[80:83]
    v_xor_b32 v125, 160, v106
    buffer_load_dwordx4 v[168:171], v104, s[56:59], s25 offen offset:0 sc1
    v_mfma_f32_16x16x32_bf16 a[48:51], v[48:51], v[164:167], a[48:51]
    ds_read_b64_tr_b16 v[88:89], v126 offset:8192
    v_mfma_f32_16x16x32_bf16 a[52:55], v[52:55], v[164:167], a[52:55]
    v_mfma_f32_16x16x32_bf16 a[56:59], v[56:59], v[164:167], a[56:59]
    ds_read_b64_tr_b16 v[90:91], v126 offset:12288
    v_mfma_f32_16x16x32_bf16 a[60:63], v[60:63], v[164:167], a[60:63]
    v_xor_b32 v126, 192, v106
    buffer_load_dwordx4 v[164:167], v104, s[56:59], s16 offen offset:1024 sc1
    v_mfma_f32_16x16x32_bf16 a[28:31], v[60:63], v[160:163], a[28:31]
    ds_read_b64_tr_b16 v[92:93], v127 offset:8192
    v_mfma_f32_16x16x32_bf16 a[24:27], v[56:59], v[160:163], a[24:27]
    v_mfma_f32_16x16x32_bf16 a[20:23], v[52:55], v[160:163], a[20:23]
    ds_read_b64_tr_b16 v[94:95], v127 offset:12288
    v_mfma_f32_16x16x32_bf16 a[16:19], v[48:51], v[160:163], a[16:19]
    v_xor_b32 v127, 224, v106
    buffer_load_dwordx4 v[160:163], v104, s[56:59], s16 offen offset:0 sc1
    s_waitcnt vmcnt(33) lgkmcnt(8)
    v_mfma_f32_16x16x32_bf16 a[0:3], v[64:67], v[176:179], a[0:3]
    ds_read_b64_tr_b16 v[32:33], v120 offset:0
    v_mfma_f32_16x16x32_bf16 a[4:7], v[68:71], v[176:179], a[4:7]
    v_mfma_f32_16x16x32_bf16 a[8:11], v[72:75], v[176:179], a[8:11]
    ds_read_b64_tr_b16 v[34:35], v120 offset:4096
    v_mfma_f32_16x16x32_bf16 a[12:15], v[76:79], v[176:179], a[12:15]
    v_mfma_f32_16x16x32_bf16 a[44:47], v[76:79], v[180:183], a[44:47]
    ds_read_b64_tr_b16 v[36:37], v121 offset:0
    v_mfma_f32_16x16x32_bf16 a[40:43], v[72:75], v[180:183], a[40:43]
    buffer_load_dwordx4 v102, s[32:35], s17 offen offset:2048 lds
    v_mfma_f32_16x16x32_bf16 a[36:39], v[68:71], v[180:183], a[36:39]
    ds_read_b64_tr_b16 v[38:39], v121 offset:4096
    v_mfma_f32_16x16x32_bf16 a[32:35], v[64:67], v[180:183], a[32:35]
    v_mfma_f32_16x16x32_bf16 a[64:67], v[64:67], v[184:187], a[64:67]
    ds_read_b64_tr_b16 v[40:41], v122 offset:0
    v_mfma_f32_16x16x32_bf16 a[68:71], v[68:71], v[184:187], a[68:71]
    v_mfma_f32_16x16x32_bf16 a[72:75], v[72:75], v[184:187], a[72:75]
    ds_read_b64_tr_b16 v[42:43], v122 offset:4096
    v_mfma_f32_16x16x32_bf16 a[76:79], v[76:79], v[184:187], a[76:79]
    buffer_load_dwordx4 v103, s[32:35], s17 offen offset:3072 lds
    v_mfma_f32_16x16x32_bf16 a[108:111], v[76:79], v[188:191], a[108:111]
    ds_read_b64_tr_b16 v[44:45], v123 offset:0
    v_mfma_f32_16x16x32_bf16 a[104:107], v[72:75], v[188:191], a[104:107]
    v_mfma_f32_16x16x32_bf16 a[100:103], v[68:71], v[188:191], a[100:103]
    ds_read_b64_tr_b16 v[46:47], v123 offset:4096
    v_mfma_f32_16x16x32_bf16 a[96:99], v[64:67], v[188:191], a[96:99]
    s_waitcnt lgkmcnt(8)
    v_mfma_f32_16x16x32_bf16 a[112:115], v[80:83], v[188:191], a[112:115]
    ds_read_b64_tr_b16 v[48:49], v124 offset:0
    s_waitcnt vmcnt(43)
    s_barrier
    v_mfma_f32_16x16x32_bf16 a[116:119], v[84:87], v[188:191], a[116:119]
    s_add_u32 m0, s21, 49152
    s_add_u32 s17, s77, 131072
    v_mfma_f32_16x16x32_bf16 a[120:123], v[88:91], v[188:191], a[120:123]
    ds_read_b64_tr_b16 v[50:51], v124 offset:4096
    v_mfma_f32_16x16x32_bf16 a[124:127], v[92:95], v[188:191], a[124:127]
    buffer_load_dwordx4 v[188:191], v104, s[56:59], s25 offen offset:3072 sc1
    v_mfma_f32_16x16x32_bf16 a[92:95], v[92:95], v[184:187], a[92:95]
    ds_read_b64_tr_b16 v[52:53], v125 offset:0
    v_mfma_f32_16x16x32_bf16 a[88:91], v[88:91], v[184:187], a[88:91]
    v_mfma_f32_16x16x32_bf16 a[84:87], v[84:87], v[184:187], a[84:87]
    ds_read_b64_tr_b16 v[54:55], v125 offset:4096
    v_mfma_f32_16x16x32_bf16 a[80:83], v[80:83], v[184:187], a[80:83]
    buffer_load_dwordx4 v[184:187], v104, s[56:59], s25 offen offset:2048 sc1
    v_mfma_f32_16x16x32_bf16 a[48:51], v[80:83], v[180:183], a[48:51]
    ds_read_b64_tr_b16 v[56:57], v126 offset:0
    v_mfma_f32_16x16x32_bf16 a[52:55], v[84:87], v[180:183], a[52:55]
    v_mfma_f32_16x16x32_bf16 a[56:59], v[88:91], v[180:183], a[56:59]
    ds_read_b64_tr_b16 v[58:59], v126 offset:4096
    v_mfma_f32_16x16x32_bf16 a[60:63], v[92:95], v[180:183], a[60:63]
    buffer_load_dwordx4 v[180:183], v104, s[56:59], s16 offen offset:3072 sc1
    v_mfma_f32_16x16x32_bf16 a[28:31], v[92:95], v[176:179], a[28:31]
    ds_read_b64_tr_b16 v[60:61], v127 offset:0
    v_mfma_f32_16x16x32_bf16 a[24:27], v[88:91], v[176:179], a[24:27]
    v_mfma_f32_16x16x32_bf16 a[20:23], v[84:87], v[176:179], a[20:23]
    ds_read_b64_tr_b16 v[62:63], v127 offset:4096
    v_mfma_f32_16x16x32_bf16 a[16:19], v[80:83], v[176:179], a[16:19]
    buffer_load_dwordx4 v[176:179], v104, s[56:59], s16 offen offset:2048 sc1
    s_waitcnt vmcnt(25)
    v_cmp_ne_u32 vcc, s98, v24
    v_cmp_ne_u32 s[28:29], s99, v25
    s_or_b64 vcc, vcc, s[28:29]
    s_and_b64 vcc, vcc, 768
    s_cbranch_scc1 L_g2_late3
L_g2_cont3x:
    buffer_load_dwordx2 v[24:25], v109, s[12:15], s44 offen sc1
    s_waitcnt vmcnt(53) lgkmcnt(8)
    v_mfma_f32_16x16x32_bf16 a[0:3], v[32:35], v[192:195], a[0:3]
    ds_read_b64_tr_b16 v[64:65], v120 offset:8192
    v_mfma_f32_16x16x32_bf16 a[4:7], v[36:39], v[192:195], a[4:7]
    s_lshr_b32 s16, s77, 5
    s_sub_u32 s25, s16, s79
    v_mfma_f32_16x16x32_bf16 a[8:11], v[40:43], v[192:195], a[8:11]
    ds_read_b64_tr_b16 v[66:67], v120 offset:12288
    v_mfma_f32_16x16x32_bf16 a[12:15], v[44:47], v[192:195], a[12:15]
    s_add_u32 s16, s16, s79
    s_add_u32 s25, s25, 229376
    v_mfma_f32_16x16x32_bf16 a[44:47], v[44:47], v[196:199], a[44:47]
    ds_read_b64_tr_b16 v[68:69], v121 offset:8192
    v_mfma_f32_16x16x32_bf16 a[40:43], v[40:43], v[196:199], a[40:43]
    buffer_load_dwordx4 v100, s[32:35], s17 offen offset:0 lds
    v_mfma_f32_16x16x32_bf16 a[36:39], v[36:39], v[196:199], a[36:39]
    ds_read_b64_tr_b16 v[70:71], v121 offset:12288
    v_mfma_f32_16x16x32_bf16 a[32:35], v[32:35], v[196:199], a[32:35]
    v_add_u32 v106, 114688, v105
    v_mfma_f32_16x16x32_bf16 a[64:67], v[32:35], v[200:203], a[64:67]
    ds_read_b64_tr_b16 v[72:73], v122 offset:8192
    v_mfma_f32_16x16x32_bf16 a[68:71], v[36:39], v[200:203], a[68:71]
    v_xor_b32 v120, 0, v106
    v_mfma_f32_16x16x32_bf16 a[72:75], v[40:43], v[200:203], a[72:75]
    ds_read_b64_tr_b16 v[74:75], v122 offset:12288
    v_xor_b32 v121, 32, v106
    v_mfma_f32_16x16x32_bf16 a[76:79], v[44:47], v[200:203], a[76:79]
    v_xor_b32 v122, 64, v106
    buffer_load_dwordx4 v101, s[32:35], s17 offen offset:1024 lds
    v_mfma_f32_16x16x32_bf16 a[108:111], v[44:47], v[204:207], a[108:111]
    ds_read_b64_tr_b16 v[76:77], v123 offset:8192
    v_mfma_f32_16x16x32_bf16 a[104:107], v[40:43], v[204:207], a[104:107]
    v_mfma_f32_16x16x32_bf16 a[100:103], v[36:39], v[204:207], a[100:103]
    ds_read_b64_tr_b16 v[78:79], v123 offset:12288
    v_mfma_f32_16x16x32_bf16 a[96:99], v[32:35], v[204:207], a[96:99]
    s_waitcnt lgkmcnt(8)
    v_xor_b32 v123, 96, v106
    v_mfma_f32_16x16x32_bf16 a[112:115], v[48:51], v[204:207], a[112:115]
    ds_read_b64_tr_b16 v[80:81], v124 offset:8192
    v_mfma_f32_16x16x32_bf16 a[116:119], v[52:55], v[204:207], a[116:119]
    v_mfma_f32_16x16x32_bf16 a[120:123], v[56:59], v[204:207], a[120:123]
    ds_read_b64_tr_b16 v[82:83], v124 offset:12288
    v_mfma_f32_16x16x32_bf16 a[124:127], v[60:63], v[204:207], a[124:127]
    v_xor_b32 v124, 128, v106
    buffer_load_dwordx4 v[204:207], v104, s[56:59], s25 offen offset:1024 sc1
    v_mfma_f32_16x16x32_bf16 a[92:95], v[60:63], v[200:203], a[92:95]
    ds_read_b64_tr_b16 v[84:85], v125 offset:8192
    v_mfma_f32_16x16x32_bf16 a[88:91], v[56:59], v[200:203], a[88:91]
    v_mfma_f32_16x16x32_bf16 a[84:87], v[52:55], v[200:203], a[84:87]
    ds_read_b64_tr_b16 v[86:87], v125 offset:12288
    v_mfma_f32_16x16x32_bf16 a[80:83], v[48:51], v[200:203], a[80:83]
    v_xor_b32 v125, 160, v106
    buffer_load_dwordx4 v[200:203], v104, s[56:59], s25 offen offset:0 sc1
    v_mfma_f32_16x16x32_bf16 a[48:51], v[48:51], v[196:199], a[48:51]
    ds_read_b64_tr_b16 v[88:89], v126 offset:8192
    v_mfma_f32_16x16x32_bf16 a[52:55], v[52:55], v[196:199], a[52:55]
    v_mfma_f32_16x16x32_bf16 a[56:59], v[56:59], v[196:199], a[56:59]
    ds_read_b64_tr_b16 v[90:91], v126 offset:12288
    v_mfma_f32_16x16x32_bf16 a[60:63], v[60:63], v[196:199], a[60:63]
    v_xor_b32 v126, 192, v106
    buffer_load_dwordx4 v[196:199], v104, s[56:59], s16 offen offset:1024 sc1
    v_mfma_f32_16x16x32_bf16 a[28:31], v[60:63], v[192:195], a[28:31]
    ds_read_b64_tr_b16 v[92:93], v127 offset:8192
    v_mfma_f32_16x16x32_bf16 a[24:27], v[56:59], v[192:195], a[24:27]
    v_mfma_f32_16x16x32_bf16 a[20:23], v[52:55], v[192:195], a[20:23]
    ds_read_b64_tr_b16 v[94:95], v127 offset:12288
    v_mfma_f32_16x16x32_bf16 a[16:19], v[48:51], v[192:195], a[16:19]
    v_xor_b32 v127, 224, v106
    buffer_load_dwordx4 v[192:195], v104, s[56:59], s16 offen offset:0 sc1
    s_waitcnt vmcnt(45) lgkmcnt(8)
    v_mfma_f32_16x16x32_bf16 a[0:3], v[64:67], v[208:211], a[0:3]
    ds_read_b64_tr_b16 v[32:33], v120 offset:0
    v_mfma_f32_16x16x32_bf16 a[4:7], v[68:71], v[208:211], a[4:7]
    v_mfma_f32_16x16x32_bf16 a[8:11], v[72:75], v[208:211], a[8:11]
    ds_read_b64_tr_b16 v[34:35], v120 offset:4096
    v_mfma_f32_16x16x32_bf16 a[12:15], v[76:79], v[208:211], a[12:15]
    v_mfma_f32_16x16x32_bf16 a[44:47], v[76:79], v[212:215], a[44:47]
    ds_read_b64_tr_b16 v[36:37], v121 offset:0
    v_mfma_f32_16x16x32_bf16 a[40:43], v[72:75], v[212:215], a[40:43]
    buffer_load_dwordx4 v102, s[32:35], s17 offen offset:2048 lds
    v_mfma_f32_16x16x32_bf16 a[36:39], v[68:71], v[212:215], a[36:39]
    ds_read_b64_tr_b16 v[38:39], v121 offset:4096
    v_mfma_f32_16x16x32_bf16 a[32:35], v[64:67], v[212:215], a[32:35]
    v_mfma_f32_16x16x32_bf16 a[64:67], v[64:67], v[216:219], a[64:67]
    ds_read_b64_tr_b16 v[40:41], v122 offset:0
    v_mfma_f32_16x16x32_bf16 a[68:71], v[68:71], v[216:219], a[68:71]
    v_mfma_f32_16x16x32_bf16 a[72:75], v[72:75], v[216:219], a[72:75]
    ds_read_b64_tr_b16 v[42:43], v122 offset:4096
    v_mfma_f32_16x16x32_bf16 a[76:79], v[76:79], v[216:219], a[76:79]
    buffer_load_dwordx4 v103, s[32:35], s17 offen offset:3072 lds
    v_mfma_f32_16x16x32_bf16 a[108:111], v[76:79], v[220:223], a[108:111]
    ds_read_b64_tr_b16 v[44:45], v123 offset:0
    v_mfma_f32_16x16x32_bf16 a[104:107], v[72:75], v[220:223], a[104:107]
    v_mfma_f32_16x16x32_bf16 a[100:103], v[68:71], v[220:223], a[100:103]
    ds_read_b64_tr_b16 v[46:47], v123 offset:4096
    v_mfma_f32_16x16x32_bf16 a[96:99], v[64:67], v[220:223], a[96:99]
    s_waitcnt lgkmcnt(8)
    v_mfma_f32_16x16x32_bf16 a[112:115], v[80:83], v[220:223], a[112:115]
    ds_read_b64_tr_b16 v[48:49], v124 offset:0
    s_waitcnt vmcnt(39)
    s_barrier
    v_mfma_f32_16x16x32_bf16 a[116:119], v[84:87], v[220:223], a[116:119]
    s_add_u32 m0, s21, 65536
    s_add_u32 s17, s78, 0
    v_mfma_f32_16x16x32_bf16 a[120:123], v[88:91], v[220:223], a[120:123]
    ds_read_b64_tr_b16 v[50:51], v124 offset:4096
    v_mfma_f32_16x16x32_bf16 a[124:127], v[92:95], v[220:223], a[124:127]
    buffer_load_dwordx4 v[220:223], v104, s[56:59], s25 offen offset:3072 sc1
    v_mfma_f32_16x16x32_bf16 a[92:95], v[92:95], v[216:219], a[92:95]
    ds_read_b64_tr_b16 v[52:53], v125 offset:0
    v_mfma_f32_16x16x32_bf16 a[88:91], v[88:91], v[216:219], a[88:91]
    v_mfma_f32_16x16x32_bf16 a[84:87], v[84:87], v[216:219], a[84:87]
    ds_read_b64_tr_b16 v[54:55], v125 offset:4096
    v_mfma_f32_16x16x32_bf16 a[80:83], v[80:83], v[216:219], a[80:83]
    buffer_load_dwordx4 v[216:219], v104, s[56:59], s25 offen offset:2048 sc1
    v_mfma_f32_16x16x32_bf16 a[48:51], v[80:83], v[212:215], a[48:51]
    ds_read_b64_tr_b16 v[56:57], v126 offset:0
    v_mfma_f32_16x16x32_bf16 a[52:55], v[84:87], v[212:215], a[52:55]
    v_mfma_f32_16x16x32_bf16 a[56:59], v[88:91], v[212:215], a[56:59]
    ds_read_b64_tr_b16 v[58:59], v126 offset:4096
    v_mfma_f32_16x16x32_bf16 a[60:63], v[92:95], v[212:215], a[60:63]
    buffer_load_dwordx4 v[212:215], v104, s[56:59], s16 offen offset:3072 sc1
    v_mfma_f32_16x16x32_bf16 a[28:31], v[92:95], v[208:211], a[28:31]
    ds_read_b64_tr_b16 v[60:61], v127 offset:0
    v_mfma_f32_16x16x32_bf16 a[24:27], v[88:91], v[208:211], a[24:27]
    v_mfma_f32_16x16x32_bf16 a[20:23], v[84:87], v[208:211], a[20:23]
    ds_read_b64_tr_b16 v[62:63], v127 offset:4096
    v_mfma_f32_16x16x32_bf16 a[16:19], v[80:83], v[208:211], a[16:19]
    buffer_load_dwordx4 v[208:211], v104, s[56:59], s16 offen offset:2048 sc1
    s_add_u32 s16, s16, 4096
    s_add_u32 s25, s25, 4096
    s_waitcnt vmcnt(45) lgkmcnt(8)
    v_mfma_f32_16x16x32_bf16 a[0:3], v[32:35], v[224:227], a[0:3]
    ds_read_b64_tr_b16 v[64:65], v120 offset:8192
    v_mfma_f32_16x16x32_bf16 a[4:7], v[36:39], v[224:227], a[4:7]
    v_mfma_f32_16x16x32_bf16 a[8:11], v[40:43], v[224:227], a[8:11]
    ds_read_b64_tr_b16 v[66:67], v120 offset:12288
    v_mfma_f32_16x16x32_bf16 a[12:15], v[44:47], v[224:227], a[12:15]
    v_mfma_f32_16x16x32_bf16 a[44:47], v[44:47], v[228:231], a[44:47]
    ds_read_b64_tr_b16 v[68:69], v121 offset:8192
    v_mfma_f32_16x16x32_bf16 a[40:43], v[40:43], v[228:231], a[40:43]
    buffer_load_dwordx4 v100, s[32:35], s17 offen offset:0 lds
    v_mfma_f32_16x16x32_bf16 a[36:39], v[36:39], v[228:231], a[36:39]
    ds_read_b64_tr_b16 v[70:71], v121 offset:12288
    v_mfma_f32_16x16x32_bf16 a[32:35], v[32:35], v[228:231], a[32:35]
    v_add_u32 v106, 0, v105
    v_mfma_f32_16x16x32_bf16 a[64:67], v[32:35], v[232:235], a[64:67]
    ds_read_b64_tr_b16 v[72:73], v122 offset:8192
    v_mfma_f32_16x16x32_bf16 a[68:71], v[36:39], v[232:235], a[68:71]
    v_xor_b32 v120, 0, v106
    v_mfma_f32_16x16x32_bf16 a[72:75], v[40:43], v[232:235], a[72:75]
    ds_read_b64_tr_b16 v[74:75], v122 offset:12288
    v_xor_b32 v121, 32, v106
    v_mfma_f32_16x16x32_bf16 a[76:79], v[44:47], v[232:235], a[76:79]
    v_xor_b32 v122, 64, v106
    buffer_load_dwordx4 v101, s[32:35], s17 offen offset:1024 lds
    v_mfma_f32_16x16x32_bf16 a[108:111], v[44:47], v[236:239], a[108:111]
    ds_read_b64_tr_b16 v[76:77], v123 offset:8192
    v_mfma_f32_16x16x32_bf16 a[104:107], v[40:43], v[236:239], a[104:107]
    v_mfma_f32_16x16x32_bf16 a[100:103], v[36:39], v[236:239], a[100:103]
    ds_read_b64_tr_b16 v[78:79], v123 offset:12288
    v_mfma_f32_16x16x32_bf16 a[96:99], v[32:35], v[236:239], a[96:99]
    s_waitcnt lgkmcnt(8)
    v_xor_b32 v123, 96, v106
    v_mfma_f32_16x16x32_bf16 a[112:115], v[48:51], v[236:239], a[112:115]
    ds_read_b64_tr_b16 v[80:81], v124 offset:8192
    v_mfma_f32_16x16x32_bf16 a[116:119], v[52:55], v[236:239], a[116:119]
    v_mfma_f32_16x16x32_bf16 a[120:123], v[56:59], v[236:239], a[120:123]
    ds_read_b64_tr_b16 v[82:83], v124 offset:12288
    v_mfma_f32_16x16x32_bf16 a[124:127], v[60:63], v[236:239], a[124:127]
    v_xor_b32 v124, 128, v106
    buffer_load_dwordx4 v[236:239], v104, s[56:59], s25 offen offset:1024 sc1
    v_mfma_f32_16x16x32_bf16 a[92:95], v[60:63], v[232:235], a[92:95]
    ds_read_b64_tr_b16 v[84:85], v125 offset:8192
    v_mfma_f32_16x16x32_bf16 a[88:91], v[56:59], v[232:235], a[88:91]
    v_mfma_f32_16x16x32_bf16 a[84:87], v[52:55], v[232:235], a[84:87]
    ds_read_b64_tr_b16 v[86:87], v125 offset:12288
    v_mfma_f32_16x16x32_bf16 a[80:83], v[48:51], v[232:235], a[80:83]
    v_xor_b32 v125, 160, v106
    buffer_load_dwordx4 v[232:235], v104, s[56:59], s25 offen offset:0 sc1
    v_mfma_f32_16x16x32_bf16 a[48:51], v[48:51], v[228:231], a[48:51]
    ds_read_b64_tr_b16 v[88:89], v126 offset:8192
    v_mfma_f32_16x16x32_bf16 a[52:55], v[52:55], v[228:231], a[52:55]
    v_mfma_f32_16x16x32_bf16 a[56:59], v[56:59], v[228:231], a[56:59]
    ds_read_b64_tr_b16 v[90:91], v126 offset:12288
    v_mfma_f32_16x16x32_bf16 a[60:63], v[60:63], v[228:231], a[60:63]
    v_xor_b32 v126, 192, v106
    buffer_load_dwordx4 v[228:231], v104, s[56:59], s16 offen offset:1024 sc1
    v_mfma_f32_16x16x32_bf16 a[28:31], v[60:63], v[224:227], a[28:31]
    ds_read_b64_tr_b16 v[92:93], v127 offset:8192
    v_mfma_f32_16x16x32_bf16 a[24:27], v[56:59], v[224:227], a[24:27]
    v_mfma_f32_16x16x32_bf16 a[20:23], v[52:55], v[224:227], a[20:23]
    ds_read_b64_tr_b16 v[94:95], v127 offset:12288
    v_mfma_f32_16x16x32_bf16 a[16:19], v[48:51], v[224:227], a[16:19]
    v_xor_b32 v127, 224, v106
    buffer_load_dwordx4 v[224:227], v104, s[56:59], s16 offen offset:0 sc1
    s_waitcnt vmcnt(45) lgkmcnt(8)
    v_mfma_f32_16x16x32_bf16 a[0:3], v[64:67], v[240:243], a[0:3]
    ds_read_b64_tr_b16 v[32:33], v120 offset:0
    v_mfma_f32_16x16x32_bf16 a[4:7], v[68:71], v[240:243], a[4:7]
    v_mfma_f32_16x16x32_bf16 a[8:11], v[72:75], v[240:243], a[8:11]
    ds_read_b64_tr_b16 v[34:35], v120 offset:4096
    v_mfma_f32_16x16x32_bf16 a[12:15], v[76:79], v[240:243], a[12:15]
    v_mfma_f32_16x16x32_bf16 a[44:47], v[76:79], v[244:247], a[44:47]
    ds_read_b64_tr_b16 v[36:37], v121 offset:0
    v_mfma_f32_16x16x32_bf16 a[40:43], v[72:75], v[244:247], a[40:43]
    buffer_load_dwordx4 v102, s[32:35], s17 offen offset:2048 lds
    v_mfma_f32_16x16x32_bf16 a[36:39], v[68:71], v[244:247], a[36:39]
    ds_read_b64_tr_b16 v[38:39], v121 offset:4096
    v_mfma_f32_16x16x32_bf16 a[32:35], v[64:67], v[244:247], a[32:35]
    v_mfma_f32_16x16x32_bf16 a[64:67], v[64:67], v[248:251], a[64:67]
    ds_read_b64_tr_b16 v[40:41], v122 offset:0
    v_mfma_f32_16x16x32_bf16 a[68:71], v[68:71], v[248:251], a[68:71]
    v_mfma_f32_16x16x32_bf16 a[72:75], v[72:75], v[248:251], a[72:75]
    ds_read_b64_tr_b16 v[42:43], v122 offset:4096
    v_mfma_f32_16x16x32_bf16 a[76:79], v[76:79], v[248:251], a[76:79]
    buffer_load_dwordx4 v103, s[32:35], s17 offen offset:3072 lds
    v_mfma_f32_16x16x32_bf16 a[108:111], v[76:79], v[252:255], a[108:111]
    ds_read_b64_tr_b16 v[44:45], v123 offset:0
    v_mfma_f32_16x16x32_bf16 a[104:107], v[72:75], v[252:255], a[104:107]
    v_mfma_f32_16x16x32_bf16 a[100:103], v[68:71], v[252:255], a[100:103]
    ds_read_b64_tr_b16 v[46:47], v123 offset:4096
    v_mfma_f32_16x16x32_bf16 a[96:99], v[64:67], v[252:255], a[96:99]
    s_waitcnt lgkmcnt(8)
    v_mfma_f32_16x16x32_bf16 a[112:115], v[80:83], v[252:255], a[112:115]
    ds_read_b64_tr_b16 v[48:49], v124 offset:0
    s_waitcnt vmcnt(37)
    s_barrier
    v_mfma_f32_16x16x32_bf16 a[116:119], v[84:87], v[252:255], a[116:119]
    s_add_u32 m0, s21, 81920
    s_add_u32 s17, s78, 131072
    v_mfma_f32_16x16x32_bf16 a[120:123], v[88:91], v[252:255], a[120:123]
    ds_read_b64_tr_b16 v[50:51], v124 offset:4096
    v_mfma_f32_16x16x32_bf16 a[124:127], v[92:95], v[252:255], a[124:127]
    buffer_load_dwordx4 v[252:255], v104, s[56:59], s25 offen offset:3072 sc1
    v_mfma_f32_16x16x32_bf16 a[92:95], v[92:95], v[248:251], a[92:95]
    ds_read_b64_tr_b16 v[52:53], v125 offset:0
    v_mfma_f32_16x16x32_bf16 a[88:91], v[88:91], v[248:251], a[88:91]
    v_mfma_f32_16x16x32_bf16 a[84:87], v[84:87], v[248:251], a[84:87]
    ds_read_b64_tr_b16 v[54:55], v125 offset:4096
    v_mfma_f32_16x16x32_bf16 a[80:83], v[80:83], v[248:251], a[80:83]
    buffer_load_dwordx4 v[248:251], v104, s[56:59], s25 offen offset:2048 sc1
    v_mfma_f32_16x16x32_bf16 a[48:51], v[80:83], v[244:247], a[48:51]
    ds_read_b64_tr_b16 v[56:57], v126 offset:0
    v_mfma_f32_16x16x32_bf16 a[52:55], v[84:87], v[244:247], a[52:55]
    v_mfma_f32_16x16x32_bf16 a[56:59], v[88:91], v[244:247], a[56:59]
    ds_read_b64_tr_b16 v[58:59], v126 offset:4096
    v_mfma_f32_16x16x32_bf16 a[60:63], v[92:95], v[244:247], a[60:63]
    buffer_load_dwordx4 v[244:247], v104, s[56:59], s16 offen offset:3072 sc1
    v_mfma_f32_16x16x32_bf16 a[28:31], v[92:95], v[240:243], a[28:31]
    ds_read_b64_tr_b16 v[60:61], v127 offset:0
    v_mfma_f32_16x16x32_bf16 a[24:27], v[88:91], v[240:243], a[24:27]
    v_mfma_f32_16x16x32_bf16 a[20:23], v[84:87], v[240:243], a[20:23]
    ds_read_b64_tr_b16 v[62:63], v127 offset:4096
    v_mfma_f32_16x16x32_bf16 a[16:19], v[80:83], v[240:243], a[16:19]
    buffer_load_dwordx4 v[240:243], v104, s[56:59], s16 offen offset:2048 sc1
    s_waitcnt vmcnt(24)
    v_cmp_ne_u32 vcc, s98, v24
    v_cmp_ne_u32 s[28:29], s99, v25
    s_or_b64 vcc, vcc, s[28:29]
    s_and_b64 vcc, vcc, 3072
    s_cbranch_scc1 L_g2_late4
L_g2_cont4x:
    buffer_load_dwordx2 v[18:19], v110, s[12:15], 0 offen sc1
    s_waitcnt vmcnt(44) lgkmcnt(8)
    v_mfma_f32_16x16x32_bf16 a[0:3], v[32:35], v[128:131], a[0:3]
    ds_read_b64_tr_b16 v[64:65], v120 offset:8192
    v_mfma_f32_16x16x32_bf16 a[4:7], v[36:39], v[128:131], a[4:7]
    s_lshr_b32 s16, s78, 5
    s_sub_u32 s25, s16, s79
    v_mfma_f32_16x16x32_bf16 a[8:11], v[40:43], v[128:131], a[8:11]
    ds_read_b64_tr_b16 v[66:67], v120 offset:12288
    v_mfma_f32_16x16x32_bf16 a[12:15], v[44:47], v[128:131], a[12:15]
    s_add_u32 s16, s16, s79
    s_add_u32 s25, s25, 229376
    v_mfma_f32_16x16x32_bf16 a[44:47], v[44:47], v[132:135], a[44:47]
    ds_read_b64_tr_b16 v[68:69], v121 offset:8192
    v_mfma_f32_16x16x32_bf16 a[40:43], v[40:43], v[132:135], a[40:43]
    buffer_load_dwordx4 v100, s[32:35], s17 offen offset:0 lds
    v_mfma_f32_16x16x32_bf16 a[36:39], v[36:39], v[132:135], a[36:39]
    ds_read_b64_tr_b16 v[70:71], v121 offset:12288
    v_mfma_f32_16x16x32_bf16 a[32:35], v[32:35], v[132:135], a[32:35]
    v_add_u32 v106, 16384, v105
    v_mfma_f32_16x16x32_bf16 a[64:67], v[32:35], v[136:139], a[64:67]
    ds_read_b64_tr_b16 v[72:73], v122 offset:8192
    v_mfma_f32_16x16x32_bf16 a[68:71], v[36:39], v[136:139], a[68:71]
    v_xor_b32 v120, 0, v106
    v_mfma_f32_16x16x32_bf16 a[72:75], v[40:43], v[136:139], a[72:75]
    ds_read_b64_tr_b16 v[74:75], v122 offset:12288
    v_xor_b32 v121, 32, v106
    v_mfma_f32_16x16x32_bf16 a[76:79], v[44:47], v[136:139], a[76:79]
    v_xor_b32 v122, 64, v106
    buffer_load_dwordx4 v101, s[32:35], s17 offen offset:1024 lds
    v_mfma_f32_16x16x32_bf16 a[108:111], v[44:47], v[140:143], a[108:111]
    ds_read_b64_tr_b16 v[76:77], v123 offset:8192
    v_mfma_f32_16x16x32_bf16 a[104:107], v[40:43], v[140:143], a[104:107]
    v_mfma_f32_16x16x32_bf16 a[100:103], v[36:39], v[140:143], a[100:103]
    ds_read_b64_tr_b16 v[78:79], v123 offset:12288
    v_mfma_f32_16x16x32_bf16 a[96:99], v[32:35], v[140:143], a[96:99]
    s_waitcnt lgkmcnt(8)
    v_xor_b32 v123, 96, v106
    v_mfma_f32_16x16x32_bf16 a[112:115], v[48:51], v[140:143], a[112:115]
    ds_read_b64_tr_b16 v[80:81], v124 offset:8192
    v_mfma_f32_16x16x32_bf16 a[116:119], v[52:55], v[140:143], a[116:119]
    v_mfma_f32_16x16x32_bf16 a[120:123], v[56:59], v[140:143], a[120:123]
    ds_read_b64_tr_b16 v[82:83], v124 offset:12288
    v_mfma_f32_16x16x32_bf16 a[124:127], v[60:63], v[140:143], a[124:127]
    v_xor_b32 v124, 128, v106
    buffer_load_dwordx4 v[140:143], v104, s[56:59], s25 offen offset:1024 sc1
    v_mfma_f32_16x16x32_bf16 a[92:95], v[60:63], v[136:139], a[92:95]
    ds_read_b64_tr_b16 v[84:85], v125 offset:8192
    v_mfma_f32_16x16x32_bf16 a[88:91], v[56:59], v[136:139], a[88:91]
    v_mfma_f32_16x16x32_bf16 a[84:87], v[52:55], v[136:139], a[84:87]
    ds_read_b64_tr_b16 v[86:87], v125 offset:12288
    v_mfma_f32_16x16x32_bf16 a[80:83], v[48:51], v[136:139], a[80:83]
    v_xor_b32 v125, 160, v106
    buffer_load_dwordx4 v[136:139], v104, s[56:59], s25 offen offset:0 sc1
    v_mfma_f32_16x16x32_bf16 a[48:51], v[48:51], v[132:135], a[48:51]
    ds_read_b64_tr_b16 v[88:89], v126 offset:8192
    v_mfma_f32_16x16x32_bf16 a[52:55], v[52:55], v[132:135], a[52:55]
    v_mfma_f32_16x16x32_bf16 a[56:59], v[56:59], v[132:135], a[56:59]
    ds_read_b64_tr_b16 v[90:91], v126 offset:12288
    v_mfma_f32_16x16x32_bf16 a[60:63], v[60:63], v[132:135], a[60:63]
    v_xor_b32 v126, 192, v106
    buffer_load_dwordx4 v[132:135], v104, s[56:59], s16 offen offset:1024 sc1
    v_mfma_f32_16x16x32_bf16 a[28:31], v[60:63], v[128:131], a[28:31]
    ds_read_b64_tr_b16 v[92:93], v127 offset:8192
    v_mfma_f32_16x16x32_bf16 a[24:27], v[56:59], v[128:131], a[24:27]
    v_mfma_f32_16x16x32_bf16 a[20:23], v[52:55], v[128:131], a[20:23]
    ds_read_b64_tr_b16 v[94:95], v127 offset:12288
    v_mfma_f32_16x16x32_bf16 a[16:19], v[48:51], v[128:131], a[16:19]
    v_xor_b32 v127, 224, v106
    buffer_load_dwordx4 v[128:131], v104, s[56:59], s16 offen offset:0 sc1
    s_waitcnt vmcnt(44) lgkmcnt(8)
    v_mfma_f32_16x16x32_bf16 a[0:3], v[64:67], v[144:147], a[0:3]
    ds_read_b64_tr_b16 v[32:33], v120 offset:0
    v_mfma_f32_16x16x32_bf16 a[4:7], v[68:71], v[144:147], a[4:7]
    v_mfma_f32_16x16x32_bf16 a[8:11], v[72:75], v[144:147], a[8:11]
    ds_read_b64_tr_b16 v[34:35], v120 offset:4096
    v_mfma_f32_16x16x32_bf16 a[12:15], v[76:79], v[144:147], a[12:15]
    v_mfma_f32_16x16x32_bf16 a[44:47], v[76:79], v[148:151], a[44:47]
    ds_read_b64_tr_b16 v[36:37], v121 offset:0
    v_mfma_f32_16x16x32_bf16 a[40:43], v[72:75], v[148:151], a[40:43]
    buffer_load_dwordx4 v102, s[32:35], s17 offen offset:2048 lds
    v_mfma_f32_16x16x32_bf16 a[36:39], v[68:71], v[148:151], a[36:39]
    ds_read_b64_tr_b16 v[38:39], v121 offset:4096
    v_mfma_f32_16x16x32_bf16 a[32:35], v[64:67], v[148:151], a[32:35]
    v_mfma_f32_16x16x32_bf16 a[64:67], v[64:67], v[152:155], a[64:67]
    ds_read_b64_tr_b16 v[40:41], v122 offset:0
    v_mfma_f32_16x16x32_bf16 a[68:71], v[68:71], v[152:155], a[68:71]
    v_mfma_f32_16x16x32_bf16 a[72:75], v[72:75], v[152:155], a[72:75]
    ds_read_b64_tr_b16 v[42:43], v122 offset:4096
    v_mfma_f32_16x16x32_bf16 a[76:79], v[76:79], v[152:155], a[76:79]
    buffer_load_dwordx4 v103, s[32:35], s17 offen offset:3072 lds
    v_mfma_f32_16x16x32_bf16 a[108:111], v[76:79], v[156:159], a[108:111]
    ds_read_b64_tr_b16 v[44:45], v123 offset:0
    v_mfma_f32_16x16x32_bf16 a[104:107], v[72:75], v[156:159], a[104:107]
    v_mfma_f32_16x16x32_bf16 a[100:103], v[68:71], v[156:159], a[100:103]
    ds_read_b64_tr_b16 v[46:47], v123 offset:4096
    v_mfma_f32_16x16x32_bf16 a[96:99], v[64:67], v[156:159], a[96:99]
    s_waitcnt lgkmcnt(8)
    v_mfma_f32_16x16x32_bf16 a[112:115], v[80:83], v[156:159], a[112:115]
    ds_read_b64_tr_b16 v[48:49], v124 offset:0
    s_waitcnt vmcnt(38)
    s_barrier
    v_mfma_f32_16x16x32_bf16 a[116:119], v[84:87], v[156:159], a[116:119]
    v_mfma_f32_16x16x32_bf16 a[120:123], v[88:91], v[156:159], a[120:123]
    ds_read_b64_tr_b16 v[50:51], v124 offset:4096
    v_mfma_f32_16x16x32_bf16 a[124:127], v[92:95], v[156:159], a[124:127]
    buffer_load_dwordx4 v[156:159], v104, s[56:59], s25 offen offset:3072 sc1
    v_mfma_f32_16x16x32_bf16 a[92:95], v[92:95], v[152:155], a[92:95]
    ds_read_b64_tr_b16 v[52:53], v125 offset:0
    v_mfma_f32_16x16x32_bf16 a[88:91], v[88:91], v[152:155], a[88:91]
    v_mfma_f32_16x16x32_bf16 a[84:87], v[84:87], v[152:155], a[84:87]
    ds_read_b64_tr_b16 v[54:55], v125 offset:4096
    v_mfma_f32_16x16x32_bf16 a[80:83], v[80:83], v[152:155], a[80:83]
    buffer_load_dwordx4 v[152:155], v104, s[56:59], s25 offen offset:2048 sc1
    v_mfma_f32_16x16x32_bf16 a[48:51], v[80:83], v[148:151], a[48:51]
    ds_read_b64_tr_b16 v[56:57], v126 offset:0
    v_mfma_f32_16x16x32_bf16 a[52:55], v[84:87], v[148:151], a[52:55]
    v_mfma_f32_16x16x32_bf16 a[56:59], v[88:91], v[148:151], a[56:59]
    ds_read_b64_tr_b16 v[58:59], v126 offset:4096
    v_mfma_f32_16x16x32_bf16 a[60:63], v[92:95], v[148:151], a[60:63]
    buffer_load_dwordx4 v[148:151], v104, s[56:59], s16 offen offset:3072 sc1
    v_mfma_f32_16x16x32_bf16 a[28:31], v[92:95], v[144:147], a[28:31]
    ds_read_b64_tr_b16 v[60:61], v127 offset:0
    v_mfma_f32_16x16x32_bf16 a[24:27], v[88:91], v[144:147], a[24:27]
    v_mfma_f32_16x16x32_bf16 a[20:23], v[84:87], v[144:147], a[20:23]
    ds_read_b64_tr_b16 v[62:63], v127 offset:4096
    v_mfma_f32_16x16x32_bf16 a[16:19], v[80:83], v[144:147], a[16:19]
    buffer_load_dwordx4 v[144:147], v104, s[56:59], s16 offen offset:2048 sc1
    s_add_u32 s16, s16, 4096
    s_add_u32 s25, s25, 4096
    s_waitcnt vmcnt(44) lgkmcnt(8)
    v_mfma_f32_16x16x32_bf16 a[0:3], v[32:35], v[160:163], a[0:3]
    ds_read_b64_tr_b16 v[64:65], v120 offset:8192
    v_mfma_f32_16x16x32_bf16 a[4:7], v[36:39], v[160:163], a[4:7]
    v_mfma_f32_16x16x32_bf16 a[8:11], v[40:43], v[160:163], a[8:11]
    ds_read_b64_tr_b16 v[66:67], v120 offset:12288
    v_mfma_f32_16x16x32_bf16 a[12:15], v[44:47], v[160:163], a[12:15]
    v_mfma_f32_16x16x32_bf16 a[44:47], v[44:47], v[164:167], a[44:47]
    ds_read_b64_tr_b16 v[68:69], v121 offset:8192
    v_mfma_f32_16x16x32_bf16 a[40:43], v[40:43], v[164:167], a[40:43]
    v_mfma_f32_16x16x32_bf16 a[36:39], v[36:39], v[164:167], a[36:39]
    ds_read_b64_tr_b16 v[70:71], v121 offset:12288
    v_mfma_f32_16x16x32_bf16 a[32:35], v[32:35], v[164:167], a[32:35]
    v_add_u32 v106, 32768, v105
    v_mfma_f32_16x16x32_bf16 a[64:67], v[32:35], v[168:171], a[64:67]
    ds_read_b64_tr_b16 v[72:73], v122 offset:8192
    v_mfma_f32_16x16x32_bf16 a[68:71], v[36:39], v[168:171], a[68:71]
    v_xor_b32 v120, 0, v106
    v_mfma_f32_16x16x32_bf16 a[72:75], v[40:43], v[168:171], a[72:75]
    ds_read_b64_tr_b16 v[74:75], v122 offset:12288
    v_xor_b32 v121, 32, v106
    v_mfma_f32_16x16x32_bf16 a[76:79], v[44:47], v[168:171], a[76:79]
    v_xor_b32 v122, 64, v106
    v_mfma_f32_16x16x32_bf16 a[108:111], v[44:47], v[172:175], a[108:111]
    ds_read_b64_tr_b16 v[76:77], v123 offset:8192
    v_mfma_f32_16x16x32_bf16 a[104:107], v[40:43], v[172:175], a[104:107]
    v_mfma_f32_16x16x32_bf16 a[100:103], v[36:39], v[172:175], a[100:103]
    ds_read_b64_tr_b16 v[78:79], v123 offset:12288
    v_mfma_f32_16x16x32_bf16 a[96:99], v[32:35], v[172:175], a[96:99]
    s_waitcnt lgkmcnt(8)
    v_xor_b32 v123, 96, v106
    v_mfma_f32_16x16x32_bf16 a[112:115], v[48:51], v[172:175], a[112:115]
    ds_read_b64_tr_b16 v[80:81], v124 offset:8192
    v_mfma_f32_16x16x32_bf16 a[116:119], v[52:55], v[172:175], a[116:119]
    v_mfma_f32_16x16x32_bf16 a[120:123], v[56:59], v[172:175], a[120:123]
    ds_read_b64_tr_b16 v[82:83], v124 offset:12288
    v_mfma_f32_16x16x32_bf16 a[124:127], v[60:63], v[172:175], a[124:127]
    v_xor_b32 v124, 128, v106
    buffer_load_dwordx4 v[172:175], v104, s[56:59], s25 offen offset:1024 sc1
    v_mfma_f32_16x16x32_bf16 a[92:95], v[60:63], v[168:171], a[92:95]
    ds_read_b64_tr_b16 v[84:85], v125 offset:8192
    v_mfma_f32_16x16x32_bf16 a[88:91], v[56:59], v[168:171], a[88:91]
    v_mfma_f32_16x16x32_bf16 a[84:87], v[52:55], v[168:171], a[84:87]
    ds_read_b64_tr_b16 v[86:87], v125 offset:12288
    v_mfma_f32_16x16x32_bf16 a[80:83], v[48:51], v[168:171], a[80:83]
    v_xor_b32 v125, 160, v106
    buffer_load_dwordx4 v[168:171], v104, s[56:59], s25 offen offset:0 sc1
    v_mfma_f32_16x16x32_bf16 a[48:51], v[48:51], v[164:167], a[48:51]
    ds_read_b64_tr_b16 v[88:89], v126 offset:8192
    v_mfma_f32_16x16x32_bf16 a[52:55], v[52:55], v[164:167], a[52:55]
    v_mfma_f32_16x16x32_bf16 a[56:59], v[56:59], v[164:167], a[56:59]
    ds_read_b64_tr_b16 v[90:91], v126 offset:12288
    v_mfma_f32_16x16x32_bf16 a[60:63], v[60:63], v[164:167], a[60:63]
    v_xor_b32 v126, 192, v106
    buffer_load_dwordx4 v[164:167], v104, s[56:59], s16 offen offset:1024 sc1
    v_mfma_f32_16x16x32_bf16 a[28:31], v[60:63], v[160:163], a[28:31]
    ds_read_b64_tr_b16 v[92:93], v127 offset:8192
    v_mfma_f32_16x16x32_bf16 a[24:27], v[56:59], v[160:163], a[24:27]
    v_mfma_f32_16x16x32_bf16 a[20:23], v[52:55], v[160:163], a[20:23]
    ds_read_b64_tr_b16 v[94:95], v127 offset:12288
    v_mfma_f32_16x16x32_bf16 a[16:19], v[48:51], v[160:163], a[16:19]
    v_xor_b32 v127, 224, v106
    buffer_load_dwordx4 v[160:163], v104, s[56:59], s16 offen offset:0 sc1
    s_waitcnt vmcnt(42) lgkmcnt(8)
    v_mfma_f32_16x16x32_bf16 a[0:3], v[64:67], v[176:179], a[0:3]
    ds_read_b64_tr_b16 v[32:33], v120 offset:0
    v_mfma_f32_16x16x32_bf16 a[4:7], v[68:71], v[176:179], a[4:7]
    v_mfma_f32_16x16x32_bf16 a[8:11], v[72:75], v[176:179], a[8:11]
    ds_read_b64_tr_b16 v[34:35], v120 offset:4096
    v_mfma_f32_16x16x32_bf16 a[12:15], v[76:79], v[176:179], a[12:15]
    v_mfma_f32_16x16x32_bf16 a[44:47], v[76:79], v[180:183], a[44:47]
    ds_read_b64_tr_b16 v[36:37], v121 offset:0
    v_mfma_f32_16x16x32_bf16 a[40:43], v[72:75], v[180:183], a[40:43]
    v_mfma_f32_16x16x32_bf16 a[36:39], v[68:71], v[180:183], a[36:39]
    ds_read_b64_tr_b16 v[38:39], v121 offset:4096
    v_mfma_f32_16x16x32_bf16 a[32:35], v[64:67], v[180:183], a[32:35]
    v_mfma_f32_16x16x32_bf16 a[64:67], v[64:67], v[184:187], a[64:67]
    ds_read_b64_tr_b16 v[40:41], v122 offset:0
    v_mfma_f32_16x16x32_bf16 a[68:71], v[68:71], v[184:187], a[68:71]
    v_mfma_f32_16x16x32_bf16 a[72:75], v[72:75], v[184:187], a[72:75]
    ds_read_b64_tr_b16 v[42:43], v122 offset:4096
    v_mfma_f32_16x16x32_bf16 a[76:79], v[76:79], v[184:187], a[76:79]
    v_mfma_f32_16x16x32_bf16 a[108:111], v[76:79], v[188:191], a[108:111]
    ds_read_b64_tr_b16 v[44:45], v123 offset:0
    v_mfma_f32_16x16x32_bf16 a[104:107], v[72:75], v[188:191], a[104:107]
    v_mfma_f32_16x16x32_bf16 a[100:103], v[68:71], v[188:191], a[100:103]
    ds_read_b64_tr_b16 v[46:47], v123 offset:4096
    v_mfma_f32_16x16x32_bf16 a[96:99], v[64:67], v[188:191], a[96:99]
    s_waitcnt lgkmcnt(8)
    v_mfma_f32_16x16x32_bf16 a[112:115], v[80:83], v[188:191], a[112:115]
    ds_read_b64_tr_b16 v[48:49], v124 offset:0
    s_waitcnt vmcnt(33)
    s_barrier
    v_mfma_f32_16x16x32_bf16 a[116:119], v[84:87], v[188:191], a[116:119]
    v_mfma_f32_16x16x32_bf16 a[120:123], v[88:91], v[188:191], a[120:123]
    ds_read_b64_tr_b16 v[50:51], v124 offset:4096
    v_mfma_f32_16x16x32_bf16 a[124:127], v[92:95], v[188:191], a[124:127]
    buffer_load_dwordx4 v[188:191], v104, s[56:59], s25 offen offset:3072 sc1
    v_mfma_f32_16x16x32_bf16 a[92:95], v[92:95], v[184:187], a[92:95]
    ds_read_b64_tr_b16 v[52:53], v125 offset:0
    v_mfma_f32_16x16x32_bf16 a[88:91], v[88:91], v[184:187], a[88:91]
    v_mfma_f32_16x16x32_bf16 a[84:87], v[84:87], v[184:187], a[84:87]
    ds_read_b64_tr_b16 v[54:55], v125 offset:4096
    v_mfma_f32_16x16x32_bf16 a[80:83], v[80:83], v[184:187], a[80:83]
    buffer_load_dwordx4 v[184:187], v104, s[56:59], s25 offen offset:2048 sc1
    v_mfma_f32_16x16x32_bf16 a[48:51], v[80:83], v[180:183], a[48:51]
    ds_read_b64_tr_b16 v[56:57], v126 offset:0
    v_mfma_f32_16x16x32_bf16 a[52:55], v[84:87], v[180:183], a[52:55]
    v_mfma_f32_16x16x32_bf16 a[56:59], v[88:91], v[180:183], a[56:59]
    ds_read_b64_tr_b16 v[58:59], v126 offset:4096
    v_mfma_f32_16x16x32_bf16 a[60:63], v[92:95], v[180:183], a[60:63]
    buffer_load_dwordx4 v[180:183], v104, s[56:59], s16 offen offset:3072 sc1
    v_mfma_f32_16x16x32_bf16 a[28:31], v[92:95], v[176:179], a[28:31]
    ds_read_b64_tr_b16 v[60:61], v127 offset:0
    v_mfma_f32_16x16x32_bf16 a[24:27], v[88:91], v[176:179], a[24:27]
    v_mfma_f32_16x16x32_bf16 a[20:23], v[84:87], v[176:179], a[20:23]
    ds_read_b64_tr_b16 v[62:63], v127 offset:4096
    v_mfma_f32_16x16x32_bf16 a[16:19], v[80:83], v[176:179], a[16:19]
    buffer_load_dwordx4 v[176:179], v104, s[56:59], s16 offen offset:2048 sc1
    s_waitcnt vmcnt(20)
    v_cmp_ne_u32 vcc, s98, v18
    v_cmp_ne_u32 s[28:29], s99, v19
    s_or_b64 vcc, vcc, s[28:29]
    s_and_b64 vcc, vcc, -1
    s_cbranch_scc1 L_g2_s4
L_g2_s4ok:
    buffer_load_dwordx4 a[160:163], v119, s[12:15], 0 offen sc1
    buffer_load_dwordx4 a[164:167], v119, s[12:15], 0 offen offset:256 sc1
    buffer_load_dwordx4 a[136:139], v114, s[12:15], 0 offen sc1
    buffer_load_dwordx4 a[140:143], v115, s[12:15], 0 offen sc1
    buffer_load_dwordx4 a[144:147], v116, s[12:15], 0 offen sc1
    buffer_load_dwordx4 a[148:151], v117, s[12:15], 0 offen sc1
    buffer_load_dword a152, v118, s[12:15], 0 offen sc1
    s_waitcnt vmcnt(46) lgkmcnt(8)
    v_mfma_f32_16x16x32_bf16 a[0:3], v[32:35], v[192:195], a[0:3]
    ds_read_b64_tr_b16 v[64:65], v120 offset:8192
    v_mfma_f32_16x16x32_bf16 a[4:7], v[36:39], v[192:195], a[4:7]
    v_mfma_f32_16x16x32_bf16 a[8:11], v[40:43], v[192:195], a[8:11]
    ds_read_b64_tr_b16 v[66:67], v120 offset:12288
    v_mfma_f32_16x16x32_bf16 a[12:15], v[44:47], v[192:195], a[12:15]
    v_mfma_f32_16x16x32_bf16 a[44:47], v[44:47], v[196:199], a[44:47]
    ds_read_b64_tr_b16 v[68:69], v121 offset:8192
    v_mfma_f32_16x16x32_bf16 a[40:43], v[40:43], v[196:199], a[40:43]
    v_mfma_f32_16x16x32_bf16 a[36:39], v[36:39], v[196:199], a[36:39]
    ds_read_b64_tr_b16 v[70:71], v121 offset:12288
    v_mfma_f32_16x16x32_bf16 a[32:35], v[32:35], v[196:199], a[32:35]
    v_add_u32 v106, 49152, v105
    v_mfma_f32_16x16x32_bf16 a[64:67], v[32:35], v[200:203], a[64:67]
    ds_read_b64_tr_b16 v[72:73], v122 offset:8192
    v_mfma_f32_16x16x32_bf16 a[68:71], v[36:39], v[200:203], a[68:71]
    v_xor_b32 v120, 0, v106
    v_mfma_f32_16x16x32_bf16 a[72:75], v[40:43], v[200:203], a[72:75]
    ds_read_b64_tr_b16 v[74:75], v122 offset:12288
    v_xor_b32 v121, 32, v106
    v_mfma_f32_16x16x32_bf16 a[76:79], v[44:47], v[200:203], a[76:79]
    v_xor_b32 v122, 64, v106
    v_mfma_f32_16x16x32_bf16 a[108:111], v[44:47], v[204:207], a[108:111]
    ds_read_b64_tr_b16 v[76:77], v123 offset:8192
    v_mfma_f32_16x16x32_bf16 a[104:107], v[40:43], v[204:207], a[104:107]
    v_mfma_f32_16x16x32_bf16 a[100:103], v[36:39], v[204:207], a[100:103]
    ds_read_b64_tr_b16 v[78:79], v123 offset:12288
    v_mfma_f32_16x16x32_bf16 a[96:99], v[32:35], v[204:207], a[96:99]
    s_waitcnt lgkmcnt(8)
    v_xor_b32 v123, 96, v106
    v_mfma_f32_16x16x32_bf16 a[112:115], v[48:51], v[204:207], a[112:115]
    ds_read_b64_tr_b16 v[80:81], v124 offset:8192
    v_mfma_f32_16x16x32_bf16 a[116:119], v[52:55], v[204:207], a[116:119]
    v_mfma_f32_16x16x32_bf16 a[120:123], v[56:59], v[204:207], a[120:123]
    ds_read_b64_tr_b16 v[82:83], v124 offset:12288
    v_mfma_f32_16x16x32_bf16 a[124:127], v[60:63], v[204:207], a[124:127]
    v_xor_b32 v124, 128, v106
    v_mfma_f32_16x16x32_bf16 a[92:95], v[60:63], v[200:203], a[92:95]
    ds_read_b64_tr_b16 v[84:85], v125 offset:8192
    v_mfma_f32_16x16x32_bf16 a[88:91], v[56:59], v[200:203], a[88:91]
    v_mfma_f32_16x16x32_bf16 a[84:87], v[52:55], v[200:203], a[84:87]
    ds_read_b64_tr_b16 v[86:87], v125 offset:12288
    v_mfma_f32_16x16x32_bf16 a[80:83], v[48:51], v[200:203], a[80:83]
    v_xor_b32 v125, 160, v106
    v_mfma_f32_16x16x32_bf16 a[48:51], v[48:51], v[196:199], a[48:51]
    ds_read_b64_tr_b16 v[88:89], v126 offset:8192
    v_mfma_f32_16x16x32_bf16 a[52:55], v[52:55], v[196:199], a[52:55]
    v_mfma_f32_16x16x32_bf16 a[56:59], v[56:59], v[196:199], a[56:59]
    ds_read_b64_tr_b16 v[90:91], v126 offset:12288
    v_mfma_f32_16x16x32_bf16 a[60:63], v[60:63], v[196:199], a[60:63]
    v_xor_b32 v126, 192, v106
    v_mfma_f32_16x16x32_bf16 a[28:31], v[60:63], v[192:195], a[28:31]
    ds_read_b64_tr_b16 v[92:93], v127 offset:8192
    v_mfma_f32_16x16x32_bf16 a[24:27], v[56:59], v[192:195], a[24:27]
    v_mfma_f32_16x16x32_bf16 a[20:23], v[52:55], v[192:195], a[20:23]
    ds_read_b64_tr_b16 v[94:95], v127 offset:12288
    v_mfma_f32_16x16x32_bf16 a[16:19], v[48:51], v[192:195], a[16:19]
    v_xor_b32 v127, 224, v106
    s_waitcnt vmcnt(40) lgkmcnt(8)
    v_mfma_f32_16x16x32_bf16 a[0:3], v[64:67], v[208:211], a[0:3]
    ds_read_b64_tr_b16 v[32:33], v120 offset:0
    v_mfma_f32_16x16x32_bf16 a[4:7], v[68:71], v[208:211], a[4:7]
    v_mfma_f32_16x16x32_bf16 a[8:11], v[72:75], v[208:211], a[8:11]
    ds_read_b64_tr_b16 v[34:35], v120 offset:4096
    v_mfma_f32_16x16x32_bf16 a[12:15], v[76:79], v[208:211], a[12:15]
    v_mfma_f32_16x16x32_bf16 a[44:47], v[76:79], v[212:215], a[44:47]
    ds_read_b64_tr_b16 v[36:37], v121 offset:0
    v_mfma_f32_16x16x32_bf16 a[40:43], v[72:75], v[212:215], a[40:43]
    v_mfma_f32_16x16x32_bf16 a[36:39], v[68:71], v[212:215], a[36:39]
    ds_read_b64_tr_b16 v[38:39], v121 offset:4096
    v_mfma_f32_16x16x32_bf16 a[32:35], v[64:67], v[212:215], a[32:35]
    v_mfma_f32_16x16x32_bf16 a[64:67], v[64:67], v[216:219], a[64:67]
    ds_read_b64_tr_b16 v[40:41], v122 offset:0
    v_mfma_f32_16x16x32_bf16 a[68:71], v[68:71], v[216:219], a[68:71]
    v_mfma_f32_16x16x32_bf16 a[72:75], v[72:75], v[216:219], a[72:75]
    ds_read_b64_tr_b16 v[42:43], v122 offset:4096
    v_mfma_f32_16x16x32_bf16 a[76:79], v[76:79], v[216:219], a[76:79]
    v_mfma_f32_16x16x32_bf16 a[108:111], v[76:79], v[220:223], a[108:111]
    ds_read_b64_tr_b16 v[44:45], v123 offset:0
    v_mfma_f32_16x16x32_bf16 a[104:107], v[72:75], v[220:223], a[104:107]
    v_mfma_f32_16x16x32_bf16 a[100:103], v[68:71], v[220:223], a[100:103]
    ds_read_b64_tr_b16 v[46:47], v123 offset:4096
    v_mfma_f32_16x16x32_bf16 a[96:99], v[64:67], v[220:223], a[96:99]
    s_waitcnt lgkmcnt(8)
    v_mfma_f32_16x16x32_bf16 a[112:115], v[80:83], v[220:223], a[112:115]
    ds_read_b64_tr_b16 v[48:49], v124 offset:0
    s_waitcnt vmcnt(32)
    s_barrier
    v_mfma_f32_16x16x32_bf16 a[116:119], v[84:87], v[220:223], a[116:119]
    v_mfma_f32_16x16x32_bf16 a[120:123], v[88:91], v[220:223], a[120:123]
    ds_read_b64_tr_b16 v[50:51], v124 offset:4096
    v_mfma_f32_16x16x32_bf16 a[124:127], v[92:95], v[220:223], a[124:127]
    v_mfma_f32_16x16x32_bf16 a[92:95], v[92:95], v[216:219], a[92:95]
    ds_read_b64_tr_b16 v[52:53], v125 offset:0
    v_mfma_f32_16x16x32_bf16 a[88:91], v[88:91], v[216:219], a[88:91]
    v_mfma_f32_16x16x32_bf16 a[84:87], v[84:87], v[216:219], a[84:87]
    ds_read_b64_tr_b16 v[54:55], v125 offset:4096
    v_mfma_f32_16x16x32_bf16 a[80:83], v[80:83], v[216:219], a[80:83]
    v_mfma_f32_16x16x32_bf16 a[48:51], v[80:83], v[212:215], a[48:51]
    ds_read_b64_tr_b16 v[56:57], v126 offset:0
    v_mfma_f32_16x16x32_bf16 a[52:55], v[84:87], v[212:215], a[52:55]
    v_mfma_f32_16x16x32_bf16 a[56:59], v[88:91], v[212:215], a[56:59]
    ds_read_b64_tr_b16 v[58:59], v126 offset:4096
    v_mfma_f32_16x16x32_bf16 a[60:63], v[92:95], v[212:215], a[60:63]
    v_mfma_f32_16x16x32_bf16 a[28:31], v[92:95], v[208:211], a[28:31]
    ds_read_b64_tr_b16 v[60:61], v127 offset:0
    v_mfma_f32_16x16x32_bf16 a[24:27], v[88:91], v[208:211], a[24:27]
    v_mfma_f32_16x16x32_bf16 a[20:23], v[84:87], v[208:211], a[20:23]
    ds_read_b64_tr_b16 v[62:63], v127 offset:4096
    v_mfma_f32_16x16x32_bf16 a[16:19], v[80:83], v[208:211], a[16:19]
    s_waitcnt vmcnt(34) lgkmcnt(8)
    v_mfma_f32_16x16x32_bf16 a[0:3], v[32:35], v[224:227], a[0:3]
    ds_read_b64_tr_b16 v[64:65], v120 offset:8192
    v_mfma_f32_16x16x32_bf16 a[4:7], v[36:39], v[224:227], a[4:7]
    v_mfma_f32_16x16x32_bf16 a[8:11], v[40:43], v[224:227], a[8:11]
    ds_read_b64_tr_b16 v[66:67], v120 offset:12288
    v_mfma_f32_16x16x32_bf16 a[12:15], v[44:47], v[224:227], a[12:15]
    v_mfma_f32_16x16x32_bf16 a[44:47], v[44:47], v[228:231], a[44:47]
    ds_read_b64_tr_b16 v[68:69], v121 offset:8192
    v_mfma_f32_16x16x32_bf16 a[40:43], v[40:43], v[228:231], a[40:43]
    v_mfma_f32_16x16x32_bf16 a[36:39], v[36:39], v[228:231], a[36:39]
    ds_read_b64_tr_b16 v[70:71], v121 offset:12288
    v_mfma_f32_16x16x32_bf16 a[32:35], v[32:35], v[228:231], a[32:35]
    v_add_u32 v106, 65536, v105
    v_mfma_f32_16x16x32_bf16 a[64:67], v[32:35], v[232:235], a[64:67]
    ds_read_b64_tr_b16 v[72:73], v122 offset:8192
    v_mfma_f32_16x16x32_bf16 a[68:71], v[36:39], v[232:235], a[68:71]
    v_xor_b32 v120, 0, v106
    v_mfma_f32_16x16x32_bf16 a[72:75], v[40:43], v[232:235], a[72:75]
    ds_read_b64_tr_b16 v[74:75], v122 offset:12288
    v_xor_b32 v121, 32, v106
    v_mfma_f32_16x16x32_bf16 a[76:79], v[44:47], v[232:235], a[76:79]
    v_xor_b32 v122, 64, v106
    v_mfma_f32_16x16x32_bf16 a[108:111], v[44:47], v[236:239], a[108:111]
    ds_read_b64_tr_b16 v[76:77], v123 offset:8192
    v_mfma_f32_16x16x32_bf16 a[104:107], v[40:43], v[236:239], a[104:107]
    v_mfma_f32_16x16x32_bf16 a[100:103], v[36:39], v[236:239], a[100:103]
    ds_read_b64_tr_b16 v[78:79], v123 offset:12288
    v_mfma_f32_16x16x32_bf16 a[96:99], v[32:35], v[236:239], a[96:99]
    s_waitcnt lgkmcnt(8)
    v_xor_b32 v123, 96, v106
    v_mfma_f32_16x16x32_bf16 a[112:115], v[48:51], v[236:239], a[112:115]
    ds_read_b64_tr_b16 v[80:81], v124 offset:8192
    v_mfma_f32_16x16x32_bf16 a[116:119], v[52:55], v[236:239], a[116:119]
    v_mfma_f32_16x16x32_bf16 a[120:123], v[56:59], v[236:239], a[120:123]
    ds_read_b64_tr_b16 v[82:83], v124 offset:12288
    v_mfma_f32_16x16x32_bf16 a[124:127], v[60:63], v[236:239], a[124:127]
    v_xor_b32 v124, 128, v106
    v_mfma_f32_16x16x32_bf16 a[92:95], v[60:63], v[232:235], a[92:95]
    ds_read_b64_tr_b16 v[84:85], v125 offset:8192
    v_mfma_f32_16x16x32_bf16 a[88:91], v[56:59], v[232:235], a[88:91]
    v_mfma_f32_16x16x32_bf16 a[84:87], v[52:55], v[232:235], a[84:87]
    ds_read_b64_tr_b16 v[86:87], v125 offset:12288
    v_mfma_f32_16x16x32_bf16 a[80:83], v[48:51], v[232:235], a[80:83]
    v_xor_b32 v125, 160, v106
    v_mfma_f32_16x16x32_bf16 a[48:51], v[48:51], v[228:231], a[48:51]
    ds_read_b64_tr_b16 v[88:89], v126 offset:8192
    v_mfma_f32_16x16x32_bf16 a[52:55], v[52:55], v[228:231], a[52:55]
    v_mfma_f32_16x16x32_bf16 a[56:59], v[56:59], v[228:231], a[56:59]
    ds_read_b64_tr_b16 v[90:91], v126 offset:12288
    v_mfma_f32_16x16x32_bf16 a[60:63], v[60:63], v[228:231], a[60:63]
    v_xor_b32 v126, 192, v106
    v_mfma_f32_16x16x32_bf16 a[28:31], v[60:63], v[224:227], a[28:31]
    ds_read_b64_tr_b16 v[92:93], v127 offset:8192
    v_mfma_f32_16x16x32_bf16 a[24:27], v[56:59], v[224:227], a[24:27]
    v_mfma_f32_16x16x32_bf16 a[20:23], v[52:55], v[224:227], a[20:23]
    ds_read_b64_tr_b16 v[94:95], v127 offset:12288
    v_mfma_f32_16x16x32_bf16 a[16:19], v[48:51], v[224:227], a[16:19]
    v_xor_b32 v127, 224, v106
    s_waitcnt vmcnt(28) lgkmcnt(8)
    v_mfma_f32_16x16x32_bf16 a[0:3], v[64:67], v[240:243], a[0:3]
    ds_read_b64_tr_b16 v[32:33], v120 offset:0
    v_mfma_f32_16x16x32_bf16 a[4:7], v[68:71], v[240:243], a[4:7]
    v_mfma_f32_16x16x32_bf16 a[8:11], v[72:75], v[240:243], a[8:11]
    ds_read_b64_tr_b16 v[34:35], v120 offset:4096
    v_mfma_f32_16x16x32_bf16 a[12:15], v[76:79], v[240:243], a[12:15]
    v_mfma_f32_16x16x32_bf16 a[44:47], v[76:79], v[244:247], a[44:47]
    ds_read_b64_tr_b16 v[36:37], v121 offset:0
    v_mfma_f32_16x16x32_bf16 a[40:43], v[72:75], v[244:247], a[40:43]
    v_mfma_f32_16x16x32_bf16 a[36:39], v[68:71], v[244:247], a[36:39]
    ds_read_b64_tr_b16 v[38:39], v121 offset:4096
    v_mfma_f32_16x16x32_bf16 a[32:35], v[64:67], v[244:247], a[32:35]
    v_mfma_f32_16x16x32_bf16 a[64:67], v[64:67], v[248:251], a[64:67]
    ds_read_b64_tr_b16 v[40:41], v122 offset:0
    v_mfma_f32_16x16x32_bf16 a[68:71], v[68:71], v[248:251], a[68:71]
    v_mfma_f32_16x16x32_bf16 a[72:75], v[72:75], v[248:251], a[72:75]
    ds_read_b64_tr_b16 v[42:43], v122 offset:4096
    v_mfma_f32_16x16x32_bf16 a[76:79], v[76:79], v[248:251], a[76:79]
    v_mfma_f32_16x16x32_bf16 a[108:111], v[76:79], v[252:255], a[108:111]
    ds_read_b64_tr_b16 v[44:45], v123 offset:0
    v_mfma_f32_16x16x32_bf16 a[104:107], v[72:75], v[252:255], a[104:107]
    v_mfma_f32_16x16x32_bf16 a[100:103], v[68:71], v[252:255], a[100:103]
    ds_read_b64_tr_b16 v[46:47], v123 offset:4096
    v_mfma_f32_16x16x32_bf16 a[96:99], v[64:67], v[252:255], a[96:99]
    s_waitcnt lgkmcnt(8)
    v_mfma_f32_16x16x32_bf16 a[112:115], v[80:83], v[252:255], a[112:115]
    ds_read_b64_tr_b16 v[48:49], v124 offset:0
    s_waitcnt vmcnt(19)
    s_barrier
    v_mfma_f32_16x16x32_bf16 a[116:119], v[84:87], v[252:255], a[116:119]
    v_mfma_f32_16x16x32_bf16 a[120:123], v[88:91], v[252:255], a[120:123]
    ds_read_b64_tr_b16 v[50:51], v124 offset:4096
    v_mfma_f32_16x16x32_bf16 a[124:127], v[92:95], v[252:255], a[124:127]
    v_mfma_f32_16x16x32_bf16 a[92:95], v[92:95], v[248:251], a[92:95]
    ds_read_b64_tr_b16 v[52:53], v125 offset:0
    v_mfma_f32_16x16x32_bf16 a[88:91], v[88:91], v[248:251], a[88:91]
    v_mfma_f32_16x16x32_bf16 a[84:87], v[84:87], v[248:251], a[84:87]
    ds_read_b64_tr_b16 v[54:55], v125 offset:4096
    v_mfma_f32_16x16x32_bf16 a[80:83], v[80:83], v[248:251], a[80:83]
    v_mfma_f32_16x16x32_bf16 a[48:51], v[80:83], v[244:247], a[48:51]
    ds_read_b64_tr_b16 v[56:57], v126 offset:0
    v_mfma_f32_16x16x32_bf16 a[52:55], v[84:87], v[244:247], a[52:55]
    v_mfma_f32_16x16x32_bf16 a[56:59], v[88:91], v[244:247], a[56:59]
    ds_read_b64_tr_b16 v[58:59], v126 offset:4096
    v_mfma_f32_16x16x32_bf16 a[60:63], v[92:95], v[244:247], a[60:63]
    v_mfma_f32_16x16x32_bf16 a[28:31], v[92:95], v[240:243], a[28:31]
    ds_read_b64_tr_b16 v[60:61], v127 offset:0
    v_mfma_f32_16x16x32_bf16 a[24:27], v[88:91], v[240:243], a[24:27]
    v_mfma_f32_16x16x32_bf16 a[20:23], v[84:87], v[240:243], a[20:23]
    ds_read_b64_tr_b16 v[62:63], v127 offset:4096
    v_mfma_f32_16x16x32_bf16 a[16:19], v[80:83], v[240:243], a[16:19]
    s_add_u32 s16, s71, 4096
    s_add_u32 s25, s71, 8192
    s_waitcnt vmcnt(7) lgkmcnt(0)
    v_mfma_f32_16x16x32_bf16 a[16:19], v[48:51], v[128:131], a[16:19]
    ds_read_b64_tr_b16 v[64:65], v124 offset:8192
    v_mfma_f32_16x16x32_bf16 a[20:23], v[52:55], v[128:131], a[20:23]
    ds_read_b64_tr_b16 v[66:67], v124 offset:12288
    v_mfma_f32_16x16x32_bf16 a[24:27], v[56:59], v[128:131], a[24:27]
    ds_read_b64_tr_b16 v[68:69], v125 offset:8192
    v_mfma_f32_16x16x32_bf16 a[28:31], v[60:63], v[128:131], a[28:31]
    ds_read_b64_tr_b16 v[70:71], v125 offset:12288
    v_mfma_f32_16x16x32_bf16 a[60:63], v[60:63], v[132:135], a[60:63]
    ds_read_b64_tr_b16 v[72:73], v126 offset:8192
    v_mfma_f32_16x16x32_bf16 a[56:59], v[56:59], v[132:135], a[56:59]
    ds_read_b64_tr_b16 v[74:75], v126 offset:12288
    v_mfma_f32_16x16x32_bf16 a[52:55], v[52:55], v[132:135], a[52:55]
    ds_read_b64_tr_b16 v[76:77], v127 offset:8192
    v_mfma_f32_16x16x32_bf16 a[48:51], v[48:51], v[132:135], a[48:51]
    ds_read_b64_tr_b16 v[78:79], v127 offset:12288
    v_mfma_f32_16x16x32_bf16 a[80:83], v[48:51], v[136:139], a[80:83]
    ds_read_b64_tr_b16 v[80:81], v124 offset:16384
    v_mfma_f32_16x16x32_bf16 a[84:87], v[52:55], v[136:139], a[84:87]
    ds_read_b64_tr_b16 v[82:83], v124 offset:20480
    v_mfma_f32_16x16x32_bf16 a[88:91], v[56:59], v[136:139], a[88:91]
    ds_read_b64_tr_b16 v[84:85], v125 offset:16384
    v_mfma_f32_16x16x32_bf16 a[92:95], v[60:63], v[136:139], a[92:95]
    ds_read_b64_tr_b16 v[86:87], v125 offset:20480
    v_mfma_f32_16x16x32_bf16 a[124:127], v[60:63], v[140:143], a[124:127]
    ds_read_b64_tr_b16 v[88:89], v126 offset:16384
    v_mfma_f32_16x16x32_bf16 a[120:123], v[56:59], v[140:143], a[120:123]
    ds_read_b64_tr_b16 v[90:91], v126 offset:20480
    v_mfma_f32_16x16x32_bf16 a[116:119], v[52:55], v[140:143], a[116:119]
    ds_read_b64_tr_b16 v[92:93], v127 offset:16384
    v_mfma_f32_16x16x32_bf16 a[112:115], v[48:51], v[140:143], a[112:115]
    ds_read_b64_tr_b16 v[94:95], v127 offset:20480
    s_waitcnt lgkmcnt(8)
    v_mfma_f32_16x16x32_bf16 a[16:19], v[64:67], v[144:147], a[16:19]
    ds_read_b64_tr_b16 v[48:49], v124 offset:24576
    v_mfma_f32_16x16x32_bf16 a[20:23], v[68:71], v[144:147], a[20:23]
    v_mfma_f32_16x16x32_bf16 a[24:27], v[72:75], v[144:147], a[24:27]
    ds_read_b64_tr_b16 v[50:51], v124 offset:28672
    v_mfma_f32_16x16x32_bf16 a[28:31], v[76:79], v[144:147], a[28:31]
    v_mfma_f32_16x16x32_bf16 a[60:63], v[76:79], v[148:151], a[60:63]
    ds_read_b64_tr_b16 v[52:53], v125 offset:24576
    v_mfma_f32_16x16x32_bf16 a[56:59], v[72:75], v[148:151], a[56:59]
    v_mfma_f32_16x16x32_bf16 a[52:55], v[68:71], v[148:151], a[52:55]
    ds_read_b64_tr_b16 v[54:55], v125 offset:28672
    v_mfma_f32_16x16x32_bf16 a[48:51], v[64:67], v[148:151], a[48:51]
    v_mfma_f32_16x16x32_bf16 a[80:83], v[64:67], v[152:155], a[80:83]
    ds_read_b64_tr_b16 v[56:57], v126 offset:24576
    v_mfma_f32_16x16x32_bf16 a[84:87], v[68:71], v[152:155], a[84:87]
    v_mfma_f32_16x16x32_bf16 a[88:91], v[72:75], v[152:155], a[88:91]
    ds_read_b64_tr_b16 v[58:59], v126 offset:28672
    v_mfma_f32_16x16x32_bf16 a[92:95], v[76:79], v[152:155], a[92:95]
    v_mfma_f32_16x16x32_bf16 a[124:127], v[76:79], v[156:159], a[124:127]
    ds_read_b64_tr_b16 v[60:61], v127 offset:24576
    v_mfma_f32_16x16x32_bf16 a[120:123], v[72:75], v[156:159], a[120:123]
    v_mfma_f32_16x16x32_bf16 a[116:119], v[68:71], v[156:159], a[116:119]
    ds_read_b64_tr_b16 v[62:63], v127 offset:28672
    v_mfma_f32_16x16x32_bf16 a[112:115], v[64:67], v[156:159], a[112:115]
    s_waitcnt lgkmcnt(8)
    v_mfma_f32_16x16x32_bf16 a[16:19], v[80:83], v[160:163], a[16:19]
    ds_read_b64_tr_b16 v[64:65], v120 offset:8192
    v_mfma_f32_16x16x32_bf16 a[20:23], v[84:87], v[160:163], a[20:23]
    v_mfma_f32_16x16x32_bf16 a[24:27], v[88:91], v[160:163], a[24:27]
    ds_read_b64_tr_b16 v[66:67], v120 offset:12288
    v_mfma_f32_16x16x32_bf16 a[28:31], v[92:95], v[160:163], a[28:31]
    v_mfma_f32_16x16x32_bf16 a[60:63], v[92:95], v[164:167], a[60:63]
    ds_read_b64_tr_b16 v[68:69], v121 offset:8192
    v_mfma_f32_16x16x32_bf16 a[56:59], v[88:91], v[164:167], a[56:59]
    v_mfma_f32_16x16x32_bf16 a[52:55], v[84:87], v[164:167], a[52:55]
    ds_read_b64_tr_b16 v[70:71], v121 offset:12288
    v_mfma_f32_16x16x32_bf16 a[48:51], v[80:83], v[164:167], a[48:51]
    v_mfma_f32_16x16x32_bf16 a[80:83], v[80:83], v[168:171], a[80:83]
    ds_read_b64_tr_b16 v[72:73], v122 offset:8192
    v_mfma_f32_16x16x32_bf16 a[84:87], v[84:87], v[168:171], a[84:87]
    v_mfma_f32_16x16x32_bf16 a[88:91], v[88:91], v[168:171], a[88:91]
    ds_read_b64_tr_b16 v[74:75], v122 offset:12288
    v_mfma_f32_16x16x32_bf16 a[92:95], v[92:95], v[168:171], a[92:95]
    v_mfma_f32_16x16x32_bf16 a[124:127], v[92:95], v[172:175], a[124:127]
    ds_read_b64_tr_b16 v[76:77], v123 offset:8192
    v_mfma_f32_16x16x32_bf16 a[120:123], v[88:91], v[172:175], a[120:123]
    v_mfma_f32_16x16x32_bf16 a[116:119], v[84:87], v[172:175], a[116:119]
    ds_read_b64_tr_b16 v[78:79], v123 offset:12288
    v_mfma_f32_16x16x32_bf16 a[112:115], v[80:83], v[172:175], a[112:115]
    s_waitcnt lgkmcnt(8)
    v_mfma_f32_16x16x32_bf16 a[16:19], v[48:51], v[176:179], a[16:19]
    ds_read_b64_tr_b16 v[80:81], v120 offset:16384
    v_mfma_f32_16x16x32_bf16 a[20:23], v[52:55], v[176:179], a[20:23]
    v_mfma_f32_16x16x32_bf16 a[24:27], v[56:59], v[176:179], a[24:27]
    ds_read_b64_tr_b16 v[82:83], v120 offset:20480
    v_mfma_f32_16x16x32_bf16 a[28:31], v[60:63], v[176:179], a[28:31]
    v_mfma_f32_16x16x32_bf16 a[60:63], v[60:63], v[180:183], a[60:63]
    ds_read_b64_tr_b16 v[84:85], v121 offset:16384
    v_mfma_f32_16x16x32_bf16 a[56:59], v[56:59], v[180:183], a[56:59]
    v_mfma_f32_16x16x32_bf16 a[52:55], v[52:55], v[180:183], a[52:55]
    ds_read_b64_tr_b16 v[86:87], v121 offset:20480
    v_mfma_f32_16x16x32_bf16 a[48:51], v[48:51], v[180:183], a[48:51]
    v_mfma_f32_16x16x32_bf16 a[80:83], v[48:51], v[184:187], a[80:83]
    ds_read_b64_tr_b16 v[88:89], v122 offset:16384
    v_mfma_f32_16x16x32_bf16 a[84:87], v[52:55], v[184:187], a[84:87]
    v_mfma_f32_16x16x32_bf16 a[88:91], v[56:59], v[184:187], a[88:91]
    ds_read_b64_tr_b16 v[90:91], v122 offset:20480
    v_mfma_f32_16x16x32_bf16 a[92:95], v[60:63], v[184:187], a[92:95]
    v_mfma_f32_16x16x32_bf16 a[124:127], v[60:63], v[188:191], a[124:127]
    ds_read_b64_tr_b16 v[92:93], v123 offset:16384
    v_mfma_f32_16x16x32_bf16 a[120:123], v[56:59], v[188:191], a[120:123]
    v_mfma_f32_16x16x32_bf16 a[116:119], v[52:55], v[188:191], a[116:119]
    ds_read_b64_tr_b16 v[94:95], v123 offset:20480
    v_mfma_f32_16x16x32_bf16 a[112:115], v[48:51], v[188:191], a[112:115]
    v_mfma_f32_16x16x32_bf16 a[64:67], v[32:35], v[136:139], a[64:67]
    ds_read_b64_tr_b16 v[48:49], v120 offset:24576
    v_mfma_f32_16x16x32_bf16 a[68:71], v[36:39], v[136:139], a[68:71]
    ds_read_b64_tr_b16 v[50:51], v120 offset:28672
    v_mfma_f32_16x16x32_bf16 a[72:75], v[40:43], v[136:139], a[72:75]
    ds_read_b64_tr_b16 v[52:53], v121 offset:24576
    v_accvgpr_read_b32 v192, a80
    v_mfma_f32_16x16x32_bf16 a[76:79], v[44:47], v[136:139], a[76:79]
    ds_read_b64_tr_b16 v[54:55], v121 offset:28672
    v_accvgpr_read_b32 v193, a81
    v_accvgpr_read_b32 v194, a82
    v_accvgpr_read_b32 v195, a83
    v_mfma_f32_16x16x32_bf16 a[108:111], v[44:47], v[140:143], a[108:111]
    ds_read_b64_tr_b16 v[56:57], v122 offset:24576
    v_accvgpr_read_b32 v196, a84
    v_accvgpr_read_b32 v197, a85
    v_accvgpr_read_b32 v198, a86
    v_mfma_f32_16x16x32_bf16 a[104:107], v[40:43], v[140:143], a[104:107]
    ds_read_b64_tr_b16 v[58:59], v122 offset:28672
    v_accvgpr_read_b32 v199, a87
    v_cvt_pk_bf16_f32 v240, v192, v193
    v_cvt_pk_bf16_f32 v241, v194, v195
    v_mfma_f32_16x16x32_bf16 a[100:103], v[36:39], v[140:143], a[100:103]
    ds_read_b64_tr_b16 v[60:61], v123 offset:24576
    v_cvt_pk_bf16_f32 v242, v196, v197
    v_cvt_pk_bf16_f32 v243, v198, v199
    buffer_store_dwordx4 v[240:243], v104, s[12:15], s25 offen offset:0 sc1
    v_mfma_f32_16x16x32_bf16 a[96:99], v[32:35], v[140:143], a[96:99]
    ds_read_b64_tr_b16 v[62:63], v123 offset:28672
    v_accvgpr_read_b32 v200, a88
    v_accvgpr_read_b32 v201, a89
    v_accvgpr_read_b32 v202, a90
    s_waitcnt lgkmcnt(8)
    v_mfma_f32_16x16x32_bf16 a[64:67], v[64:67], v[152:155], a[64:67]
    v_accvgpr_read_b32 v203, a91
    v_accvgpr_read_b32 v204, a92
    v_accvgpr_read_b32 v205, a93
    v_mfma_f32_16x16x32_bf16 a[68:71], v[68:71], v[152:155], a[68:71]
    v_accvgpr_read_b32 v206, a94
    v_accvgpr_read_b32 v207, a95
    v_cvt_pk_bf16_f32 v244, v200, v201
    v_mfma_f32_16x16x32_bf16 a[72:75], v[72:75], v[152:155], a[72:75]
    v_cvt_pk_bf16_f32 v245, v202, v203
    v_cvt_pk_bf16_f32 v246, v204, v205
    v_cvt_pk_bf16_f32 v247, v206, v207
    v_mfma_f32_16x16x32_bf16 a[76:79], v[76:79], v[152:155], a[76:79]
    buffer_store_dwordx4 v[244:247], v104, s[12:15], s25 offen offset:1024 sc1
    v_accvgpr_read_b32 v192, a112
    v_accvgpr_read_b32 v193, a113
    v_mfma_f32_16x16x32_bf16 a[108:111], v[76:79], v[156:159], a[108:111]
    v_accvgpr_read_b32 v194, a114
    v_accvgpr_read_b32 v195, a115
    v_accvgpr_read_b32 v196, a116
    v_mfma_f32_16x16x32_bf16 a[104:107], v[72:75], v[156:159], a[104:107]
    v_accvgpr_read_b32 v197, a117
    v_accvgpr_read_b32 v198, a118
    v_accvgpr_read_b32 v199, a119
    v_mfma_f32_16x16x32_bf16 a[100:103], v[68:71], v[156:159], a[100:103]
    v_cvt_pk_bf16_f32 v248, v192, v193
    v_cvt_pk_bf16_f32 v249, v194, v195
    v_cvt_pk_bf16_f32 v250, v196, v197
    v_mfma_f32_16x16x32_bf16 a[96:99], v[64:67], v[156:159], a[96:99]
    v_cvt_pk_bf16_f32 v251, v198, v199
    buffer_store_dwordx4 v[248:251], v104, s[12:15], s25 offen offset:2048 sc1
    v_accvgpr_read_b32 v200, a120
    s_waitcnt lgkmcnt(8)
    v_mfma_f32_16x16x32_bf16 a[64:67], v[80:83], v[168:171], a[64:67]
    v_accvgpr_read_b32 v201, a121
    v_accvgpr_read_b32 v202, a122
    v_accvgpr_read_b32 v203, a123
    v_mfma_f32_16x16x32_bf16 a[68:71], v[84:87], v[168:171], a[68:71]
    v_accvgpr_read_b32 v204, a124
    v_accvgpr_read_b32 v205, a125
    v_accvgpr_read_b32 v206, a126
    v_mfma_f32_16x16x32_bf16 a[72:75], v[88:91], v[168:171], a[72:75]
    v_accvgpr_read_b32 v207, a127
    v_cvt_pk_bf16_f32 v252, v200, v201
    v_cvt_pk_bf16_f32 v253, v202, v203
    v_mfma_f32_16x16x32_bf16 a[76:79], v[92:95], v[168:171], a[76:79]
    v_cvt_pk_bf16_f32 v254, v204, v205
    v_cvt_pk_bf16_f32 v255, v206, v207
    buffer_store_dwordx4 v[252:255], v104, s[12:15], s25 offen offset:3072 sc1
    v_mfma_f32_16x16x32_bf16 a[108:111], v[92:95], v[172:175], a[108:111]
    v_accvgpr_read_b32 v192, a16
    v_accvgpr_read_b32 v193, a17
    v_accvgpr_read_b32 v194, a18
    v_mfma_f32_16x16x32_bf16 a[104:107], v[88:91], v[172:175], a[104:107]
    v_accvgpr_read_b32 v195, a19
    v_accvgpr_read_b32 v196, a20
    v_accvgpr_read_b32 v197, a21
    v_mfma_f32_16x16x32_bf16 a[100:103], v[84:87], v[172:175], a[100:103]
    v_accvgpr_read_b32 v198, a22
    v_accvgpr_read_b32 v199, a23
    v_cvt_pk_bf16_f32 v240, v192, v193
    v_mfma_f32_16x16x32_bf16 a[96:99], v[80:83], v[172:175], a[96:99]
    v_cvt_pk_bf16_f32 v241, v194, v195
    v_cvt_pk_bf16_f32 v242, v196, v197
    v_cvt_pk_bf16_f32 v243, v198, v199
    s_waitcnt lgkmcnt(0)
    v_mfma_f32_16x16x32_bf16 a[64:67], v[48:51], v[184:187], a[64:67]
    buffer_store_dwordx4 v[240:243], v104, s[12:15], s71 offen offset:0 sc1
    v_accvgpr_read_b32 v200, a24
    v_accvgpr_read_b32 v201, a25
    v_mfma_f32_16x16x32_bf16 a[68:71], v[52:55], v[184:187], a[68:71]
    v_accvgpr_read_b32 v202, a26
    v_accvgpr_read_b32 v203, a27
    v_accvgpr_read_b32 v204, a28
    v_mfma_f32_16x16x32_bf16 a[72:75], v[56:59], v[184:187], a[72:75]
    v_accvgpr_read_b32 v205, a29
    v_accvgpr_read_b32 v206, a30
    v_accvgpr_read_b32 v207, a31
    v_mfma_f32_16x16x32_bf16 a[76:79], v[60:63], v[184:187], a[76:79]
    v_cvt_pk_bf16_f32 v244, v200, v201
    v_cvt_pk_bf16_f32 v245, v202, v203
    v_cvt_pk_bf16_f32 v246, v204, v205
    v_mfma_f32_16x16x32_bf16 a[108:111], v[60:63], v[188:191], a[108:111]
    v_cvt_pk_bf16_f32 v247, v206, v207
    buffer_store_dwordx4 v[244:247], v104, s[12:15], s71 offen offset:1024 sc1
    v_accvgpr_read_b32 v192, a48
    v_mfma_f32_16x16x32_bf16 a[104:107], v[56:59], v[188:191], a[104:107]
    v_accvgpr_read_b32 v193, a49
    v_accvgpr_read_b32 v194, a50
    v_accvgpr_read_b32 v195, a51
    v_mfma_f32_16x16x32_bf16 a[100:103], v[52:55], v[188:191], a[100:103]
    v_accvgpr_read_b32 v196, a52
    v_accvgpr_read_b32 v197, a53
    v_accvgpr_read_b32 v198, a54
    v_mfma_f32_16x16x32_bf16 a[96:99], v[48:51], v[188:191], a[96:99]
    v_accvgpr_read_b32 v199, a55
    v_cvt_pk_bf16_f32 v248, v192, v193
    v_cvt_pk_bf16_f32 v249, v194, v195
    v_mfma_f32_16x16x32_bf16 a[0:3], v[32:35], v[128:131], a[0:3]
    v_cvt_pk_bf16_f32 v250, v196, v197
    v_cvt_pk_bf16_f32 v251, v198, v199
    buffer_store_dwordx4 v[248:251], v104, s[12:15], s71 offen offset:2048 sc1
    v_mfma_f32_16x16x32_bf16 a[4:7], v[36:39], v[128:131], a[4:7]
    v_accvgpr_read_b32 v200, a56
    v_accvgpr_read_b32 v201, a57
    v_accvgpr_read_b32 v202, a58
    v_mfma_f32_16x16x32_bf16 a[8:11], v[40:43], v[128:131], a[8:11]
    v_accvgpr_read_b32 v203, a59
    v_accvgpr_read_b32 v204, a60
    v_accvgpr_read_b32 v205, a61
    v_mfma_f32_16x16x32_bf16 a[12:15], v[44:47], v[128:131], a[12:15]
    v_accvgpr_read_b32 v206, a62
    v_accvgpr_read_b32 v207, a63
    v_cvt_pk_bf16_f32 v252, v200, v201
    v_mfma_f32_16x16x32_bf16 a[44:47], v[44:47], v[132:135], a[44:47]
    v_cvt_pk_bf16_f32 v253, v202, v203
    v_cvt_pk_bf16_f32 v254, v204, v205
    v_cvt_pk_bf16_f32 v255, v206, v207
    v_mfma_f32_16x16x32_bf16 a[40:43], v[40:43], v[132:135], a[40:43]
    buffer_store_dwordx4 v[252:255], v104, s[12:15], s71 offen offset:3072 sc1
    v_accvgpr_read_b32 v192, a64
    v_accvgpr_read_b32 v193, a65
    v_mfma_f32_16x16x32_bf16 a[36:39], v[36:39], v[132:135], a[36:39]
    v_accvgpr_read_b32 v194, a66
    v_accvgpr_read_b32 v195, a67
    v_accvgpr_read_b32 v196, a68
    v_mfma_f32_16x16x32_bf16 a[32:35], v[32:35], v[132:135], a[32:35]
    v_accvgpr_read_b32 v197, a69
    v_accvgpr_read_b32 v198, a70
    v_accvgpr_read_b32 v199, a71
    v_mfma_f32_16x16x32_bf16 a[0:3], v[64:67], v[144:147], a[0:3]
    v_cvt_pk_bf16_f32 v224, v192, v193
    v_cvt_pk_bf16_f32 v225, v194, v195
    v_cvt_pk_bf16_f32 v226, v196, v197
    v_mfma_f32_16x16x32_bf16 a[4:7], v[68:71], v[144:147], a[4:7]
    v_cvt_pk_bf16_f32 v227, v198, v199
    buffer_store_dwordx4 v[224:227], v104, s[12:15], s16 offen offset:0 sc1
    v_accvgpr_read_b32 v200, a72
    v_mfma_f32_16x16x32_bf16 a[8:11], v[72:75], v[144:147], a[8:11]
    v_accvgpr_read_b32 v201, a73
    v_accvgpr_read_b32 v202, a74
    v_accvgpr_read_b32 v203, a75
    v_mfma_f32_16x16x32_bf16 a[12:15], v[76:79], v[144:147], a[12:15]
    v_accvgpr_read_b32 v204, a76
    v_accvgpr_read_b32 v205, a77
    v_accvgpr_read_b32 v206, a78
    v_mfma_f32_16x16x32_bf16 a[44:47], v[76:79], v[148:151], a[44:47]
    v_accvgpr_read_b32 v207, a79
    v_cvt_pk_bf16_f32 v228, v200, v201
    v_cvt_pk_bf16_f32 v229, v202, v203
    v_mfma_f32_16x16x32_bf16 a[40:43], v[72:75], v[148:151], a[40:43]
    v_cvt_pk_bf16_f32 v230, v204, v205
    v_cvt_pk_bf16_f32 v231, v206, v207
    buffer_store_dwordx4 v[228:231], v104, s[12:15], s16 offen offset:1024 sc1
    v_mfma_f32_16x16x32_bf16 a[36:39], v[68:71], v[148:151], a[36:39]
    v_accvgpr_read_b32 v192, a96
    v_accvgpr_read_b32 v193, a97
    v_accvgpr_read_b32 v194, a98
    v_mfma_f32_16x16x32_bf16 a[32:35], v[64:67], v[148:151], a[32:35]
    v_accvgpr_read_b32 v195, a99
    v_accvgpr_read_b32 v196, a100
    v_accvgpr_read_b32 v197, a101
    v_mfma_f32_16x16x32_bf16 a[0:3], v[80:83], v[160:163], a[0:3]
    v_accvgpr_read_b32 v198, a102
    v_accvgpr_read_b32 v199, a103
    v_cvt_pk_bf16_f32 v232, v192, v193
    v_mfma_f32_16x16x32_bf16 a[4:7], v[84:87], v[160:163], a[4:7]
    v_cvt_pk_bf16_f32 v233, v194, v195
    v_cvt_pk_bf16_f32 v234, v196, v197
    v_cvt_pk_bf16_f32 v235, v198, v199
    v_mfma_f32_16x16x32_bf16 a[8:11], v[88:91], v[160:163], a[8:11]
    buffer_store_dwordx4 v[232:235], v104, s[12:15], s16 offen offset:2048 sc1
    v_accvgpr_read_b32 v200, a104
    v_accvgpr_read_b32 v201, a105
    v_mfma_f32_16x16x32_bf16 a[12:15], v[92:95], v[160:163], a[12:15]
    v_accvgpr_read_b32 v202, a106
    v_accvgpr_read_b32 v203, a107
    v_accvgpr_read_b32 v204, a108
    v_mfma_f32_16x16x32_bf16 a[44:47], v[92:95], v[164:167], a[44:47]
    v_accvgpr_read_b32 v205, a109
    v_accvgpr_read_b32 v206, a110
    v_accvgpr_read_b32 v207, a111
    v_mfma_f32_16x16x32_bf16 a[40:43], v[88:91], v[164:167], a[40:43]
    v_cvt_pk_bf16_f32 v236, v200, v201
    v_cvt_pk_bf16_f32 v237, v202, v203
    v_cvt_pk_bf16_f32 v238, v204, v205
    v_mfma_f32_16x16x32_bf16 a[36:39], v[84:87], v[164:167], a[36:39]
    v_cvt_pk_bf16_f32 v239, v206, v207
    buffer_store_dwordx4 v[236:239], v104, s[12:15], s16 offen offset:3072 sc1
    v_mfma_f32_16x16x32_bf16 a[32:35], v[80:83], v[164:167], a[32:35]
    v_mfma_f32_16x16x32_bf16 a[0:3], v[48:51], v[176:179], a[0:3]
    v_mfma_f32_16x16x32_bf16 a[4:7], v[52:55], v[176:179], a[4:7]
    v_mfma_f32_16x16x32_bf16 a[8:11], v[56:59], v[176:179], a[8:11]
    v_mfma_f32_16x16x32_bf16 a[12:15], v[60:63], v[176:179], a[12:15]
    v_mfma_f32_16x16x32_bf16 a[44:47], v[60:63], v[180:183], a[44:47]
    v_mfma_f32_16x16x32_bf16 a[40:43], v[56:59], v[180:183], a[40:43]
    v_mfma_f32_16x16x32_bf16 a[36:39], v[52:55], v[180:183], a[36:39]
    v_mfma_f32_16x16x32_bf16 a[32:35], v[48:51], v[180:183], a[32:35]
    s_mul_i32 s26, s3, 4608
    s_add_u32 s26, s26, 131072
    v_lshrrev_b32 v4, 2, v1
    v_mul_u32_u24 v4, 288, v4
    v_and_b32 v5, 3, v1
    v_lshl_add_u32 v4, v5, 4, v4
    v_add_u32 v4, s26, v4
    v_and_b32 v5, 31, v1
    v_mul_u32_u24 v5, 144, v5
    v_add_u32 v5, s26, v5

    ds_write_b128 v4, a[136:139] offset:0
    ds_write_b128 v4, a[140:143] offset:144
    ds_write_b128 v4, a[144:147] offset:64
    ds_write_b128 v4, a[148:151] offset:208
    ds_write_b32 v5, a152 offset:128
    v_and_b32 v4, 15, v1
    v_mul_u32_u24 v4, 144, v4
    v_lshrrev_b32 v5, 4, v1
    v_lshlrev_b32 v5, 3, v5
    v_sub_u32 v6, 24, v5
    v_cndmask_b32 v5, v5, v6, s[46:47]
    v_add3_u32 v4, v4, v5, s26

    s_waitcnt vmcnt(0) lgkmcnt(0)
    buffer_store_dwordx2 v[26:27], v23, s[12:15], s69 offen sc1
    ds_read_b64 v[128:129], v4 offset:0
    ds_read_b32 v130, v4 offset:8
    ds_read_b64 v[132:133], v4 offset:32
    ds_read_b32 v134, v4 offset:40
    ds_read_b64 v[136:137], v4 offset:64
    ds_read_b32 v138, v4 offset:72
    ds_read_b64 v[140:141], v4 offset:96
    ds_read_b32 v142, v4 offset:104
    ds_read_b64 v[144:145], v4 offset:2304
    ds_read_b32 v146, v4 offset:2312
    ds_read_b64 v[148:149], v4 offset:2336
    ds_read_b32 v150, v4 offset:2344
    ds_read_b64 v[152:153], v4 offset:2368
    ds_read_b32 v154, v4 offset:2376
    ds_read_b64 v[156:157], v4 offset:2400
    ds_read_b32 v158, v4 offset:2408
    v_add_u32 v6, 1, v1
    v_lshlrev_b32 v6, 10, v6
    v_xor_b32 v6, s69, v6
    v_cmp_gt_u32 vcc, 3, v1
    s_lshl_b32 s26, s2, 2
    s_add_u32 s26, s26, s3
    v_cndmask_b32 v109, v107, v6, vcc

    s_xor_b32 s27, s26, 8
    s_mul_i32 s41, s27, 12288
    s_add_u32 s41, s41, 27262976
    s_xor_b32 s27, s26, 16
    s_mul_i32 s42, s27, 12288
    s_add_u32 s42, s42, 27267072
    s_xor_b32 s27, s26, 24
    s_mul_i32 s43, s27, 12288
    s_add_u32 s43, s43, 27271168
    v_accvgpr_read_b32 v40, a160
    v_accvgpr_read_b32 v41, a161
    v_accvgpr_read_b32 v42, a162
    v_accvgpr_read_b32 v43, a163
    v_add_f32 v40, v40, v41
    v_add_f32 v42, v42, v43
    v_add_f32 v40, v40, v42
    v_cvt_pk_bf16_f32 v40, v40, v40
    v_lshlrev_b32 v40, 16, v40
    v_mul_f32 v40, 3216550459, v40
    v_exp_f32 v40, v40
    s_nop 0
    v_add_f32 v40, 1.0, v40
    v_rcp_f32 v40, v40
    s_nop 0
    v_cvt_pk_bf16_f32 v40, v40, v40
    v_lshlrev_b32 v32, 16, v40
    v_sub_f32 v40, 1.0, v32
    v_cvt_pk_bf16_f32 v40, v40, v40
    v_lshlrev_b32 v34, 16, v40
    v_and_b32 v36, 0xffff, v40

    v_accvgpr_read_b32 v40, a164
    v_accvgpr_read_b32 v41, a165
    v_accvgpr_read_b32 v42, a166
    v_accvgpr_read_b32 v43, a167
    v_add_f32 v40, v40, v41
    v_add_f32 v42, v42, v43
    v_add_f32 v40, v40, v42
    v_cvt_pk_bf16_f32 v40, v40, v40
    v_lshlrev_b32 v40, 16, v40
    v_mul_f32 v40, 3216550459, v40
    v_exp_f32 v40, v40
    s_nop 0
    v_add_f32 v40, 1.0, v40
    v_rcp_f32 v40, v40
    s_nop 0
    v_cvt_pk_bf16_f32 v40, v40, v40
    v_lshlrev_b32 v33, 16, v40
    v_sub_f32 v40, 1.0, v33
    v_cvt_pk_bf16_f32 v40, v40, v40
    v_lshlrev_b32 v35, 16, v40
    v_and_b32 v37, 0xffff, v40

    v_accvgpr_read_b32 v64, a0
    v_accvgpr_read_b32 v65, a1
    v_accvgpr_read_b32 v66, a2
    v_accvgpr_read_b32 v67, a3
    v_accvgpr_read_b32 v68, a4
    v_accvgpr_read_b32 v69, a5
    v_accvgpr_read_b32 v70, a6
    v_accvgpr_read_b32 v71, a7
    v_accvgpr_read_b32 v72, a8
    v_accvgpr_read_b32 v73, a9
    v_accvgpr_read_b32 v74, a10
    v_accvgpr_read_b32 v75, a11
    v_accvgpr_read_b32 v76, a12
    v_accvgpr_read_b32 v77, a13
    v_accvgpr_read_b32 v78, a14
    v_accvgpr_read_b32 v79, a15
    v_accvgpr_read_b32 v80, a32
    v_accvgpr_read_b32 v81, a33
    v_accvgpr_read_b32 v82, a34
    v_accvgpr_read_b32 v83, a35
    v_accvgpr_read_b32 v84, a36
    v_accvgpr_read_b32 v85, a37
    v_accvgpr_read_b32 v86, a38
    v_accvgpr_read_b32 v87, a39
    v_accvgpr_read_b32 v88, a40
    v_accvgpr_read_b32 v89, a41
    v_accvgpr_read_b32 v90, a42
    v_accvgpr_read_b32 v91, a43
    v_accvgpr_read_b32 v92, a44
    v_accvgpr_read_b32 v93, a45
    v_accvgpr_read_b32 v94, a46
    v_accvgpr_read_b32 v95, a47
    v_mul_f32 v64, v34, v64
    v_mul_f32 v65, v34, v65
    v_mul_f32 v66, v34, v66
    v_mul_f32 v67, v34, v67
    v_mul_f32 v68, v34, v68
    v_mul_f32 v69, v34, v69
    v_mul_f32 v70, v34, v70
    v_mul_f32 v71, v34, v71
    v_mul_f32 v72, v34, v72
    v_mul_f32 v73, v34, v73
    v_mul_f32 v74, v34, v74
    v_mul_f32 v75, v34, v75
    v_mul_f32 v76, v34, v76
    v_mul_f32 v77, v34, v77
    v_mul_f32 v78, v34, v78
    v_mul_f32 v79, v34, v79
    v_mul_f32 v80, v35, v80
    v_mul_f32 v81, v35, v81
    v_mul_f32 v82, v35, v82
    v_mul_f32 v83, v35, v83
    v_mul_f32 v84, v35, v84
    v_mul_f32 v85, v35, v85
    v_mul_f32 v86, v35, v86
    v_mul_f32 v87, v35, v87
    v_mul_f32 v88, v35, v88
    v_mul_f32 v89, v35, v89
    v_mul_f32 v90, v35, v90
    v_mul_f32 v91, v35, v91
    v_mul_f32 v92, v35, v92
    v_mul_f32 v93, v35, v93
    v_mul_f32 v94, v35, v94
    v_mul_f32 v95, v35, v95
    buffer_load_dwordx2 v[24:25], v109, s[12:15], 0 offen sc1
    s_waitcnt lgkmcnt(0)
    s_cmp_lg_u32 s46, 0
    s_cbranch_scc1 L_g2_mir
    v_lshlrev_b32 v40, 16, v128
    v_and_b32 v41, 0xffff0000, v128
    v_lshlrev_b32 v42, 16, v129
    v_and_b32 v43, 0xffff0000, v129
    v_fma_f32 v64, v40, v32, v64
    v_fma_f32 v65, v41, v32, v65
    v_fma_f32 v66, v42, v32, v66
    v_fma_f32 v67, v43, v32, v67
    v_lshlrev_b32 v40, 16, v132
    v_and_b32 v41, 0xffff0000, v132
    v_lshlrev_b32 v42, 16, v133
    v_and_b32 v43, 0xffff0000, v133
    v_fma_f32 v68, v40, v32, v68
    v_fma_f32 v69, v41, v32, v69
    v_fma_f32 v70, v42, v32, v70
    v_fma_f32 v71, v43, v32, v71
    v_lshlrev_b32 v40, 16, v136
    v_and_b32 v41, 0xffff0000, v136
    v_lshlrev_b32 v42, 16, v137
    v_and_b32 v43, 0xffff0000, v137
    v_fma_f32 v72, v40, v32, v72
    v_fma_f32 v73, v41, v32, v73
    v_fma_f32 v74, v42, v32, v74
    v_fma_f32 v75, v43, v32, v75
    v_lshlrev_b32 v40, 16, v140
    v_and_b32 v41, 0xffff0000, v140
    v_lshlrev_b32 v42, 16, v141
    v_and_b32 v43, 0xffff0000, v141
    v_fma_f32 v76, v40, v32, v76
    v_fma_f32 v77, v41, v32, v77
    v_fma_f32 v78, v42, v32, v78
    v_fma_f32 v79, v43, v32, v79
    v_lshlrev_b32 v40, 16, v144
    v_and_b32 v41, 0xffff0000, v144
    v_lshlrev_b32 v42, 16, v145
    v_and_b32 v43, 0xffff0000, v145
    v_fma_f32 v80, v40, v33, v80
    v_fma_f32 v81, v41, v33, v81
    v_fma_f32 v82, v42, v33, v82
    v_fma_f32 v83, v43, v33, v83
    v_lshlrev_b32 v40, 16, v148
    v_and_b32 v41, 0xffff0000, v148
    v_lshlrev_b32 v42, 16, v149
    v_and_b32 v43, 0xffff0000, v149
    v_fma_f32 v84, v40, v33, v84
    v_fma_f32 v85, v41, v33, v85
    v_fma_f32 v86, v42, v33, v86
    v_fma_f32 v87, v43, v33, v87
    v_lshlrev_b32 v40, 16, v152
    v_and_b32 v41, 0xffff0000, v152
    v_lshlrev_b32 v42, 16, v153
    v_and_b32 v43, 0xffff0000, v153
    v_fma_f32 v88, v40, v33, v88
    v_fma_f32 v89, v41, v33, v89
    v_fma_f32 v90, v42, v33, v90
    v_fma_f32 v91, v43, v33, v91
    v_lshlrev_b32 v40, 16, v156
    v_and_b32 v41, 0xffff0000, v156
    v_lshlrev_b32 v42, 16, v157
    v_and_b32 v43, 0xffff0000, v157
    v_fma_f32 v92, v40, v33, v92
    v_fma_f32 v93, v41, v33, v93
    v_fma_f32 v94, v42, v33, v94
    v_fma_f32 v95, v43, v33, v95
    s_branch L_g2_st
L_g2_mir:
    v_lshlrev_b32 v40, 16, v142
    v_and_b32 v41, 0xffff0000, v141
    v_lshlrev_b32 v42, 16, v141
    v_and_b32 v43, 0xffff0000, v140
    v_fma_f32 v64, v40, v32, v64
    v_fma_f32 v65, v41, v32, v65
    v_fma_f32 v66, v42, v32, v66
    v_fma_f32 v67, v43, v32, v67
    v_lshlrev_b32 v40, 16, v138
    v_and_b32 v41, 0xffff0000, v137
    v_lshlrev_b32 v42, 16, v137
    v_and_b32 v43, 0xffff0000, v136
    v_fma_f32 v68, v40, v32, v68
    v_fma_f32 v69, v41, v32, v69
    v_fma_f32 v70, v42, v32, v70
    v_fma_f32 v71, v43, v32, v71
    v_lshlrev_b32 v40, 16, v134
    v_and_b32 v41, 0xffff0000, v133
    v_lshlrev_b32 v42, 16, v133
    v_and_b32 v43, 0xffff0000, v132
    v_fma_f32 v72, v40, v32, v72
    v_fma_f32 v73, v41, v32, v73
    v_fma_f32 v74, v42, v32, v74
    v_fma_f32 v75, v43, v32, v75
    v_lshlrev_b32 v40, 16, v130
    v_and_b32 v41, 0xffff0000, v129
    v_lshlrev_b32 v42, 16, v129
    v_and_b32 v43, 0xffff0000, v128
    v_fma_f32 v76, v40, v32, v76
    v_fma_f32 v77, v41, v32, v77
    v_fma_f32 v78, v42, v32, v78
    v_fma_f32 v79, v43, v32, v79
    v_lshlrev_b32 v40, 16, v158
    v_and_b32 v41, 0xffff0000, v157
    v_lshlrev_b32 v42, 16, v157
    v_and_b32 v43, 0xffff0000, v156
    v_fma_f32 v80, v40, v33, v80
    v_fma_f32 v81, v41, v33, v81
    v_fma_f32 v82, v42, v33, v82
    v_fma_f32 v83, v43, v33, v83
    v_lshlrev_b32 v40, 16, v154
    v_and_b32 v41, 0xffff0000, v153
    v_lshlrev_b32 v42, 16, v153
    v_and_b32 v43, 0xffff0000, v152
    v_fma_f32 v84, v40, v33, v84
    v_fma_f32 v85, v41, v33, v85
    v_fma_f32 v86, v42, v33, v86
    v_fma_f32 v87, v43, v33, v87
    v_lshlrev_b32 v40, 16, v150
    v_and_b32 v41, 0xffff0000, v149
    v_lshlrev_b32 v42, 16, v149
    v_and_b32 v43, 0xffff0000, v148
    v_fma_f32 v88, v40, v33, v88
    v_fma_f32 v89, v41, v33, v89
    v_fma_f32 v90, v42, v33, v90
    v_fma_f32 v91, v43, v33, v91
    v_lshlrev_b32 v40, 16, v146
    v_and_b32 v41, 0xffff0000, v145
    v_lshlrev_b32 v42, 16, v145
    v_and_b32 v43, 0xffff0000, v144
    v_fma_f32 v92, v40, v33, v92
    v_fma_f32 v93, v41, v33, v93
    v_fma_f32 v94, v42, v33, v94
    v_fma_f32 v95, v43, v33, v95
L_g2_st:
    s_waitcnt vmcnt(0)
    v_cmp_ne_u32 vcc, s98, v24
    v_cmp_ne_u32 s[28:29], s99, v25
    s_or_b64 vcc, vcc, s[28:29]
    s_and_b64 vcc, vcc, 7
    s_cbranch_scc0 L_g2_xok
    s_mov_b32 s26, 0
    s_mov_b32 s27, 0
    buffer_load_dwordx2 v[44:45], v109, s[12:15], s26 offen sc1
    s_sleep 4
    buffer_load_dwordx2 v[46:47], v109, s[12:15], s26 offen sc1
    s_sleep 4
L_poll_8792:
    buffer_load_dwordx2 v[48:49], v109, s[12:15], s26 offen sc1
    s_waitcnt vmcnt(2)
    v_cmp_ne_u32 vcc, s98, v44
    v_cmp_ne_u32 s[28:29], s99, v45
    s_or_b64 vcc, vcc, s[28:29]
    s_and_b64 s[64:65], vcc, 7
    s_cbranch_scc0 L_poll_8792_done
    s_sleep 1
    buffer_load_dwordx2 v[44:45], v109, s[12:15], s26 offen sc1
    s_waitcnt vmcnt(2)
    v_cmp_ne_u32 vcc, s98, v46
    v_cmp_ne_u32 s[28:29], s99, v47
    s_or_b64 vcc, vcc, s[28:29]
    s_and_b64 s[64:65], vcc, 7
    s_cbranch_scc0 L_poll_8792_done
    s_sleep 1
    buffer_load_dwordx2 v[46:47], v109, s[12:15], s26 offen sc1
    s_waitcnt vmcnt(2)
    v_cmp_ne_u32 vcc, s98, v48
    v_cmp_ne_u32 s[28:29], s99, v49
    s_or_b64 vcc, vcc, s[28:29]
    s_and_b64 s[64:65], vcc, 7
    s_cbranch_scc0 L_poll_8792_done
    s_sleep 1
    s_add_u32 s27, s27, 1
    s_cmp_lt_u32 s27, 0x20000
    s_cbranch_scc1 L_poll_8792
L_poll_8792_done:

L_g2_xok:
    buffer_load_dwordx4 v[160:163], v104, s[12:15], s41 offen offset:0 sc1
    buffer_load_dwordx4 v[164:167], v104, s[12:15], s42 offen offset:0 sc1
    buffer_load_dwordx4 v[168:171], v104, s[12:15], s43 offen offset:0 sc1
    buffer_load_dwordx4 v[172:175], v104, s[12:15], s41 offen offset:1024 sc1
    buffer_load_dwordx4 v[176:179], v104, s[12:15], s42 offen offset:1024 sc1
    buffer_load_dwordx4 v[180:183], v104, s[12:15], s43 offen offset:1024 sc1
    buffer_load_dwordx4 v[184:187], v104, s[12:15], s41 offen offset:2048 sc1
    buffer_load_dwordx4 v[188:191], v104, s[12:15], s42 offen offset:2048 sc1
    buffer_load_dwordx4 v[192:195], v104, s[12:15], s43 offen offset:2048 sc1
    buffer_load_dwordx4 v[196:199], v104, s[12:15], s41 offen offset:3072 sc1
    buffer_load_dwordx4 v[200:203], v104, s[12:15], s42 offen offset:3072 sc1
    buffer_load_dwordx4 v[204:207], v104, s[12:15], s43 offen offset:3072 sc1
L_g2_x1:
    s_waitcnt vmcnt(9)
    v_dot2_f32_bf16 v64, v160, v36, v64
    v_dot2_f32_bf16 v65, v160, v34, v65
    v_dot2_f32_bf16 v66, v161, v36, v66
    v_dot2_f32_bf16 v67, v161, v34, v67
    v_dot2_f32_bf16 v68, v162, v36, v68
    v_dot2_f32_bf16 v69, v162, v34, v69
    v_dot2_f32_bf16 v70, v163, v36, v70
    v_dot2_f32_bf16 v71, v163, v34, v71
    v_dot2_f32_bf16 v64, v164, v36, v64
    v_dot2_f32_bf16 v65, v164, v34, v65
    v_dot2_f32_bf16 v66, v165, v36, v66
    v_dot2_f32_bf16 v67, v165, v34, v67
    v_dot2_f32_bf16 v68, v166, v36, v68
    v_dot2_f32_bf16 v69, v166, v34, v69
    v_dot2_f32_bf16 v70, v167, v36, v70
    v_dot2_f32_bf16 v71, v167, v34, v71
    v_dot2_f32_bf16 v64, v168, v36, v64
    v_dot2_f32_bf16 v65, v168, v34, v65
    v_dot2_f32_bf16 v66, v169, v36, v66
    v_dot2_f32_bf16 v67, v169, v34, v67
    v_dot2_f32_bf16 v68, v170, v36, v68
    v_dot2_f32_bf16 v69, v170, v34, v69
    v_dot2_f32_bf16 v70, v171, v36, v70
    v_dot2_f32_bf16 v71, v171, v34, v71
    s_nop 2
    v_cvt_pk_bf16_f32 v208, v64, v65
    v_cvt_pk_bf16_f32 v209, v66, v67
    v_cvt_pk_bf16_f32 v210, v68, v69
    v_cvt_pk_bf16_f32 v211, v70, v71
    s_nop 1
    v_permlane16_swap_b32 v208, v210
    v_permlane16_swap_b32 v209, v211
    buffer_store_dwordx4 v[208:211], v112, s[52:55], 0 offen offset:0 nt
    s_waitcnt vmcnt(7)
    v_dot2_f32_bf16 v72, v172, v36, v72
    v_dot2_f32_bf16 v73, v172, v34, v73
    v_dot2_f32_bf16 v74, v173, v36, v74
    v_dot2_f32_bf16 v75, v173, v34, v75
    v_dot2_f32_bf16 v76, v174, v36, v76
    v_dot2_f32_bf16 v77, v174, v34, v77
    v_dot2_f32_bf16 v78, v175, v36, v78
    v_dot2_f32_bf16 v79, v175, v34, v79
    v_dot2_f32_bf16 v72, v176, v36, v72
    v_dot2_f32_bf16 v73, v176, v34, v73
    v_dot2_f32_bf16 v74, v177, v36, v74
    v_dot2_f32_bf16 v75, v177, v34, v75
    v_dot2_f32_bf16 v76, v178, v36, v76
    v_dot2_f32_bf16 v77, v178, v34, v77
    v_dot2_f32_bf16 v78, v179, v36, v78
    v_dot2_f32_bf16 v79, v179, v34, v79
    v_dot2_f32_bf16 v72, v180, v36, v72
    v_dot2_f32_bf16 v73, v180, v34, v73
    v_dot2_f32_bf16 v74, v181, v36, v74
    v_dot2_f32_bf16 v75, v181, v34, v75
    v_dot2_f32_bf16 v76, v182, v36, v76
    v_dot2_f32_bf16 v77, v182, v34, v77
    v_dot2_f32_bf16 v78, v183, v36, v78
    v_dot2_f32_bf16 v79, v183, v34, v79
    s_nop 2
    v_cvt_pk_bf16_f32 v212, v72, v73
    v_cvt_pk_bf16_f32 v213, v74, v75
    v_cvt_pk_bf16_f32 v214, v76, v77
    v_cvt_pk_bf16_f32 v215, v78, v79
    s_nop 1
    v_permlane16_swap_b32 v212, v214
    v_permlane16_swap_b32 v213, v215
    buffer_store_dwordx4 v[212:215], v112, s[52:55], 0 offen offset:64 nt
    s_waitcnt vmcnt(5)
    v_dot2_f32_bf16 v80, v184, v37, v80
    v_dot2_f32_bf16 v81, v184, v35, v81
    v_dot2_f32_bf16 v82, v185, v37, v82
    v_dot2_f32_bf16 v83, v185, v35, v83
    v_dot2_f32_bf16 v84, v186, v37, v84
    v_dot2_f32_bf16 v85, v186, v35, v85
    v_dot2_f32_bf16 v86, v187, v37, v86
    v_dot2_f32_bf16 v87, v187, v35, v87
    v_dot2_f32_bf16 v80, v188, v37, v80
    v_dot2_f32_bf16 v81, v188, v35, v81
    v_dot2_f32_bf16 v82, v189, v37, v82
    v_dot2_f32_bf16 v83, v189, v35, v83
    v_dot2_f32_bf16 v84, v190, v37, v84
    v_dot2_f32_bf16 v85, v190, v35, v85
    v_dot2_f32_bf16 v86, v191, v37, v86
    v_dot2_f32_bf16 v87, v191, v35, v87
    v_dot2_f32_bf16 v80, v192, v37, v80
    v_dot2_f32_bf16 v81, v192, v35, v81
    v_dot2_f32_bf16 v82, v193, v37, v82
    v_dot2_f32_bf16 v83, v193, v35, v83
    v_dot2_f32_bf16 v84, v194, v37, v84
    v_dot2_f32_bf16 v85, v194, v35, v85
    v_dot2_f32_bf16 v86, v195, v37, v86
    v_dot2_f32_bf16 v87, v195, v35, v87
    s_nop 2
    v_cvt_pk_bf16_f32 v216, v80, v81
    v_cvt_pk_bf16_f32 v217, v82, v83
    v_cvt_pk_bf16_f32 v218, v84, v85
    v_cvt_pk_bf16_f32 v219, v86, v87
    s_nop 1
    v_permlane16_swap_b32 v216, v218
    v_permlane16_swap_b32 v217, v219
    buffer_store_dwordx4 v[216:219], v113, s[52:55], 0 offen offset:0 nt
    s_waitcnt vmcnt(3)
    v_dot2_f32_bf16 v88, v196, v37, v88
    v_dot2_f32_bf16 v89, v196, v35, v89
    v_dot2_f32_bf16 v90, v197, v37, v90
    v_dot2_f32_bf16 v91, v197, v35, v91
    v_dot2_f32_bf16 v92, v198, v37, v92
    v_dot2_f32_bf16 v93, v198, v35, v93
    v_dot2_f32_bf16 v94, v199, v37, v94
    v_dot2_f32_bf16 v95, v199, v35, v95
    v_dot2_f32_bf16 v88, v200, v37, v88
    v_dot2_f32_bf16 v89, v200, v35, v89
    v_dot2_f32_bf16 v90, v201, v37, v90
    v_dot2_f32_bf16 v91, v201, v35, v91
    v_dot2_f32_bf16 v92, v202, v37, v92
    v_dot2_f32_bf16 v93, v202, v35, v93
    v_dot2_f32_bf16 v94, v203, v37, v94
    v_dot2_f32_bf16 v95, v203, v35, v95
    v_dot2_f32_bf16 v88, v204, v37, v88
    v_dot2_f32_bf16 v89, v204, v35, v89
    v_dot2_f32_bf16 v90, v205, v37, v90
    v_dot2_f32_bf16 v91, v205, v35, v91
    v_dot2_f32_bf16 v92, v206, v37, v92
    v_dot2_f32_bf16 v93, v206, v35, v93
    v_dot2_f32_bf16 v94, v207, v37, v94
    v_dot2_f32_bf16 v95, v207, v35, v95
    s_nop 2
    v_cvt_pk_bf16_f32 v220, v88, v89
    v_cvt_pk_bf16_f32 v221, v90, v91
    v_cvt_pk_bf16_f32 v222, v92, v93
    v_cvt_pk_bf16_f32 v223, v94, v95
    s_nop 1
    v_permlane16_swap_b32 v220, v222
    v_permlane16_swap_b32 v221, v223
    buffer_store_dwordx4 v[220:223], v113, s[52:55], 0 offen offset:64 nt
    s_branch L_end
L_g2_late0:
    s_mov_b32 s27, 0
    buffer_load_dwordx2 v[10:11], v109, s[12:15], s44 offen sc1
    s_sleep 4
    buffer_load_dwordx2 v[12:13], v109, s[12:15], s44 offen sc1
    s_sleep 4
L_poll_8979:
    buffer_load_dwordx2 v[14:15], v109, s[12:15], s44 offen sc1
    s_waitcnt vmcnt(2)
    v_cmp_ne_u32 vcc, s98, v10
    v_cmp_ne_u32 s[28:29], s99, v11
    s_or_b64 vcc, vcc, s[28:29]
    s_and_b64 s[64:65], vcc, 63
    s_cbranch_scc0 L_poll_8979_done
    s_sleep 2
    buffer_load_dwordx2 v[10:11], v109, s[12:15], s44 offen sc1
    s_waitcnt vmcnt(2)
    v_cmp_ne_u32 vcc, s98, v12
    v_cmp_ne_u32 s[28:29], s99, v13
    s_or_b64 vcc, vcc, s[28:29]
    s_and_b64 s[64:65], vcc, 63
    s_cbranch_scc0 L_poll_8979_done
    s_sleep 2
    buffer_load_dwordx2 v[12:13], v109, s[12:15], s44 offen sc1
    s_waitcnt vmcnt(2)
    v_cmp_ne_u32 vcc, s98, v14
    v_cmp_ne_u32 s[28:29], s99, v15
    s_or_b64 vcc, vcc, s[28:29]
    s_and_b64 s[64:65], vcc, 63
    s_cbranch_scc0 L_poll_8979_done
    s_sleep 2
    s_add_u32 s27, s27, 1
    s_cmp_lt_u32 s27, 0x20000
    s_cbranch_scc1 L_poll_8979
L_poll_8979_done:

    s_waitcnt vmcnt(0)
    s_cmp_eq_u32 s31, 0
    s_cbranch_scc1 L_g2_cont0
L_g2_redo:
    s_lshr_b32 s16, s41, 5
    s_sub_u32 s25, s16, s79
    s_add_u32 s16, s16, s79
    s_add_u32 s25, s25, 229376
    buffer_load_dwordx4 v[192:195], v104, s[56:59], s16 offen offset:0 sc1
    buffer_load_dwordx4 v[196:199], v104, s[56:59], s16 offen offset:1024 sc1
    buffer_load_dwordx4 v[200:203], v104, s[56:59], s25 offen offset:0 sc1
    buffer_load_dwordx4 v[204:207], v104, s[56:59], s25 offen offset:1024 sc1
    buffer_load_dwordx4 v[208:211], v104, s[56:59], s16 offen offset:2048 sc1
    buffer_load_dwordx4 v[212:215], v104, s[56:59], s16 offen offset:3072 sc1
    buffer_load_dwordx4 v[216:219], v104, s[56:59], s25 offen offset:2048 sc1
    buffer_load_dwordx4 v[220:223], v104, s[56:59], s25 offen offset:3072 sc1
    s_add_u32 s16, s16, 4096
    s_add_u32 s25, s25, 4096
    buffer_load_dwordx4 v[224:227], v104, s[56:59], s16 offen offset:0 sc1
    buffer_load_dwordx4 v[228:231], v104, s[56:59], s16 offen offset:1024 sc1
    buffer_load_dwordx4 v[232:235], v104, s[56:59], s25 offen offset:0 sc1
    buffer_load_dwordx4 v[236:239], v104, s[56:59], s25 offen offset:1024 sc1
    buffer_load_dwordx4 v[240:243], v104, s[56:59], s16 offen offset:2048 sc1
    buffer_load_dwordx4 v[244:247], v104, s[56:59], s16 offen offset:3072 sc1
    buffer_load_dwordx4 v[248:251], v104, s[56:59], s25 offen offset:2048 sc1
    buffer_load_dwordx4 v[252:255], v104, s[56:59], s25 offen offset:3072 sc1
    s_waitcnt vmcnt(0)
    s_branch L_g2_cont0
L_g2_ep:
    v_cmp_gt_u32 vcc, 64, v1
    v_lshlrev_b32 v6, 7, v1
    v_mov_b32 v7, 1073741824
    v_cndmask_b32 v6, v7, v6, vcc
    s_mov_b32 s27, 0
    buffer_load_dwordx2 v[10:11], v6, s[12:15], s70 offen sc1
    s_sleep 4
    buffer_load_dwordx2 v[12:13], v6, s[12:15], s70 offen sc1
    s_sleep 4
L_poll_9043:
    buffer_load_dwordx2 v[14:15], v6, s[12:15], s70 offen sc1
    s_waitcnt vmcnt(2)
    v_cmp_ne_u32 vcc, s98, v10
    v_cmp_ne_u32 s[28:29], s99, v11
    s_or_b64 vcc, vcc, s[28:29]
    s_and_b64 s[64:65], vcc, -1
    s_cbranch_scc0 L_poll_9043_done
    s_sleep 2
    buffer_load_dwordx2 v[10:11], v6, s[12:15], s70 offen sc1
    s_waitcnt vmcnt(2)
    v_cmp_ne_u32 vcc, s98, v12
    v_cmp_ne_u32 s[28:29], s99, v13
    s_or_b64 vcc, vcc, s[28:29]
    s_and_b64 s[64:65], vcc, -1
    s_cbranch_scc0 L_poll_9043_done
    s_sleep 2
    buffer_load_dwordx2 v[12:13], v6, s[12:15], s70 offen sc1
    s_waitcnt vmcnt(2)
    v_cmp_ne_u32 vcc, s98, v14
    v_cmp_ne_u32 s[28:29], s99, v15
    s_or_b64 vcc, vcc, s[28:29]
    s_and_b64 s[64:65], vcc, -1
    s_cbranch_scc0 L_poll_9043_done
    s_sleep 2
    s_add_u32 s27, s27, 1
    s_cmp_lt_u32 s27, 0x20000
    s_cbranch_scc1 L_poll_9043
L_poll_9043_done:

    s_waitcnt vmcnt(0)
    s_branch L_g2_cont1
L_g2_late2:
    s_mov_b32 s27, 0
    buffer_load_dwordx2 v[10:11], v109, s[12:15], s44 offen sc1
    s_sleep 4
    buffer_load_dwordx2 v[12:13], v109, s[12:15], s44 offen sc1
    s_sleep 4
L_poll_9085:
    buffer_load_dwordx2 v[14:15], v109, s[12:15], s44 offen sc1
    s_waitcnt vmcnt(2)
    v_cmp_ne_u32 vcc, s98, v10
    v_cmp_ne_u32 s[28:29], s99, v11
    s_or_b64 vcc, vcc, s[28:29]
    s_and_b64 s[64:65], vcc, 192
    s_cbranch_scc0 L_poll_9085_done
    s_sleep 2
    buffer_load_dwordx2 v[10:11], v109, s[12:15], s44 offen sc1
    s_waitcnt vmcnt(2)
    v_cmp_ne_u32 vcc, s98, v12
    v_cmp_ne_u32 s[28:29], s99, v13
    s_or_b64 vcc, vcc, s[28:29]
    s_and_b64 s[64:65], vcc, 192
    s_cbranch_scc0 L_poll_9085_done
    s_sleep 2
    buffer_load_dwordx2 v[12:13], v109, s[12:15], s44 offen sc1
    s_waitcnt vmcnt(2)
    v_cmp_ne_u32 vcc, s98, v14
    v_cmp_ne_u32 s[28:29], s99, v15
    s_or_b64 vcc, vcc, s[28:29]
    s_and_b64 s[64:65], vcc, 192
    s_cbranch_scc0 L_poll_9085_done
    s_sleep 2
    s_add_u32 s27, s27, 1
    s_cmp_lt_u32 s27, 0x20000
    s_cbranch_scc1 L_poll_9085
L_poll_9085_done:

    s_waitcnt vmcnt(0)
    s_branch L_g2_cont2x
L_g2_late3:
    s_mov_b32 s27, 0
    buffer_load_dwordx2 v[10:11], v109, s[12:15], s44 offen sc1
    s_sleep 4
    buffer_load_dwordx2 v[12:13], v109, s[12:15], s44 offen sc1
    s_sleep 4
L_poll_9123:
    buffer_load_dwordx2 v[14:15], v109, s[12:15], s44 offen sc1
    s_waitcnt vmcnt(2)
    v_cmp_ne_u32 vcc, s98, v10
    v_cmp_ne_u32 s[28:29], s99, v11
    s_or_b64 vcc, vcc, s[28:29]
    s_and_b64 s[64:65], vcc, 768
    s_cbranch_scc0 L_poll_9123_done
    s_sleep 2
    buffer_load_dwordx2 v[10:11], v109, s[12:15], s44 offen sc1
    s_waitcnt vmcnt(2)
    v_cmp_ne_u32 vcc, s98, v12
    v_cmp_ne_u32 s[28:29], s99, v13
    s_or_b64 vcc, vcc, s[28:29]
    s_and_b64 s[64:65], vcc, 768
    s_cbranch_scc0 L_poll_9123_done
    s_sleep 2
    buffer_load_dwordx2 v[12:13], v109, s[12:15], s44 offen sc1
    s_waitcnt vmcnt(2)
    v_cmp_ne_u32 vcc, s98, v14
    v_cmp_ne_u32 s[28:29], s99, v15
    s_or_b64 vcc, vcc, s[28:29]
    s_and_b64 s[64:65], vcc, 768
    s_cbranch_scc0 L_poll_9123_done
    s_sleep 2
    s_add_u32 s27, s27, 1
    s_cmp_lt_u32 s27, 0x20000
    s_cbranch_scc1 L_poll_9123
L_poll_9123_done:

    s_waitcnt vmcnt(0)
    s_branch L_g2_cont3x
L_g2_late4:
    s_mov_b32 s27, 0
    buffer_load_dwordx2 v[10:11], v109, s[12:15], s44 offen sc1
    s_sleep 4
    buffer_load_dwordx2 v[12:13], v109, s[12:15], s44 offen sc1
    s_sleep 4
L_poll_9161:
    buffer_load_dwordx2 v[14:15], v109, s[12:15], s44 offen sc1
    s_waitcnt vmcnt(2)
    v_cmp_ne_u32 vcc, s98, v10
    v_cmp_ne_u32 s[28:29], s99, v11
    s_or_b64 vcc, vcc, s[28:29]
    s_and_b64 s[64:65], vcc, 3072
    s_cbranch_scc0 L_poll_9161_done
    s_sleep 2
    buffer_load_dwordx2 v[10:11], v109, s[12:15], s44 offen sc1
    s_waitcnt vmcnt(2)
    v_cmp_ne_u32 vcc, s98, v12
    v_cmp_ne_u32 s[28:29], s99, v13
    s_or_b64 vcc, vcc, s[28:29]
    s_and_b64 s[64:65], vcc, 3072
    s_cbranch_scc0 L_poll_9161_done
    s_sleep 2
    buffer_load_dwordx2 v[12:13], v109, s[12:15], s44 offen sc1
    s_waitcnt vmcnt(2)
    v_cmp_ne_u32 vcc, s98, v14
    v_cmp_ne_u32 s[28:29], s99, v15
    s_or_b64 vcc, vcc, s[28:29]
    s_and_b64 s[64:65], vcc, 3072
    s_cbranch_scc0 L_poll_9161_done
    s_sleep 2
    s_add_u32 s27, s27, 1
    s_cmp_lt_u32 s27, 0x20000
    s_cbranch_scc1 L_poll_9161
L_poll_9161_done:

    s_waitcnt vmcnt(0)
    s_branch L_g2_cont4x
L_g2_s4:
    s_mov_b32 s26, 26247168
    v_cmp_gt_u32 vcc, 32, v1
    v_lshlrev_b32 v6, 7, v1
    v_mov_b32 v7, 1073741824
    v_cndmask_b32 v6, v7, v6, vcc
    s_mov_b32 s27, 0
    buffer_load_dwordx2 v[10:11], v6, s[12:15], s26 offen sc1
    s_sleep 4
    buffer_load_dwordx2 v[12:13], v6, s[12:15], s26 offen sc1
    s_sleep 4
L_poll_9200:
    buffer_load_dwordx2 v[14:15], v6, s[12:15], s26 offen sc1
    s_waitcnt vmcnt(2)
    v_cmp_ne_u32 vcc, s98, v10
    v_cmp_ne_u32 s[28:29], s99, v11
    s_or_b64 vcc, vcc, s[28:29]
    s_and_b64 s[64:65], vcc, 0xffffffff
    s_cbranch_scc0 L_poll_9200_done
    s_sleep 2
    buffer_load_dwordx2 v[10:11], v6, s[12:15], s26 offen sc1
    s_waitcnt vmcnt(2)
    v_cmp_ne_u32 vcc, s98, v12
    v_cmp_ne_u32 s[28:29], s99, v13
    s_or_b64 vcc, vcc, s[28:29]
    s_and_b64 s[64:65], vcc, 0xffffffff
    s_cbranch_scc0 L_poll_9200_done
    s_sleep 2
    buffer_load_dwordx2 v[12:13], v6, s[12:15], s26 offen sc1
    s_waitcnt vmcnt(2)
    v_cmp_ne_u32 vcc, s98, v14
    v_cmp_ne_u32 s[28:29], s99, v15
    s_or_b64 vcc, vcc, s[28:29]
    s_and_b64 s[64:65], vcc, 0xffffffff
    s_cbranch_scc0 L_poll_9200_done
    s_sleep 2
    s_add_u32 s27, s27, 1
    s_cmp_lt_u32 s27, 0x20000
    s_cbranch_scc1 L_poll_9200
L_poll_9200_done:

    s_waitcnt vmcnt(0)
    s_branch L_g2_s4ok
L_end:

    s_endpgm
.text
.fill 3072, 4, 0xbf800000
.section .rodata,"a"
.p2align 6
.amdhsa_kernel gated_mix__spectral_fnet__geglu_ffn__prompt_kernel
  .amdhsa_next_free_vgpr 512
  .amdhsa_next_free_sgpr 102
  .amdhsa_accum_offset 256
  .amdhsa_group_segment_fixed_size 0
  .amdhsa_kernarg_size 104
  .amdhsa_user_sgpr_count 2
  .amdhsa_user_sgpr_kernarg_segment_ptr 1
  .amdhsa_system_sgpr_workgroup_id_x 1
.end_amdhsa_kernel
```
